```python
import torch

def _softmax(x, axis=-1):
    return torch.softmax(x, dim=axis)
def _gelu(x):
    return torch.nn.functional.gelu(x, approximate="tanh")
def _silu(x):
    return torch.nn.functional.silu(x)
def _sigmoid(x):
    return torch.sigmoid(x)
def _layernorm(x, axis=-1, eps=1e-5):
    m = x.mean(dim=axis, keepdim=True)
    v = x.var(dim=axis, keepdim=True, unbiased=False)
    return (x - m) / torch.sqrt(v + eps)
def _scatter_add(tgt, idx, src, axis=0):
    return tgt.clone().index_add_(axis, idx, src)
def _segment_sum(src, seg, n):
    out = torch.zeros((n,) + src.shape[1:], dtype=src.dtype)
    return out.index_add_(0, seg, src)
def _pad(x, pw):
    flat = tuple(v for pair in reversed(pw) for v in pair)
    return torch.nn.functional.pad(x, flat)

kernel_name = 'gated_mix__grouped_kv_mqa__dense_activation_mish__prompt'

def setup_inputs():

    _w = (lambda a: (lambda t: t.to(torch.bfloat16) if t.is_floating_point() else t)(torch.as_tensor(a)))
    def _A_setup():
        B, S, D, H = 1, 2048, 1024, 32
        Dh = D // H
        return {
            "x": _w((lambda *s: torch.randn(*s, dtype=torch.bfloat16) * 0.05)(B, S, D)),
            "wq": _w((lambda *s: torch.randn(*s, dtype=torch.bfloat16) * 0.8)(D, H * Dh)),
            "wk": _w((lambda *s: torch.randn(*s, dtype=torch.bfloat16) * 0.8)(D, Dh)),
            "wv": _w((lambda *s: torch.randn(*s, dtype=torch.bfloat16) * 0.05)(D, Dh)),
            "wo": _w((lambda *s: torch.randn(*s, dtype=torch.bfloat16) * 0.05)(H * Dh, D)),
        }
    _A_in = _A_setup()

    def _B_setup():
        B, S, D, F = 1, 2048, 1024, 3584
        return {
            "x": _w((lambda *s: torch.randn(*s, dtype=torch.bfloat16) * 0.05)(B, S, D)),
            "w1": _w((lambda *s: torch.randn(*s, dtype=torch.bfloat16) * 6.4)(D, F) * (D ** -0.5)),
            "b1": _w((lambda *s: torch.randn(*s, dtype=torch.bfloat16) * 0.1)(F)),
            "w2": _w((lambda *s: torch.randn(*s, dtype=torch.bfloat16) * 0.1)(F, D) * (F ** -0.5)),
        }
    _B_in = _B_setup()

    return {
        "A_x": _A_in["x"],
        "A_wq": _A_in["wq"],
        "A_wk": _A_in["wk"],
        "A_wv": _A_in["wv"],
        "A_wo": _A_in["wo"],
        "B_x": _B_in["x"],
        "B_w1": _B_in["w1"],
        "B_b1": _B_in["b1"],
        "B_w2": _B_in["w2"],
        "gate_w": _w((lambda *s: torch.randn(*s, dtype=torch.bfloat16) * 0.05)(1024) * 16.0),
    }

def reference(A_x, A_wq, A_wk, A_wv, A_wo, B_x, B_w1, B_b1, B_w2, gate_w):
    def _A_ref(x, wq, wk, wv, wo):
        B, S, D = x.shape
        H = 32
        Dh = D // H
        q = (lambda x, *d: x.permute(*d))((x @ wq).reshape(B, S, H, Dh), 0, 2, 1, 3)
        k = x @ wk
        v = x @ wv
        scores = torch.einsum("bhqd,bkd->bhqk", q, k) * (Dh ** -0.5)
        p = _softmax(scores, axis=-1)
        o = torch.einsum("bhqk,bkd->bhqd", p, v)
        return (lambda x, *d: x.permute(*d))(o, 0, 2, 1, 3).reshape(B, S, H * Dh) @ wo

    def _B_ref(x, w1, b1, w2):
        h = torch.einsum("bsd,df->bsf", x, w1) + b1
        sp = torch.log1p(torch.exp(-torch.abs(h))) + torch.where(h > 0, h, torch.zeros_like(h))
        act = h * torch.tanh(sp)
        return torch.einsum("bsf,fd->bsd", act, w2)

    x = A_x
    g = _sigmoid((x * gate_w).sum(-1, keepdims=True))
    a = _A_ref(x, A_wq, A_wk, A_wv, A_wo)
    b = _B_ref(x, B_w1, B_b1, B_w2)
    return g * a + (1 - g) * b
```

```asm
; @launch grid=(512,1,1) block=(256,1,1) lds=81920
.amdgcn_target "amdgcn-amd-amdhsa--gfx950"
.text
.globl gated_mix__grouped_kv_mqa__dense_activation_mish__prompt_kernel
.p2align 8
.type gated_mix__grouped_kv_mqa__dense_activation_mish__prompt_kernel,@function
gated_mix__grouped_kv_mqa__dense_activation_mish__prompt_kernel:
    s_cmp_ge_u32 s2, 512
    s_cbranch_scc1 L_exit
    s_load_dwordx16 s[72:87], s[0:1], 0
    s_load_dwordx8 s[88:95], s[0:1], 64
    s_load_dwordx2 s[96:97], s[0:1], 96
    v_lshrrev_b32 v1, 6, v0
    v_and_b32 v0, 63, v0
    s_and_b32 s24, s2, 7
    v_readfirstlane_b32 s3, v1
    s_lshr_b32 s25, s2, 3
    s_and_b32 s25, s25, 31
    s_and_b32 s28, s24, 3
    s_lshl_b32 s28, s28, 2
    s_and_b32 s29, s25, 3
    s_add_u32 s26, s28, s29
    s_and_b32 s68, s2, 255
    s_lshl_b32 s68, s68, 2
    s_add_u32 s68, s68, s3
    v_lshlrev_b32 v1, 7, v0
    s_waitcnt lgkmcnt(0)
    s_mov_b32 s4, s96
    s_mov_b32 s5, s97
    s_mov_b32 s6, 0x10000000
    s_mov_b32 s7, 0x20000
    s_mov_b32 s20, s94
    s_mov_b32 s21, s95
    s_mov_b32 s22, 256
    s_mov_b32 s23, 0x20000
    s_mov_b32 s8, s72
    s_mov_b32 s9, s73
    s_mov_b32 s10, 0x400000
    s_mov_b32 s11, 0x20000
    s_cmp_lt_u32 s2, 256
    s_cbranch_scc1 L_roleB
    s_mov_b32 s12, s74
    s_mov_b32 s13, s75
    s_mov_b32 s14, 0x200000
    s_mov_b32 s15, 0x20000
    s_mul_i32 s32, s68, 4096
    s_bfm_b64 exec, 32, 0
    buffer_load_dword v240, v1, s[8:11], s32 offen
    s_mov_b64 exec, -1
    s_mul_i32 s32, s68, 2048
    s_bfm_b64 exec, 16, 0
    buffer_load_dword v241, v1, s[12:15], s32 offen
    s_mov_b64 exec, -1
    s_cmp_ge_u32 s68, 16
    s_cbranch_scc1 L_notk_1
    s_cmp_ge_u32 s68, 8
    s_cselect_b32 s16, s78, s76
    s_cselect_b32 s17, s79, s77
    s_mov_b32 s18, 65536
    s_mov_b32 s19, 0x20000
    s_and_b32 s28, s68, 7
    s_mul_i32 s32, s28, 8192
    buffer_load_dword v242, v1, s[16:19], s32 offen
L_notk_1:
    v_lshlrev_b32 v14, 4, v0
    v_lshlrev_b32 v15, 2, v0
    s_cmp_lg_u32 s68, 0
    s_cbranch_scc1 L_nozero_2
    v_mov_b32 v20, 0
    v_mov_b32 v21, 0
    v_mov_b32 v22, 0
    v_mov_b32 v23, 0
    s_mov_b32 s28, 0
    buffer_store_dwordx4 v[20:23], v14, s[4:7], s28 offen sc1
    s_mov_b32 s28, 1024
    buffer_store_dwordx4 v[20:23], v14, s[4:7], s28 offen sc1
    s_mov_b32 s28, 2048
    buffer_store_dwordx4 v[20:23], v14, s[4:7], s28 offen sc1
    s_mov_b32 s28, 3072
    buffer_store_dwordx4 v[20:23], v14, s[4:7], s28 offen sc1
    s_mov_b32 s28, 4096
    buffer_store_dwordx4 v[20:23], v14, s[4:7], s28 offen sc1
L_nozero_2:
    s_branch L_roleA
L_roleB:
    s_cmp_ge_u32 s25, 28
    s_cbranch_scc1 L_kv
    s_setprio 2
    s_mov_b32 s12, s84
    s_mov_b32 s13, s85
    s_mov_b32 s14, 0x700000
    s_mov_b32 s15, 0x20000
    s_mov_b32 s16, s86
    s_mov_b32 s17, s87
    s_mov_b32 s18, 7168
    s_mov_b32 s19, 0x20000
    s_lshr_b32 s28, s24, 2
    s_mul_i32 s28, s28, 7
    s_lshr_b32 s29, s25, 2
    s_add_u32 s27, s28, s29
    v_lshrrev_b32 v20, 3, v0
    v_lshlrev_b32 v20, 11, v20
    v_lshrrev_b32 v21, 4, v0
    v_and_b32 v22, 7, v0
    v_xor_b32 v21, v21, v22
    v_xor_b32 v22, 0, v21
    v_lshlrev_b32 v22, 4, v22
    v_add_u32 v22, v20, v22
    v_add_u32 v8, 0, v22
    v_xor_b32 v22, 4, v21
    v_lshlrev_b32 v22, 4, v22
    v_add_u32 v22, v20, v22
    v_add_u32 v9, 15360, v22
    v_xor_b32 v22, 0, v21
    v_lshlrev_b32 v22, 4, v22
    v_add_u32 v22, v20, v22
    v_add_u32 v10, 30720, v22
    v_xor_b32 v22, 4, v21
    v_lshlrev_b32 v22, 4, v22
    v_add_u32 v22, v20, v22
    v_add_u32 v11, 46080, v22
    v_lshrrev_b32 v20, 3, v0
    v_mul_u32_u24 v20, 7168, v20
    v_bfe_u32 v21, v0, 4, 1
    v_lshlrev_b32 v21, 1, v21
    v_and_b32 v22, 7, v0
    v_xor_b32 v21, v21, v22
    v_xor_b32 v22, 0, v21
    v_lshlrev_b32 v22, 4, v22
    v_add_u32 v22, v20, v22
    v_add_u32 v12, 0, v22
    v_xor_b32 v22, 4, v21
    v_lshlrev_b32 v22, 4, v22
    v_add_u32 v22, v20, v22
    v_add_u32 v13, 56320, v22
    v_xor_b32 v22, 0, v21
    v_lshlrev_b32 v22, 4, v22
    v_add_u32 v22, v20, v22
    v_add_u32 v14, 112640, v22
    v_xor_b32 v22, 4, v21
    v_lshlrev_b32 v22, 4, v22
    v_add_u32 v22, v20, v22
    v_add_u32 v15, 168960, v22
    s_lshl_b32 s28, s26, 2
    s_add_u32 s28, s28, s3
    s_lshl_b32 s34, s28, 16
    s_lshl_b32 s36, s3, 12
    s_lshl_b32 s28, s27, 2
    s_add_u32 s28, s28, s3
    s_lshl_b32 s35, s28, 7
    s_mov_b32 s40, s35
    s_mul_i32 s37, s3, 12288
    s_add_u32 s37, s37, 32768
    v_lshrrev_b32 v17, 4, v0
    v_lshlrev_b32 v17, 3, v17
    buffer_load_dwordx2 v[64:65], v17, s[16:19], s40 offen offset:0
    buffer_load_dwordx2 v[66:67], v17, s[16:19], s40 offen offset:32
    buffer_load_dwordx2 v[68:69], v17, s[16:19], s40 offen offset:64
    buffer_load_dwordx2 v[70:71], v17, s[16:19], s40 offen offset:96
    s_add_u32 m0, s36, 0
    s_add_u32 s30, s34, 0
    buffer_load_dwordx4 v8, s[8:11], s30 offen offset:0 lds
    buffer_load_dwordx4 v9, s[8:11], s30 offen offset:1024 lds
    buffer_load_dwordx4 v10, s[8:11], s30 offen offset:2048 lds
    buffer_load_dwordx4 v11, s[8:11], s30 offen offset:3072 lds
    s_add_u32 m0, s37, 0
    s_add_u32 s57, s35, 0
    buffer_load_dwordx4 v12, s[12:15], s57 offen offset:0 lds
    buffer_load_dwordx4 v13, s[12:15], s57 offen offset:1024 lds
    buffer_load_dwordx4 v14, s[12:15], s57 offen offset:2048 lds
    buffer_load_dwordx4 v15, s[12:15], s57 offen offset:3072 lds
    s_add_u32 m0, s36, 16384
    s_add_u32 s30, s34, 128
    buffer_load_dwordx4 v8, s[8:11], s30 offen offset:0 lds
    buffer_load_dwordx4 v9, s[8:11], s30 offen offset:1024 lds
    buffer_load_dwordx4 v10, s[8:11], s30 offen offset:2048 lds
    buffer_load_dwordx4 v11, s[8:11], s30 offen offset:3072 lds
    s_add_u32 m0, s37, 4096
    s_add_u32 s57, s35, 229376
    buffer_load_dwordx4 v12, s[12:15], s57 offen offset:0 lds
    buffer_load_dwordx4 v13, s[12:15], s57 offen offset:1024 lds
    buffer_load_dwordx4 v14, s[12:15], s57 offen offset:2048 lds
    buffer_load_dwordx4 v15, s[12:15], s57 offen offset:3072 lds
    s_add_u32 m0, s37, 8192
    s_add_u32 s57, s35, 458752
    buffer_load_dwordx4 v12, s[12:15], s57 offen offset:0 lds
    buffer_load_dwordx4 v13, s[12:15], s57 offen offset:1024 lds
    buffer_load_dwordx4 v14, s[12:15], s57 offen offset:2048 lds
    buffer_load_dwordx4 v15, s[12:15], s57 offen offset:3072 lds
    s_mul_i32 s32, s68, 2048
    s_bfm_b64 exec, 16, 0
    buffer_load_dword v16, v1, s[12:15], s32 offen
    s_mov_b64 exec, -1
    s_mul_i32 s32, s68, 2048
    s_add_u32 s32, s32, 1835008
    s_bfm_b64 exec, 16, 0
    buffer_load_dword v16, v1, s[12:15], s32 offen
    s_mov_b64 exec, -1
    s_mov_b32 s44, s88
    s_mov_b32 s45, s89
    s_mov_b32 s46, 0x700000
    s_mov_b32 s47, 0x20000
    v_and_b32 v20, 15, v0
    v_lshrrev_b32 v21, 1, v20
    v_lshrrev_b32 v22, 4, v0
    v_xor_b32 v21, v21, v22
    v_lshlrev_b32 v20, 7, v20
    v_xor_b32 v22, 0, v21
    v_lshlrev_b32 v22, 4, v22
    v_add_u32 v2, v20, v22
    v_xor_b32 v22, 4, v21
    v_lshlrev_b32 v22, 4, v22
    v_add_u32 v3, v20, v22
    v_lshrrev_b32 v20, 4, v0
    v_bfe_u32 v21, v0, 2, 2
    v_lshlrev_b32 v22, 3, v20
    v_add_u32 v22, v22, v21
    v_lshlrev_b32 v22, 7, v22
    v_add_u32 v22, s37, v22
    v_and_b32 v20, 1, v20
    v_lshlrev_b32 v20, 1, v20
    v_lshrrev_b32 v21, 1, v21
    v_or_b32 v20, v20, v21
    v_and_b32 v21, 3, v0
    v_lshlrev_b32 v21, 3, v21
    v_add_u32 v22, v22, v21
    v_xor_b32 v21, 0, v20
    v_lshlrev_b32 v21, 5, v21
    v_add_u32 v4, v22, v21
    v_xor_b32 v21, 1, v20
    v_lshlrev_b32 v21, 5, v21
    v_add_u32 v5, v22, v21
    v_xor_b32 v21, 2, v20
    v_lshlrev_b32 v21, 5, v21
    v_add_u32 v6, v22, v21
    v_xor_b32 v21, 3, v20
    v_lshlrev_b32 v21, 5, v21
    v_add_u32 v7, v22, v21
    v_cmp_gt_u32 vcc, 16, v0
    v_mov_b32 v23, 0x7ff00000
    s_nop 0
    v_cndmask_b32 v23, v23, v1, vcc
    s_waitcnt vmcnt(22)
    v_lshlrev_b32 v128, 16, v64
    v_and_b32 v129, 0xffff0000, v64
    v_lshlrev_b32 v130, 16, v65
    v_and_b32 v131, 0xffff0000, v65
    v_lshlrev_b32 v132, 16, v66
    v_and_b32 v133, 0xffff0000, v66
    v_lshlrev_b32 v134, 16, v67
    v_and_b32 v135, 0xffff0000, v67
    v_lshlrev_b32 v136, 16, v68
    v_and_b32 v137, 0xffff0000, v68
    v_lshlrev_b32 v138, 16, v69
    v_and_b32 v139, 0xffff0000, v69
    v_lshlrev_b32 v140, 16, v70
    v_and_b32 v141, 0xffff0000, v70
    v_lshlrev_b32 v142, 16, v71
    v_and_b32 v143, 0xffff0000, v71
    v_mov_b32 v144, v128
    v_mov_b32 v145, v129
    v_mov_b32 v146, v130
    v_mov_b32 v147, v131
    v_mov_b32 v148, v132
    v_mov_b32 v149, v133
    v_mov_b32 v150, v134
    v_mov_b32 v151, v135
    v_mov_b32 v152, v136
    v_mov_b32 v153, v137
    v_mov_b32 v154, v138
    v_mov_b32 v155, v139
    v_mov_b32 v156, v140
    v_mov_b32 v157, v141
    v_mov_b32 v158, v142
    v_mov_b32 v159, v143
    v_mov_b32 v160, v128
    v_mov_b32 v161, v129
    v_mov_b32 v162, v130
    v_mov_b32 v163, v131
    v_mov_b32 v164, v132
    v_mov_b32 v165, v133
    v_mov_b32 v166, v134
    v_mov_b32 v167, v135
    v_mov_b32 v168, v136
    v_mov_b32 v169, v137
    v_mov_b32 v170, v138
    v_mov_b32 v171, v139
    v_mov_b32 v172, v140
    v_mov_b32 v173, v141
    v_mov_b32 v174, v142
    v_mov_b32 v175, v143
    v_mov_b32 v176, v128
    v_mov_b32 v177, v129
    v_mov_b32 v178, v130
    v_mov_b32 v179, v131
    v_mov_b32 v180, v132
    v_mov_b32 v181, v133
    v_mov_b32 v182, v134
    v_mov_b32 v183, v135
    v_mov_b32 v184, v136
    v_mov_b32 v185, v137
    v_mov_b32 v186, v138
    v_mov_b32 v187, v139
    v_mov_b32 v188, v140
    v_mov_b32 v189, v141
    v_mov_b32 v190, v142
    v_mov_b32 v191, v143
    v_mov_b32 v192, v128
    v_mov_b32 v193, v129
    v_mov_b32 v194, v130
    v_mov_b32 v195, v131
    v_mov_b32 v196, v132
    v_mov_b32 v197, v133
    v_mov_b32 v198, v134
    v_mov_b32 v199, v135
    v_mov_b32 v200, v136
    v_mov_b32 v201, v137
    v_mov_b32 v202, v138
    v_mov_b32 v203, v139
    v_mov_b32 v204, v140
    v_mov_b32 v205, v141
    v_mov_b32 v206, v142
    v_mov_b32 v207, v143
    v_mov_b32 v208, v128
    v_mov_b32 v209, v129
    v_mov_b32 v210, v130
    v_mov_b32 v211, v131
    v_mov_b32 v212, v132
    v_mov_b32 v213, v133
    v_mov_b32 v214, v134
    v_mov_b32 v215, v135
    v_mov_b32 v216, v136
    v_mov_b32 v217, v137
    v_mov_b32 v218, v138
    v_mov_b32 v219, v139
    v_mov_b32 v220, v140
    v_mov_b32 v221, v141
    v_mov_b32 v222, v142
    v_mov_b32 v223, v143
    v_mov_b32 v224, v128
    v_mov_b32 v225, v129
    v_mov_b32 v226, v130
    v_mov_b32 v227, v131
    v_mov_b32 v228, v132
    v_mov_b32 v229, v133
    v_mov_b32 v230, v134
    v_mov_b32 v231, v135
    v_mov_b32 v232, v136
    v_mov_b32 v233, v137
    v_mov_b32 v234, v138
    v_mov_b32 v235, v139
    v_mov_b32 v236, v140
    v_mov_b32 v237, v141
    v_mov_b32 v238, v142
    v_mov_b32 v239, v143
    v_mov_b32 v240, v128
    v_mov_b32 v241, v129
    v_mov_b32 v242, v130
    v_mov_b32 v243, v131
    v_mov_b32 v244, v132
    v_mov_b32 v245, v133
    v_mov_b32 v246, v134
    v_mov_b32 v247, v135
    v_mov_b32 v248, v136
    v_mov_b32 v249, v137
    v_mov_b32 v250, v138
    v_mov_b32 v251, v139
    v_mov_b32 v252, v140
    v_mov_b32 v253, v141
    v_mov_b32 v254, v142
    v_mov_b32 v255, v143
    s_waitcnt vmcnt(14)
    s_barrier
    ds_read_b64_tr_b16 v[32:33], v4 offset:0
    ds_read_b64_tr_b16 v[34:35], v4 offset:512
    ds_read_b64_tr_b16 v[36:37], v5 offset:0
    ds_read_b64_tr_b16 v[38:39], v5 offset:512
    ds_read_b64_tr_b16 v[40:41], v6 offset:0
    ds_read_b64_tr_b16 v[42:43], v6 offset:512
    ds_read_b64_tr_b16 v[44:45], v7 offset:0
    ds_read_b64_tr_b16 v[46:47], v7 offset:512
    ds_read_b128 v[64:67], v2 offset:0
    ds_read_b128 v[68:71], v2 offset:2048
    ds_read_b128 v[72:75], v2 offset:4096
    ds_read_b128 v[76:79], v2 offset:6144
    ds_read_b128 v[80:83], v2 offset:8192
    ds_read_b128 v[84:87], v2 offset:10240
    ds_read_b128 v[88:91], v2 offset:12288
    ds_read_b128 v[92:95], v2 offset:14336
    s_waitcnt lgkmcnt(0)
    s_waitcnt vmcnt(6)
    v_mfma_f32_16x16x32_bf16 v[128:131], v[32:35], v[64:67], v[128:131]
    s_add_u32 m0, s37, 0
    v_mfma_f32_16x16x32_bf16 v[132:135], v[36:39], v[64:67], v[132:135]
    s_add_u32 s57, s35, 688128
    v_mfma_f32_16x16x32_bf16 v[136:139], v[40:43], v[64:67], v[136:139]
    buffer_load_dwordx4 v12, s[12:15], s57 offen offset:0 lds
    ds_read_b64_tr_b16 v[48:49], v4 offset:4096
    v_mfma_f32_16x16x32_bf16 v[140:143], v[44:47], v[64:67], v[140:143]
    buffer_load_dwordx4 v13, s[12:15], s57 offen offset:1024 lds
    ds_read_b64_tr_b16 v[50:51], v4 offset:4608
    v_mfma_f32_16x16x32_bf16 v[156:159], v[44:47], v[68:71], v[156:159]
    buffer_load_dwordx4 v14, s[12:15], s57 offen offset:2048 lds
    ds_read_b64_tr_b16 v[52:53], v5 offset:4096
    v_mfma_f32_16x16x32_bf16 v[152:155], v[40:43], v[68:71], v[152:155]
    buffer_load_dwordx4 v15, s[12:15], s57 offen offset:3072 lds
    ds_read_b64_tr_b16 v[54:55], v5 offset:4608
    v_mfma_f32_16x16x32_bf16 v[148:151], v[36:39], v[68:71], v[148:151]
    ds_read_b64_tr_b16 v[56:57], v6 offset:4096
    v_mfma_f32_16x16x32_bf16 v[144:147], v[32:35], v[68:71], v[144:147]
    ds_read_b64_tr_b16 v[58:59], v6 offset:4608
    v_mfma_f32_16x16x32_bf16 v[160:163], v[32:35], v[72:75], v[160:163]
    ds_read_b64_tr_b16 v[60:61], v7 offset:4096
    v_mfma_f32_16x16x32_bf16 v[164:167], v[36:39], v[72:75], v[164:167]
    ds_read_b64_tr_b16 v[62:63], v7 offset:4608
    v_mfma_f32_16x16x32_bf16 v[168:171], v[40:43], v[72:75], v[168:171]
    ds_read_b128 v[96:99], v3 offset:0
    v_mfma_f32_16x16x32_bf16 v[172:175], v[44:47], v[72:75], v[172:175]
    ds_read_b128 v[100:103], v3 offset:2048
    v_mfma_f32_16x16x32_bf16 v[188:191], v[44:47], v[76:79], v[188:191]
    ds_read_b128 v[104:107], v3 offset:4096
    v_mfma_f32_16x16x32_bf16 v[184:187], v[40:43], v[76:79], v[184:187]
    ds_read_b128 v[108:111], v3 offset:6144
    v_mfma_f32_16x16x32_bf16 v[180:183], v[36:39], v[76:79], v[180:183]
    ds_read_b128 v[112:115], v3 offset:8192
    v_mfma_f32_16x16x32_bf16 v[176:179], v[32:35], v[76:79], v[176:179]
    ds_read_b128 v[116:119], v3 offset:10240
    v_mfma_f32_16x16x32_bf16 v[192:195], v[32:35], v[80:83], v[192:195]
    ds_read_b128 v[120:123], v3 offset:12288
    v_mfma_f32_16x16x32_bf16 v[196:199], v[36:39], v[80:83], v[196:199]
    ds_read_b128 v[124:127], v3 offset:14336
    v_mfma_f32_16x16x32_bf16 v[200:203], v[40:43], v[80:83], v[200:203]
    v_mfma_f32_16x16x32_bf16 v[204:207], v[44:47], v[80:83], v[204:207]
    v_mfma_f32_16x16x32_bf16 v[220:223], v[44:47], v[84:87], v[220:223]
    v_mfma_f32_16x16x32_bf16 v[216:219], v[40:43], v[84:87], v[216:219]
    v_mfma_f32_16x16x32_bf16 v[212:215], v[36:39], v[84:87], v[212:215]
    v_mfma_f32_16x16x32_bf16 v[208:211], v[32:35], v[84:87], v[208:211]
    v_mfma_f32_16x16x32_bf16 v[224:227], v[32:35], v[88:91], v[224:227]
    v_mfma_f32_16x16x32_bf16 v[228:231], v[36:39], v[88:91], v[228:231]
    v_mfma_f32_16x16x32_bf16 v[232:235], v[40:43], v[88:91], v[232:235]
    v_mfma_f32_16x16x32_bf16 v[236:239], v[44:47], v[88:91], v[236:239]
    v_mfma_f32_16x16x32_bf16 v[252:255], v[44:47], v[92:95], v[252:255]
    v_mfma_f32_16x16x32_bf16 v[248:251], v[40:43], v[92:95], v[248:251]
    v_mfma_f32_16x16x32_bf16 v[244:247], v[36:39], v[92:95], v[244:247]
    v_mfma_f32_16x16x32_bf16 v[240:243], v[32:35], v[92:95], v[240:243]
    s_waitcnt lgkmcnt(0)
    s_waitcnt vmcnt(6)
    s_barrier
    v_mfma_f32_16x16x32_bf16 v[128:131], v[48:51], v[96:99], v[128:131]
    s_add_u32 m0, s37, 4096
    v_mfma_f32_16x16x32_bf16 v[132:135], v[52:55], v[96:99], v[132:135]
    s_add_u32 s57, s35, 917504
    v_mfma_f32_16x16x32_bf16 v[136:139], v[56:59], v[96:99], v[136:139]
    buffer_load_dwordx4 v12, s[12:15], s57 offen offset:0 lds
    ds_read_b64_tr_b16 v[32:33], v4 offset:8192
    v_mfma_f32_16x16x32_bf16 v[140:143], v[60:63], v[96:99], v[140:143]
    buffer_load_dwordx4 v13, s[12:15], s57 offen offset:1024 lds
    ds_read_b64_tr_b16 v[34:35], v4 offset:8704
    v_mfma_f32_16x16x32_bf16 v[156:159], v[60:63], v[100:103], v[156:159]
    buffer_load_dwordx4 v14, s[12:15], s57 offen offset:2048 lds
    ds_read_b64_tr_b16 v[36:37], v5 offset:8192
    v_mfma_f32_16x16x32_bf16 v[152:155], v[56:59], v[100:103], v[152:155]
    buffer_load_dwordx4 v15, s[12:15], s57 offen offset:3072 lds
    ds_read_b64_tr_b16 v[38:39], v5 offset:8704
    v_mfma_f32_16x16x32_bf16 v[148:151], v[52:55], v[100:103], v[148:151]
    s_add_u32 m0, s36, 0
    ds_read_b64_tr_b16 v[40:41], v6 offset:8192
    v_mfma_f32_16x16x32_bf16 v[144:147], v[48:51], v[100:103], v[144:147]
    s_add_u32 s30, s34, 256
    ds_read_b64_tr_b16 v[42:43], v6 offset:8704
    v_mfma_f32_16x16x32_bf16 v[160:163], v[48:51], v[104:107], v[160:163]
    buffer_load_dwordx4 v8, s[8:11], s30 offen offset:0 lds
    ds_read_b64_tr_b16 v[44:45], v7 offset:8192
    v_mfma_f32_16x16x32_bf16 v[164:167], v[52:55], v[104:107], v[164:167]
    buffer_load_dwordx4 v9, s[8:11], s30 offen offset:1024 lds
    ds_read_b64_tr_b16 v[46:47], v7 offset:8704
    v_mfma_f32_16x16x32_bf16 v[168:171], v[56:59], v[104:107], v[168:171]
    buffer_load_dwordx4 v10, s[8:11], s30 offen offset:2048 lds
    ds_read_b128 v[64:67], v2 offset:16384
    v_mfma_f32_16x16x32_bf16 v[172:175], v[60:63], v[104:107], v[172:175]
    buffer_load_dwordx4 v11, s[8:11], s30 offen offset:3072 lds
    ds_read_b128 v[68:71], v2 offset:18432
    v_mfma_f32_16x16x32_bf16 v[188:191], v[60:63], v[108:111], v[188:191]
    ds_read_b128 v[72:75], v2 offset:20480
    v_mfma_f32_16x16x32_bf16 v[184:187], v[56:59], v[108:111], v[184:187]
    ds_read_b128 v[76:79], v2 offset:22528
    v_mfma_f32_16x16x32_bf16 v[180:183], v[52:55], v[108:111], v[180:183]
    ds_read_b128 v[80:83], v2 offset:24576
    v_mfma_f32_16x16x32_bf16 v[176:179], v[48:51], v[108:111], v[176:179]
    ds_read_b128 v[84:87], v2 offset:26624
    v_mfma_f32_16x16x32_bf16 v[192:195], v[48:51], v[112:115], v[192:195]
    ds_read_b128 v[88:91], v2 offset:28672
    v_mfma_f32_16x16x32_bf16 v[196:199], v[52:55], v[112:115], v[196:199]
    ds_read_b128 v[92:95], v2 offset:30720
    v_mfma_f32_16x16x32_bf16 v[200:203], v[56:59], v[112:115], v[200:203]
    v_mfma_f32_16x16x32_bf16 v[204:207], v[60:63], v[112:115], v[204:207]
    v_mfma_f32_16x16x32_bf16 v[220:223], v[60:63], v[116:119], v[220:223]
    v_mfma_f32_16x16x32_bf16 v[216:219], v[56:59], v[116:119], v[216:219]
    v_mfma_f32_16x16x32_bf16 v[212:215], v[52:55], v[116:119], v[212:215]
    v_mfma_f32_16x16x32_bf16 v[208:211], v[48:51], v[116:119], v[208:211]
    v_mfma_f32_16x16x32_bf16 v[224:227], v[48:51], v[120:123], v[224:227]
    v_mfma_f32_16x16x32_bf16 v[228:231], v[52:55], v[120:123], v[228:231]
    v_mfma_f32_16x16x32_bf16 v[232:235], v[56:59], v[120:123], v[232:235]
    v_mfma_f32_16x16x32_bf16 v[236:239], v[60:63], v[120:123], v[236:239]
    v_mfma_f32_16x16x32_bf16 v[252:255], v[60:63], v[124:127], v[252:255]
    v_mfma_f32_16x16x32_bf16 v[248:251], v[56:59], v[124:127], v[248:251]
    v_mfma_f32_16x16x32_bf16 v[244:247], v[52:55], v[124:127], v[244:247]
    v_mfma_f32_16x16x32_bf16 v[240:243], v[48:51], v[124:127], v[240:243]
    s_waitcnt lgkmcnt(0)
    s_waitcnt vmcnt(8)
    v_mfma_f32_16x16x32_bf16 v[128:131], v[32:35], v[64:67], v[128:131]
    s_add_u32 m0, s37, 8192
    v_mfma_f32_16x16x32_bf16 v[132:135], v[36:39], v[64:67], v[132:135]
    s_add_u32 s57, s35, 1146880
    v_mfma_f32_16x16x32_bf16 v[136:139], v[40:43], v[64:67], v[136:139]
    buffer_load_dwordx4 v12, s[12:15], s57 offen offset:0 lds
    ds_read_b64_tr_b16 v[48:49], v4 offset:0
    v_mfma_f32_16x16x32_bf16 v[140:143], v[44:47], v[64:67], v[140:143]
    buffer_load_dwordx4 v13, s[12:15], s57 offen offset:1024 lds
    ds_read_b64_tr_b16 v[50:51], v4 offset:512
    v_mfma_f32_16x16x32_bf16 v[156:159], v[44:47], v[68:71], v[156:159]
    buffer_load_dwordx4 v14, s[12:15], s57 offen offset:2048 lds
    ds_read_b64_tr_b16 v[52:53], v5 offset:0
    v_mfma_f32_16x16x32_bf16 v[152:155], v[40:43], v[68:71], v[152:155]
    buffer_load_dwordx4 v15, s[12:15], s57 offen offset:3072 lds
    ds_read_b64_tr_b16 v[54:55], v5 offset:512
    v_mfma_f32_16x16x32_bf16 v[148:151], v[36:39], v[68:71], v[148:151]
    s_mul_i32 s32, s68, 2048
    ds_read_b64_tr_b16 v[56:57], v6 offset:0
    v_mfma_f32_16x16x32_bf16 v[144:147], v[32:35], v[68:71], v[144:147]
    s_add_u32 s32, s32, 3670016
    ds_read_b64_tr_b16 v[58:59], v6 offset:512
    v_mfma_f32_16x16x32_bf16 v[160:163], v[32:35], v[72:75], v[160:163]
    buffer_load_dword v16, v23, s[12:15], s32 offen
    ds_read_b64_tr_b16 v[60:61], v7 offset:0
    v_mfma_f32_16x16x32_bf16 v[164:167], v[36:39], v[72:75], v[164:167]
    ds_read_b64_tr_b16 v[62:63], v7 offset:512
    v_mfma_f32_16x16x32_bf16 v[168:171], v[40:43], v[72:75], v[168:171]
    ds_read_b128 v[96:99], v3 offset:16384
    v_mfma_f32_16x16x32_bf16 v[172:175], v[44:47], v[72:75], v[172:175]
    ds_read_b128 v[100:103], v3 offset:18432
    v_mfma_f32_16x16x32_bf16 v[188:191], v[44:47], v[76:79], v[188:191]
    ds_read_b128 v[104:107], v3 offset:20480
    v_mfma_f32_16x16x32_bf16 v[184:187], v[40:43], v[76:79], v[184:187]
    ds_read_b128 v[108:111], v3 offset:22528
    v_mfma_f32_16x16x32_bf16 v[180:183], v[36:39], v[76:79], v[180:183]
    ds_read_b128 v[112:115], v3 offset:24576
    v_mfma_f32_16x16x32_bf16 v[176:179], v[32:35], v[76:79], v[176:179]
    ds_read_b128 v[116:119], v3 offset:26624
    v_mfma_f32_16x16x32_bf16 v[192:195], v[32:35], v[80:83], v[192:195]
    ds_read_b128 v[120:123], v3 offset:28672
    v_mfma_f32_16x16x32_bf16 v[196:199], v[36:39], v[80:83], v[196:199]
    ds_read_b128 v[124:127], v3 offset:30720
    v_mfma_f32_16x16x32_bf16 v[200:203], v[40:43], v[80:83], v[200:203]
    v_mfma_f32_16x16x32_bf16 v[204:207], v[44:47], v[80:83], v[204:207]
    v_mfma_f32_16x16x32_bf16 v[220:223], v[44:47], v[84:87], v[220:223]
    v_mfma_f32_16x16x32_bf16 v[216:219], v[40:43], v[84:87], v[216:219]
    v_mfma_f32_16x16x32_bf16 v[212:215], v[36:39], v[84:87], v[212:215]
    v_mfma_f32_16x16x32_bf16 v[208:211], v[32:35], v[84:87], v[208:211]
    v_mfma_f32_16x16x32_bf16 v[224:227], v[32:35], v[88:91], v[224:227]
    v_mfma_f32_16x16x32_bf16 v[228:231], v[36:39], v[88:91], v[228:231]
    v_mfma_f32_16x16x32_bf16 v[232:235], v[40:43], v[88:91], v[232:235]
    v_mfma_f32_16x16x32_bf16 v[236:239], v[44:47], v[88:91], v[236:239]
    v_mfma_f32_16x16x32_bf16 v[252:255], v[44:47], v[92:95], v[252:255]
    v_mfma_f32_16x16x32_bf16 v[248:251], v[40:43], v[92:95], v[248:251]
    v_mfma_f32_16x16x32_bf16 v[244:247], v[36:39], v[92:95], v[244:247]
    v_mfma_f32_16x16x32_bf16 v[240:243], v[32:35], v[92:95], v[240:243]
    s_waitcnt lgkmcnt(0)
    s_waitcnt vmcnt(5)
    s_barrier
    v_mfma_f32_16x16x32_bf16 v[128:131], v[48:51], v[96:99], v[128:131]
    s_add_u32 m0, s37, 0
    v_mfma_f32_16x16x32_bf16 v[132:135], v[52:55], v[96:99], v[132:135]
    s_add_u32 s57, s35, 1376256
    v_mfma_f32_16x16x32_bf16 v[136:139], v[56:59], v[96:99], v[136:139]
    buffer_load_dwordx4 v12, s[12:15], s57 offen offset:0 lds
    ds_read_b64_tr_b16 v[32:33], v4 offset:4096
    v_mfma_f32_16x16x32_bf16 v[140:143], v[60:63], v[96:99], v[140:143]
    buffer_load_dwordx4 v13, s[12:15], s57 offen offset:1024 lds
    ds_read_b64_tr_b16 v[34:35], v4 offset:4608
    v_mfma_f32_16x16x32_bf16 v[156:159], v[60:63], v[100:103], v[156:159]
    buffer_load_dwordx4 v14, s[12:15], s57 offen offset:2048 lds
    ds_read_b64_tr_b16 v[36:37], v5 offset:4096
    v_mfma_f32_16x16x32_bf16 v[152:155], v[56:59], v[100:103], v[152:155]
    buffer_load_dwordx4 v15, s[12:15], s57 offen offset:3072 lds
    ds_read_b64_tr_b16 v[38:39], v5 offset:4608
    v_mfma_f32_16x16x32_bf16 v[148:151], v[52:55], v[100:103], v[148:151]
    s_add_u32 m0, s36, 16384
    ds_read_b64_tr_b16 v[40:41], v6 offset:4096
    v_mfma_f32_16x16x32_bf16 v[144:147], v[48:51], v[100:103], v[144:147]
    s_add_u32 s30, s34, 384
    ds_read_b64_tr_b16 v[42:43], v6 offset:4608
    v_mfma_f32_16x16x32_bf16 v[160:163], v[48:51], v[104:107], v[160:163]
    buffer_load_dwordx4 v8, s[8:11], s30 offen offset:0 lds
    ds_read_b64_tr_b16 v[44:45], v7 offset:4096
    v_mfma_f32_16x16x32_bf16 v[164:167], v[52:55], v[104:107], v[164:167]
    buffer_load_dwordx4 v9, s[8:11], s30 offen offset:1024 lds
    ds_read_b64_tr_b16 v[46:47], v7 offset:4608
    v_mfma_f32_16x16x32_bf16 v[168:171], v[56:59], v[104:107], v[168:171]
    buffer_load_dwordx4 v10, s[8:11], s30 offen offset:2048 lds
    ds_read_b128 v[64:67], v2 offset:0
    v_mfma_f32_16x16x32_bf16 v[172:175], v[60:63], v[104:107], v[172:175]
    buffer_load_dwordx4 v11, s[8:11], s30 offen offset:3072 lds
    ds_read_b128 v[68:71], v2 offset:2048
    v_mfma_f32_16x16x32_bf16 v[188:191], v[60:63], v[108:111], v[188:191]
    ds_read_b128 v[72:75], v2 offset:4096
    v_mfma_f32_16x16x32_bf16 v[184:187], v[56:59], v[108:111], v[184:187]
    ds_read_b128 v[76:79], v2 offset:6144
    v_mfma_f32_16x16x32_bf16 v[180:183], v[52:55], v[108:111], v[180:183]
    ds_read_b128 v[80:83], v2 offset:8192
    v_mfma_f32_16x16x32_bf16 v[176:179], v[48:51], v[108:111], v[176:179]
    ds_read_b128 v[84:87], v2 offset:10240
    v_mfma_f32_16x16x32_bf16 v[192:195], v[48:51], v[112:115], v[192:195]
    ds_read_b128 v[88:91], v2 offset:12288
    v_mfma_f32_16x16x32_bf16 v[196:199], v[52:55], v[112:115], v[196:199]
    ds_read_b128 v[92:95], v2 offset:14336
    v_mfma_f32_16x16x32_bf16 v[200:203], v[56:59], v[112:115], v[200:203]
    v_mfma_f32_16x16x32_bf16 v[204:207], v[60:63], v[112:115], v[204:207]
    v_mfma_f32_16x16x32_bf16 v[220:223], v[60:63], v[116:119], v[220:223]
    v_mfma_f32_16x16x32_bf16 v[216:219], v[56:59], v[116:119], v[216:219]
    v_mfma_f32_16x16x32_bf16 v[212:215], v[52:55], v[116:119], v[212:215]
    v_mfma_f32_16x16x32_bf16 v[208:211], v[48:51], v[116:119], v[208:211]
    v_mfma_f32_16x16x32_bf16 v[224:227], v[48:51], v[120:123], v[224:227]
    v_mfma_f32_16x16x32_bf16 v[228:231], v[52:55], v[120:123], v[228:231]
    v_mfma_f32_16x16x32_bf16 v[232:235], v[56:59], v[120:123], v[232:235]
    v_mfma_f32_16x16x32_bf16 v[236:239], v[60:63], v[120:123], v[236:239]
    v_mfma_f32_16x16x32_bf16 v[252:255], v[60:63], v[124:127], v[252:255]
    v_mfma_f32_16x16x32_bf16 v[248:251], v[56:59], v[124:127], v[248:251]
    v_mfma_f32_16x16x32_bf16 v[244:247], v[52:55], v[124:127], v[244:247]
    v_mfma_f32_16x16x32_bf16 v[240:243], v[48:51], v[124:127], v[240:243]
    s_waitcnt lgkmcnt(0)
    s_waitcnt vmcnt(9)
    v_mfma_f32_16x16x32_bf16 v[128:131], v[32:35], v[64:67], v[128:131]
    s_add_u32 m0, s37, 4096
    v_mfma_f32_16x16x32_bf16 v[132:135], v[36:39], v[64:67], v[132:135]
    s_add_u32 s57, s35, 1605632
    v_mfma_f32_16x16x32_bf16 v[136:139], v[40:43], v[64:67], v[136:139]
    buffer_load_dwordx4 v12, s[12:15], s57 offen offset:0 lds
    ds_read_b64_tr_b16 v[48:49], v4 offset:8192
    v_mfma_f32_16x16x32_bf16 v[140:143], v[44:47], v[64:67], v[140:143]
    buffer_load_dwordx4 v13, s[12:15], s57 offen offset:1024 lds
    ds_read_b64_tr_b16 v[50:51], v4 offset:8704
    v_mfma_f32_16x16x32_bf16 v[156:159], v[44:47], v[68:71], v[156:159]
    buffer_load_dwordx4 v14, s[12:15], s57 offen offset:2048 lds
    ds_read_b64_tr_b16 v[52:53], v5 offset:8192
    v_mfma_f32_16x16x32_bf16 v[152:155], v[40:43], v[68:71], v[152:155]
    buffer_load_dwordx4 v15, s[12:15], s57 offen offset:3072 lds
    ds_read_b64_tr_b16 v[54:55], v5 offset:8704
    v_mfma_f32_16x16x32_bf16 v[148:151], v[36:39], v[68:71], v[148:151]
    ds_read_b64_tr_b16 v[56:57], v6 offset:8192
    v_mfma_f32_16x16x32_bf16 v[144:147], v[32:35], v[68:71], v[144:147]
    ds_read_b64_tr_b16 v[58:59], v6 offset:8704
    v_mfma_f32_16x16x32_bf16 v[160:163], v[32:35], v[72:75], v[160:163]
    ds_read_b64_tr_b16 v[60:61], v7 offset:8192
    v_mfma_f32_16x16x32_bf16 v[164:167], v[36:39], v[72:75], v[164:167]
    ds_read_b64_tr_b16 v[62:63], v7 offset:8704
    v_mfma_f32_16x16x32_bf16 v[168:171], v[40:43], v[72:75], v[168:171]
    ds_read_b128 v[96:99], v3 offset:0
    v_mfma_f32_16x16x32_bf16 v[172:175], v[44:47], v[72:75], v[172:175]
    ds_read_b128 v[100:103], v3 offset:2048
    v_mfma_f32_16x16x32_bf16 v[188:191], v[44:47], v[76:79], v[188:191]
    ds_read_b128 v[104:107], v3 offset:4096
    v_mfma_f32_16x16x32_bf16 v[184:187], v[40:43], v[76:79], v[184:187]
    ds_read_b128 v[108:111], v3 offset:6144
    v_mfma_f32_16x16x32_bf16 v[180:183], v[36:39], v[76:79], v[180:183]
    ds_read_b128 v[112:115], v3 offset:8192
    v_mfma_f32_16x16x32_bf16 v[176:179], v[32:35], v[76:79], v[176:179]
    ds_read_b128 v[116:119], v3 offset:10240
    v_mfma_f32_16x16x32_bf16 v[192:195], v[32:35], v[80:83], v[192:195]
    ds_read_b128 v[120:123], v3 offset:12288
    v_mfma_f32_16x16x32_bf16 v[196:199], v[36:39], v[80:83], v[196:199]
    ds_read_b128 v[124:127], v3 offset:14336
    v_mfma_f32_16x16x32_bf16 v[200:203], v[40:43], v[80:83], v[200:203]
    v_mfma_f32_16x16x32_bf16 v[204:207], v[44:47], v[80:83], v[204:207]
    v_mfma_f32_16x16x32_bf16 v[220:223], v[44:47], v[84:87], v[220:223]
    v_mfma_f32_16x16x32_bf16 v[216:219], v[40:43], v[84:87], v[216:219]
    v_mfma_f32_16x16x32_bf16 v[212:215], v[36:39], v[84:87], v[212:215]
    v_mfma_f32_16x16x32_bf16 v[208:211], v[32:35], v[84:87], v[208:211]
    v_mfma_f32_16x16x32_bf16 v[224:227], v[32:35], v[88:91], v[224:227]
    v_mfma_f32_16x16x32_bf16 v[228:231], v[36:39], v[88:91], v[228:231]
    v_mfma_f32_16x16x32_bf16 v[232:235], v[40:43], v[88:91], v[232:235]
    v_mfma_f32_16x16x32_bf16 v[236:239], v[44:47], v[88:91], v[236:239]
    v_mfma_f32_16x16x32_bf16 v[252:255], v[44:47], v[92:95], v[252:255]
    v_mfma_f32_16x16x32_bf16 v[248:251], v[40:43], v[92:95], v[248:251]
    v_mfma_f32_16x16x32_bf16 v[244:247], v[36:39], v[92:95], v[244:247]
    v_mfma_f32_16x16x32_bf16 v[240:243], v[32:35], v[92:95], v[240:243]
    s_waitcnt lgkmcnt(0)
    s_waitcnt vmcnt(4)
    s_barrier
    v_mfma_f32_16x16x32_bf16 v[128:131], v[48:51], v[96:99], v[128:131]
    s_add_u32 m0, s37, 8192
    v_mfma_f32_16x16x32_bf16 v[132:135], v[52:55], v[96:99], v[132:135]
    s_add_u32 s57, s35, 1835008
    v_mfma_f32_16x16x32_bf16 v[136:139], v[56:59], v[96:99], v[136:139]
    buffer_load_dwordx4 v12, s[12:15], s57 offen offset:0 lds
    ds_read_b64_tr_b16 v[32:33], v4 offset:0
    v_mfma_f32_16x16x32_bf16 v[140:143], v[60:63], v[96:99], v[140:143]
    buffer_load_dwordx4 v13, s[12:15], s57 offen offset:1024 lds
    ds_read_b64_tr_b16 v[34:35], v4 offset:512
    v_mfma_f32_16x16x32_bf16 v[156:159], v[60:63], v[100:103], v[156:159]
    buffer_load_dwordx4 v14, s[12:15], s57 offen offset:2048 lds
    ds_read_b64_tr_b16 v[36:37], v5 offset:0
    v_mfma_f32_16x16x32_bf16 v[152:155], v[56:59], v[100:103], v[152:155]
    buffer_load_dwordx4 v15, s[12:15], s57 offen offset:3072 lds
    ds_read_b64_tr_b16 v[38:39], v5 offset:512
    v_mfma_f32_16x16x32_bf16 v[148:151], v[52:55], v[100:103], v[148:151]
    s_add_u32 m0, s36, 0
    ds_read_b64_tr_b16 v[40:41], v6 offset:0
    v_mfma_f32_16x16x32_bf16 v[144:147], v[48:51], v[100:103], v[144:147]
    s_add_u32 s30, s34, 512
    ds_read_b64_tr_b16 v[42:43], v6 offset:512
    v_mfma_f32_16x16x32_bf16 v[160:163], v[48:51], v[104:107], v[160:163]
    buffer_load_dwordx4 v8, s[8:11], s30 offen offset:0 lds
    ds_read_b64_tr_b16 v[44:45], v7 offset:0
    v_mfma_f32_16x16x32_bf16 v[164:167], v[52:55], v[104:107], v[164:167]
    buffer_load_dwordx4 v9, s[8:11], s30 offen offset:1024 lds
    ds_read_b64_tr_b16 v[46:47], v7 offset:512
    v_mfma_f32_16x16x32_bf16 v[168:171], v[56:59], v[104:107], v[168:171]
    buffer_load_dwordx4 v10, s[8:11], s30 offen offset:2048 lds
    ds_read_b128 v[64:67], v2 offset:16384
    v_mfma_f32_16x16x32_bf16 v[172:175], v[60:63], v[104:107], v[172:175]
    buffer_load_dwordx4 v11, s[8:11], s30 offen offset:3072 lds
    ds_read_b128 v[68:71], v2 offset:18432
    v_mfma_f32_16x16x32_bf16 v[188:191], v[60:63], v[108:111], v[188:191]
    ds_read_b128 v[72:75], v2 offset:20480
    v_mfma_f32_16x16x32_bf16 v[184:187], v[56:59], v[108:111], v[184:187]
    ds_read_b128 v[76:79], v2 offset:22528
    v_mfma_f32_16x16x32_bf16 v[180:183], v[52:55], v[108:111], v[180:183]
    ds_read_b128 v[80:83], v2 offset:24576
    v_mfma_f32_16x16x32_bf16 v[176:179], v[48:51], v[108:111], v[176:179]
    ds_read_b128 v[84:87], v2 offset:26624
    v_mfma_f32_16x16x32_bf16 v[192:195], v[48:51], v[112:115], v[192:195]
    ds_read_b128 v[88:91], v2 offset:28672
    v_mfma_f32_16x16x32_bf16 v[196:199], v[52:55], v[112:115], v[196:199]
    ds_read_b128 v[92:95], v2 offset:30720
    v_mfma_f32_16x16x32_bf16 v[200:203], v[56:59], v[112:115], v[200:203]
    v_mfma_f32_16x16x32_bf16 v[204:207], v[60:63], v[112:115], v[204:207]
    v_mfma_f32_16x16x32_bf16 v[220:223], v[60:63], v[116:119], v[220:223]
    v_mfma_f32_16x16x32_bf16 v[216:219], v[56:59], v[116:119], v[216:219]
    v_mfma_f32_16x16x32_bf16 v[212:215], v[52:55], v[116:119], v[212:215]
    v_mfma_f32_16x16x32_bf16 v[208:211], v[48:51], v[116:119], v[208:211]
    v_mfma_f32_16x16x32_bf16 v[224:227], v[48:51], v[120:123], v[224:227]
    v_mfma_f32_16x16x32_bf16 v[228:231], v[52:55], v[120:123], v[228:231]
    v_mfma_f32_16x16x32_bf16 v[232:235], v[56:59], v[120:123], v[232:235]
    v_mfma_f32_16x16x32_bf16 v[236:239], v[60:63], v[120:123], v[236:239]
    v_mfma_f32_16x16x32_bf16 v[252:255], v[60:63], v[124:127], v[252:255]
    v_mfma_f32_16x16x32_bf16 v[248:251], v[56:59], v[124:127], v[248:251]
    v_mfma_f32_16x16x32_bf16 v[244:247], v[52:55], v[124:127], v[244:247]
    v_mfma_f32_16x16x32_bf16 v[240:243], v[48:51], v[124:127], v[240:243]
    s_waitcnt lgkmcnt(0)
    s_waitcnt vmcnt(8)
    v_mfma_f32_16x16x32_bf16 v[128:131], v[32:35], v[64:67], v[128:131]
    s_add_u32 m0, s37, 0
    v_mfma_f32_16x16x32_bf16 v[132:135], v[36:39], v[64:67], v[132:135]
    s_add_u32 s57, s35, 2064384
    v_mfma_f32_16x16x32_bf16 v[136:139], v[40:43], v[64:67], v[136:139]
    buffer_load_dwordx4 v12, s[12:15], s57 offen offset:0 lds
    ds_read_b64_tr_b16 v[48:49], v4 offset:4096
    v_mfma_f32_16x16x32_bf16 v[140:143], v[44:47], v[64:67], v[140:143]
    buffer_load_dwordx4 v13, s[12:15], s57 offen offset:1024 lds
    ds_read_b64_tr_b16 v[50:51], v4 offset:4608
    v_mfma_f32_16x16x32_bf16 v[156:159], v[44:47], v[68:71], v[156:159]
    buffer_load_dwordx4 v14, s[12:15], s57 offen offset:2048 lds
    ds_read_b64_tr_b16 v[52:53], v5 offset:4096
    v_mfma_f32_16x16x32_bf16 v[152:155], v[40:43], v[68:71], v[152:155]
    buffer_load_dwordx4 v15, s[12:15], s57 offen offset:3072 lds
    ds_read_b64_tr_b16 v[54:55], v5 offset:4608
    v_mfma_f32_16x16x32_bf16 v[148:151], v[36:39], v[68:71], v[148:151]
    ds_read_b64_tr_b16 v[56:57], v6 offset:4096
    v_mfma_f32_16x16x32_bf16 v[144:147], v[32:35], v[68:71], v[144:147]
    ds_read_b64_tr_b16 v[58:59], v6 offset:4608
    v_mfma_f32_16x16x32_bf16 v[160:163], v[32:35], v[72:75], v[160:163]
    ds_read_b64_tr_b16 v[60:61], v7 offset:4096
    v_mfma_f32_16x16x32_bf16 v[164:167], v[36:39], v[72:75], v[164:167]
    ds_read_b64_tr_b16 v[62:63], v7 offset:4608
    v_mfma_f32_16x16x32_bf16 v[168:171], v[40:43], v[72:75], v[168:171]
    ds_read_b128 v[96:99], v3 offset:16384
    v_mfma_f32_16x16x32_bf16 v[172:175], v[44:47], v[72:75], v[172:175]
    ds_read_b128 v[100:103], v3 offset:18432
    v_mfma_f32_16x16x32_bf16 v[188:191], v[44:47], v[76:79], v[188:191]
    ds_read_b128 v[104:107], v3 offset:20480
    v_mfma_f32_16x16x32_bf16 v[184:187], v[40:43], v[76:79], v[184:187]
    ds_read_b128 v[108:111], v3 offset:22528
    v_mfma_f32_16x16x32_bf16 v[180:183], v[36:39], v[76:79], v[180:183]
    ds_read_b128 v[112:115], v3 offset:24576
    v_mfma_f32_16x16x32_bf16 v[176:179], v[32:35], v[76:79], v[176:179]
    ds_read_b128 v[116:119], v3 offset:26624
    v_mfma_f32_16x16x32_bf16 v[192:195], v[32:35], v[80:83], v[192:195]
    ds_read_b128 v[120:123], v3 offset:28672
    v_mfma_f32_16x16x32_bf16 v[196:199], v[36:39], v[80:83], v[196:199]
    ds_read_b128 v[124:127], v3 offset:30720
    v_mfma_f32_16x16x32_bf16 v[200:203], v[40:43], v[80:83], v[200:203]
    v_mfma_f32_16x16x32_bf16 v[204:207], v[44:47], v[80:83], v[204:207]
    v_mfma_f32_16x16x32_bf16 v[220:223], v[44:47], v[84:87], v[220:223]
    v_mfma_f32_16x16x32_bf16 v[216:219], v[40:43], v[84:87], v[216:219]
    v_mfma_f32_16x16x32_bf16 v[212:215], v[36:39], v[84:87], v[212:215]
    v_mfma_f32_16x16x32_bf16 v[208:211], v[32:35], v[84:87], v[208:211]
    v_mfma_f32_16x16x32_bf16 v[224:227], v[32:35], v[88:91], v[224:227]
    v_mfma_f32_16x16x32_bf16 v[228:231], v[36:39], v[88:91], v[228:231]
    v_mfma_f32_16x16x32_bf16 v[232:235], v[40:43], v[88:91], v[232:235]
    v_mfma_f32_16x16x32_bf16 v[236:239], v[44:47], v[88:91], v[236:239]
    v_mfma_f32_16x16x32_bf16 v[252:255], v[44:47], v[92:95], v[252:255]
    v_mfma_f32_16x16x32_bf16 v[248:251], v[40:43], v[92:95], v[248:251]
    v_mfma_f32_16x16x32_bf16 v[244:247], v[36:39], v[92:95], v[244:247]
    v_mfma_f32_16x16x32_bf16 v[240:243], v[32:35], v[92:95], v[240:243]
    s_waitcnt lgkmcnt(0)
    s_waitcnt vmcnt(4)
    s_barrier
    v_mfma_f32_16x16x32_bf16 v[128:131], v[48:51], v[96:99], v[128:131]
    s_add_u32 m0, s37, 4096
    v_mfma_f32_16x16x32_bf16 v[132:135], v[52:55], v[96:99], v[132:135]
    s_add_u32 s57, s35, 2293760
    v_mfma_f32_16x16x32_bf16 v[136:139], v[56:59], v[96:99], v[136:139]
    buffer_load_dwordx4 v12, s[12:15], s57 offen offset:0 lds
    ds_read_b64_tr_b16 v[32:33], v4 offset:8192
    v_mfma_f32_16x16x32_bf16 v[140:143], v[60:63], v[96:99], v[140:143]
    buffer_load_dwordx4 v13, s[12:15], s57 offen offset:1024 lds
    ds_read_b64_tr_b16 v[34:35], v4 offset:8704
    v_mfma_f32_16x16x32_bf16 v[156:159], v[60:63], v[100:103], v[156:159]
    buffer_load_dwordx4 v14, s[12:15], s57 offen offset:2048 lds
    ds_read_b64_tr_b16 v[36:37], v5 offset:8192
    v_mfma_f32_16x16x32_bf16 v[152:155], v[56:59], v[100:103], v[152:155]
    buffer_load_dwordx4 v15, s[12:15], s57 offen offset:3072 lds
    ds_read_b64_tr_b16 v[38:39], v5 offset:8704
    v_mfma_f32_16x16x32_bf16 v[148:151], v[52:55], v[100:103], v[148:151]
    s_add_u32 m0, s36, 16384
    ds_read_b64_tr_b16 v[40:41], v6 offset:8192
    v_mfma_f32_16x16x32_bf16 v[144:147], v[48:51], v[100:103], v[144:147]
    s_add_u32 s30, s34, 640
    ds_read_b64_tr_b16 v[42:43], v6 offset:8704
    v_mfma_f32_16x16x32_bf16 v[160:163], v[48:51], v[104:107], v[160:163]
    buffer_load_dwordx4 v8, s[8:11], s30 offen offset:0 lds
    ds_read_b64_tr_b16 v[44:45], v7 offset:8192
    v_mfma_f32_16x16x32_bf16 v[164:167], v[52:55], v[104:107], v[164:167]
    buffer_load_dwordx4 v9, s[8:11], s30 offen offset:1024 lds
    ds_read_b64_tr_b16 v[46:47], v7 offset:8704
    v_mfma_f32_16x16x32_bf16 v[168:171], v[56:59], v[104:107], v[168:171]
    buffer_load_dwordx4 v10, s[8:11], s30 offen offset:2048 lds
    ds_read_b128 v[64:67], v2 offset:0
    v_mfma_f32_16x16x32_bf16 v[172:175], v[60:63], v[104:107], v[172:175]
    buffer_load_dwordx4 v11, s[8:11], s30 offen offset:3072 lds
    ds_read_b128 v[68:71], v2 offset:2048
    v_mfma_f32_16x16x32_bf16 v[188:191], v[60:63], v[108:111], v[188:191]
    s_mul_i32 s32, s68, 2048
    ds_read_b128 v[72:75], v2 offset:4096
    v_mfma_f32_16x16x32_bf16 v[184:187], v[56:59], v[108:111], v[184:187]
    s_add_u32 s32, s32, 5505024
    ds_read_b128 v[76:79], v2 offset:6144
    v_mfma_f32_16x16x32_bf16 v[180:183], v[52:55], v[108:111], v[180:183]
    buffer_load_dword v16, v23, s[12:15], s32 offen
    ds_read_b128 v[80:83], v2 offset:8192
    v_mfma_f32_16x16x32_bf16 v[176:179], v[48:51], v[108:111], v[176:179]
    ds_read_b128 v[84:87], v2 offset:10240
    v_mfma_f32_16x16x32_bf16 v[192:195], v[48:51], v[112:115], v[192:195]
    ds_read_b128 v[88:91], v2 offset:12288
    v_mfma_f32_16x16x32_bf16 v[196:199], v[52:55], v[112:115], v[196:199]
    ds_read_b128 v[92:95], v2 offset:14336
    v_mfma_f32_16x16x32_bf16 v[200:203], v[56:59], v[112:115], v[200:203]
    v_mfma_f32_16x16x32_bf16 v[204:207], v[60:63], v[112:115], v[204:207]
    v_mfma_f32_16x16x32_bf16 v[220:223], v[60:63], v[116:119], v[220:223]
    v_mfma_f32_16x16x32_bf16 v[216:219], v[56:59], v[116:119], v[216:219]
    v_mfma_f32_16x16x32_bf16 v[212:215], v[52:55], v[116:119], v[212:215]
    v_mfma_f32_16x16x32_bf16 v[208:211], v[48:51], v[116:119], v[208:211]
    v_mfma_f32_16x16x32_bf16 v[224:227], v[48:51], v[120:123], v[224:227]
    v_mfma_f32_16x16x32_bf16 v[228:231], v[52:55], v[120:123], v[228:231]
    v_mfma_f32_16x16x32_bf16 v[232:235], v[56:59], v[120:123], v[232:235]
    v_mfma_f32_16x16x32_bf16 v[236:239], v[60:63], v[120:123], v[236:239]
    v_mfma_f32_16x16x32_bf16 v[252:255], v[60:63], v[124:127], v[252:255]
    v_mfma_f32_16x16x32_bf16 v[248:251], v[56:59], v[124:127], v[248:251]
    v_mfma_f32_16x16x32_bf16 v[244:247], v[52:55], v[124:127], v[244:247]
    v_mfma_f32_16x16x32_bf16 v[240:243], v[48:51], v[124:127], v[240:243]
    s_waitcnt lgkmcnt(0)
    s_waitcnt vmcnt(9)
    v_mfma_f32_16x16x32_bf16 v[128:131], v[32:35], v[64:67], v[128:131]
    s_add_u32 m0, s37, 8192
    v_mfma_f32_16x16x32_bf16 v[132:135], v[36:39], v[64:67], v[132:135]
    s_add_u32 s57, s35, 2523136
    v_mfma_f32_16x16x32_bf16 v[136:139], v[40:43], v[64:67], v[136:139]
    buffer_load_dwordx4 v12, s[12:15], s57 offen offset:0 lds
    ds_read_b64_tr_b16 v[48:49], v4 offset:0
    v_mfma_f32_16x16x32_bf16 v[140:143], v[44:47], v[64:67], v[140:143]
    buffer_load_dwordx4 v13, s[12:15], s57 offen offset:1024 lds
    ds_read_b64_tr_b16 v[50:51], v4 offset:512
    v_mfma_f32_16x16x32_bf16 v[156:159], v[44:47], v[68:71], v[156:159]
    buffer_load_dwordx4 v14, s[12:15], s57 offen offset:2048 lds
    ds_read_b64_tr_b16 v[52:53], v5 offset:0
    v_mfma_f32_16x16x32_bf16 v[152:155], v[40:43], v[68:71], v[152:155]
    buffer_load_dwordx4 v15, s[12:15], s57 offen offset:3072 lds
    ds_read_b64_tr_b16 v[54:55], v5 offset:512
    v_mfma_f32_16x16x32_bf16 v[148:151], v[36:39], v[68:71], v[148:151]
    ds_read_b64_tr_b16 v[56:57], v6 offset:0
    v_mfma_f32_16x16x32_bf16 v[144:147], v[32:35], v[68:71], v[144:147]
    ds_read_b64_tr_b16 v[58:59], v6 offset:512
    v_mfma_f32_16x16x32_bf16 v[160:163], v[32:35], v[72:75], v[160:163]
    ds_read_b64_tr_b16 v[60:61], v7 offset:0
    v_mfma_f32_16x16x32_bf16 v[164:167], v[36:39], v[72:75], v[164:167]
    ds_read_b64_tr_b16 v[62:63], v7 offset:512
    v_mfma_f32_16x16x32_bf16 v[168:171], v[40:43], v[72:75], v[168:171]
    ds_read_b128 v[96:99], v3 offset:0
    v_mfma_f32_16x16x32_bf16 v[172:175], v[44:47], v[72:75], v[172:175]
    ds_read_b128 v[100:103], v3 offset:2048
    v_mfma_f32_16x16x32_bf16 v[188:191], v[44:47], v[76:79], v[188:191]
    ds_read_b128 v[104:107], v3 offset:4096
    v_mfma_f32_16x16x32_bf16 v[184:187], v[40:43], v[76:79], v[184:187]
    ds_read_b128 v[108:111], v3 offset:6144
    v_mfma_f32_16x16x32_bf16 v[180:183], v[36:39], v[76:79], v[180:183]
    ds_read_b128 v[112:115], v3 offset:8192
    v_mfma_f32_16x16x32_bf16 v[176:179], v[32:35], v[76:79], v[176:179]
    ds_read_b128 v[116:119], v3 offset:10240
    v_mfma_f32_16x16x32_bf16 v[192:195], v[32:35], v[80:83], v[192:195]
    ds_read_b128 v[120:123], v3 offset:12288
    v_mfma_f32_16x16x32_bf16 v[196:199], v[36:39], v[80:83], v[196:199]
    ds_read_b128 v[124:127], v3 offset:14336
    v_mfma_f32_16x16x32_bf16 v[200:203], v[40:43], v[80:83], v[200:203]
    v_mfma_f32_16x16x32_bf16 v[204:207], v[44:47], v[80:83], v[204:207]
    v_mfma_f32_16x16x32_bf16 v[220:223], v[44:47], v[84:87], v[220:223]
    v_mfma_f32_16x16x32_bf16 v[216:219], v[40:43], v[84:87], v[216:219]
    v_mfma_f32_16x16x32_bf16 v[212:215], v[36:39], v[84:87], v[212:215]
    v_mfma_f32_16x16x32_bf16 v[208:211], v[32:35], v[84:87], v[208:211]
    v_mfma_f32_16x16x32_bf16 v[224:227], v[32:35], v[88:91], v[224:227]
    v_mfma_f32_16x16x32_bf16 v[228:231], v[36:39], v[88:91], v[228:231]
    v_mfma_f32_16x16x32_bf16 v[232:235], v[40:43], v[88:91], v[232:235]
    v_mfma_f32_16x16x32_bf16 v[236:239], v[44:47], v[88:91], v[236:239]
    v_mfma_f32_16x16x32_bf16 v[252:255], v[44:47], v[92:95], v[252:255]
    v_mfma_f32_16x16x32_bf16 v[248:251], v[40:43], v[92:95], v[248:251]
    v_mfma_f32_16x16x32_bf16 v[244:247], v[36:39], v[92:95], v[244:247]
    v_mfma_f32_16x16x32_bf16 v[240:243], v[32:35], v[92:95], v[240:243]
    s_waitcnt lgkmcnt(0)
    s_waitcnt vmcnt(5)
    s_barrier
    v_mfma_f32_16x16x32_bf16 v[128:131], v[48:51], v[96:99], v[128:131]
    s_add_u32 m0, s37, 0
    v_mfma_f32_16x16x32_bf16 v[132:135], v[52:55], v[96:99], v[132:135]
    s_add_u32 s57, s35, 2752512
    v_mfma_f32_16x16x32_bf16 v[136:139], v[56:59], v[96:99], v[136:139]
    buffer_load_dwordx4 v12, s[12:15], s57 offen offset:0 lds
    ds_read_b64_tr_b16 v[32:33], v4 offset:4096
    v_mfma_f32_16x16x32_bf16 v[140:143], v[60:63], v[96:99], v[140:143]
    buffer_load_dwordx4 v13, s[12:15], s57 offen offset:1024 lds
    ds_read_b64_tr_b16 v[34:35], v4 offset:4608
    v_mfma_f32_16x16x32_bf16 v[156:159], v[60:63], v[100:103], v[156:159]
    buffer_load_dwordx4 v14, s[12:15], s57 offen offset:2048 lds
    ds_read_b64_tr_b16 v[36:37], v5 offset:4096
    v_mfma_f32_16x16x32_bf16 v[152:155], v[56:59], v[100:103], v[152:155]
    buffer_load_dwordx4 v15, s[12:15], s57 offen offset:3072 lds
    ds_read_b64_tr_b16 v[38:39], v5 offset:4608
    v_mfma_f32_16x16x32_bf16 v[148:151], v[52:55], v[100:103], v[148:151]
    s_add_u32 m0, s36, 0
    ds_read_b64_tr_b16 v[40:41], v6 offset:4096
    v_mfma_f32_16x16x32_bf16 v[144:147], v[48:51], v[100:103], v[144:147]
    s_add_u32 s30, s34, 768
    ds_read_b64_tr_b16 v[42:43], v6 offset:4608
    v_mfma_f32_16x16x32_bf16 v[160:163], v[48:51], v[104:107], v[160:163]
    buffer_load_dwordx4 v8, s[8:11], s30 offen offset:0 lds
    ds_read_b64_tr_b16 v[44:45], v7 offset:4096
    v_mfma_f32_16x16x32_bf16 v[164:167], v[52:55], v[104:107], v[164:167]
    buffer_load_dwordx4 v9, s[8:11], s30 offen offset:1024 lds
    ds_read_b64_tr_b16 v[46:47], v7 offset:4608
    v_mfma_f32_16x16x32_bf16 v[168:171], v[56:59], v[104:107], v[168:171]
    buffer_load_dwordx4 v10, s[8:11], s30 offen offset:2048 lds
    ds_read_b128 v[64:67], v2 offset:16384
    v_mfma_f32_16x16x32_bf16 v[172:175], v[60:63], v[104:107], v[172:175]
    buffer_load_dwordx4 v11, s[8:11], s30 offen offset:3072 lds
    ds_read_b128 v[68:71], v2 offset:18432
    v_mfma_f32_16x16x32_bf16 v[188:191], v[60:63], v[108:111], v[188:191]
    ds_read_b128 v[72:75], v2 offset:20480
    v_mfma_f32_16x16x32_bf16 v[184:187], v[56:59], v[108:111], v[184:187]
    ds_read_b128 v[76:79], v2 offset:22528
    v_mfma_f32_16x16x32_bf16 v[180:183], v[52:55], v[108:111], v[180:183]
    ds_read_b128 v[80:83], v2 offset:24576
    v_mfma_f32_16x16x32_bf16 v[176:179], v[48:51], v[108:111], v[176:179]
    ds_read_b128 v[84:87], v2 offset:26624
    v_mfma_f32_16x16x32_bf16 v[192:195], v[48:51], v[112:115], v[192:195]
    ds_read_b128 v[88:91], v2 offset:28672
    v_mfma_f32_16x16x32_bf16 v[196:199], v[52:55], v[112:115], v[196:199]
    ds_read_b128 v[92:95], v2 offset:30720
    v_mfma_f32_16x16x32_bf16 v[200:203], v[56:59], v[112:115], v[200:203]
    v_mfma_f32_16x16x32_bf16 v[204:207], v[60:63], v[112:115], v[204:207]
    v_mfma_f32_16x16x32_bf16 v[220:223], v[60:63], v[116:119], v[220:223]
    v_mfma_f32_16x16x32_bf16 v[216:219], v[56:59], v[116:119], v[216:219]
    v_mfma_f32_16x16x32_bf16 v[212:215], v[52:55], v[116:119], v[212:215]
    v_mfma_f32_16x16x32_bf16 v[208:211], v[48:51], v[116:119], v[208:211]
    v_mfma_f32_16x16x32_bf16 v[224:227], v[48:51], v[120:123], v[224:227]
    v_mfma_f32_16x16x32_bf16 v[228:231], v[52:55], v[120:123], v[228:231]
    v_mfma_f32_16x16x32_bf16 v[232:235], v[56:59], v[120:123], v[232:235]
    v_mfma_f32_16x16x32_bf16 v[236:239], v[60:63], v[120:123], v[236:239]
    v_mfma_f32_16x16x32_bf16 v[252:255], v[60:63], v[124:127], v[252:255]
    v_mfma_f32_16x16x32_bf16 v[248:251], v[56:59], v[124:127], v[248:251]
    v_mfma_f32_16x16x32_bf16 v[244:247], v[52:55], v[124:127], v[244:247]
    v_mfma_f32_16x16x32_bf16 v[240:243], v[48:51], v[124:127], v[240:243]
    s_waitcnt lgkmcnt(0)
    s_waitcnt vmcnt(8)
    v_mfma_f32_16x16x32_bf16 v[128:131], v[32:35], v[64:67], v[128:131]
    s_add_u32 m0, s37, 4096
    v_mfma_f32_16x16x32_bf16 v[132:135], v[36:39], v[64:67], v[132:135]
    s_add_u32 s57, s35, 2981888
    v_mfma_f32_16x16x32_bf16 v[136:139], v[40:43], v[64:67], v[136:139]
    buffer_load_dwordx4 v12, s[12:15], s57 offen offset:0 lds
    ds_read_b64_tr_b16 v[48:49], v4 offset:8192
    v_mfma_f32_16x16x32_bf16 v[140:143], v[44:47], v[64:67], v[140:143]
    buffer_load_dwordx4 v13, s[12:15], s57 offen offset:1024 lds
    ds_read_b64_tr_b16 v[50:51], v4 offset:8704
    v_mfma_f32_16x16x32_bf16 v[156:159], v[44:47], v[68:71], v[156:159]
    buffer_load_dwordx4 v14, s[12:15], s57 offen offset:2048 lds
    ds_read_b64_tr_b16 v[52:53], v5 offset:8192
    v_mfma_f32_16x16x32_bf16 v[152:155], v[40:43], v[68:71], v[152:155]
    buffer_load_dwordx4 v15, s[12:15], s57 offen offset:3072 lds
    ds_read_b64_tr_b16 v[54:55], v5 offset:8704
    v_mfma_f32_16x16x32_bf16 v[148:151], v[36:39], v[68:71], v[148:151]
    ds_read_b64_tr_b16 v[56:57], v6 offset:8192
    v_mfma_f32_16x16x32_bf16 v[144:147], v[32:35], v[68:71], v[144:147]
    ds_read_b64_tr_b16 v[58:59], v6 offset:8704
    v_mfma_f32_16x16x32_bf16 v[160:163], v[32:35], v[72:75], v[160:163]
    ds_read_b64_tr_b16 v[60:61], v7 offset:8192
    v_mfma_f32_16x16x32_bf16 v[164:167], v[36:39], v[72:75], v[164:167]
    ds_read_b64_tr_b16 v[62:63], v7 offset:8704
    v_mfma_f32_16x16x32_bf16 v[168:171], v[40:43], v[72:75], v[168:171]
    ds_read_b128 v[96:99], v3 offset:16384
    v_mfma_f32_16x16x32_bf16 v[172:175], v[44:47], v[72:75], v[172:175]
    ds_read_b128 v[100:103], v3 offset:18432
    v_mfma_f32_16x16x32_bf16 v[188:191], v[44:47], v[76:79], v[188:191]
    ds_read_b128 v[104:107], v3 offset:20480
    v_mfma_f32_16x16x32_bf16 v[184:187], v[40:43], v[76:79], v[184:187]
    ds_read_b128 v[108:111], v3 offset:22528
    v_mfma_f32_16x16x32_bf16 v[180:183], v[36:39], v[76:79], v[180:183]
    ds_read_b128 v[112:115], v3 offset:24576
    v_mfma_f32_16x16x32_bf16 v[176:179], v[32:35], v[76:79], v[176:179]
    ds_read_b128 v[116:119], v3 offset:26624
    v_mfma_f32_16x16x32_bf16 v[192:195], v[32:35], v[80:83], v[192:195]
    ds_read_b128 v[120:123], v3 offset:28672
    v_mfma_f32_16x16x32_bf16 v[196:199], v[36:39], v[80:83], v[196:199]
    ds_read_b128 v[124:127], v3 offset:30720
    v_mfma_f32_16x16x32_bf16 v[200:203], v[40:43], v[80:83], v[200:203]
    v_mfma_f32_16x16x32_bf16 v[204:207], v[44:47], v[80:83], v[204:207]
    v_mfma_f32_16x16x32_bf16 v[220:223], v[44:47], v[84:87], v[220:223]
    v_mfma_f32_16x16x32_bf16 v[216:219], v[40:43], v[84:87], v[216:219]
    v_mfma_f32_16x16x32_bf16 v[212:215], v[36:39], v[84:87], v[212:215]
    v_mfma_f32_16x16x32_bf16 v[208:211], v[32:35], v[84:87], v[208:211]
    v_mfma_f32_16x16x32_bf16 v[224:227], v[32:35], v[88:91], v[224:227]
    v_mfma_f32_16x16x32_bf16 v[228:231], v[36:39], v[88:91], v[228:231]
    v_mfma_f32_16x16x32_bf16 v[232:235], v[40:43], v[88:91], v[232:235]
    v_mfma_f32_16x16x32_bf16 v[236:239], v[44:47], v[88:91], v[236:239]
    v_mfma_f32_16x16x32_bf16 v[252:255], v[44:47], v[92:95], v[252:255]
    v_mfma_f32_16x16x32_bf16 v[248:251], v[40:43], v[92:95], v[248:251]
    v_mfma_f32_16x16x32_bf16 v[244:247], v[36:39], v[92:95], v[244:247]
    v_mfma_f32_16x16x32_bf16 v[240:243], v[32:35], v[92:95], v[240:243]
    s_waitcnt lgkmcnt(0)
    s_waitcnt vmcnt(4)
    s_barrier
    v_mfma_f32_16x16x32_bf16 v[128:131], v[48:51], v[96:99], v[128:131]
    s_add_u32 m0, s37, 8192
    v_mfma_f32_16x16x32_bf16 v[132:135], v[52:55], v[96:99], v[132:135]
    s_add_u32 s57, s35, 3211264
    v_mfma_f32_16x16x32_bf16 v[136:139], v[56:59], v[96:99], v[136:139]
    buffer_load_dwordx4 v12, s[12:15], s57 offen offset:0 lds
    ds_read_b64_tr_b16 v[32:33], v4 offset:0
    v_mfma_f32_16x16x32_bf16 v[140:143], v[60:63], v[96:99], v[140:143]
    buffer_load_dwordx4 v13, s[12:15], s57 offen offset:1024 lds
    ds_read_b64_tr_b16 v[34:35], v4 offset:512
    v_mfma_f32_16x16x32_bf16 v[156:159], v[60:63], v[100:103], v[156:159]
    buffer_load_dwordx4 v14, s[12:15], s57 offen offset:2048 lds
    ds_read_b64_tr_b16 v[36:37], v5 offset:0
    v_mfma_f32_16x16x32_bf16 v[152:155], v[56:59], v[100:103], v[152:155]
    buffer_load_dwordx4 v15, s[12:15], s57 offen offset:3072 lds
    ds_read_b64_tr_b16 v[38:39], v5 offset:512
    v_mfma_f32_16x16x32_bf16 v[148:151], v[52:55], v[100:103], v[148:151]
    s_add_u32 m0, s36, 16384
    ds_read_b64_tr_b16 v[40:41], v6 offset:0
    v_mfma_f32_16x16x32_bf16 v[144:147], v[48:51], v[100:103], v[144:147]
    s_add_u32 s30, s34, 896
    ds_read_b64_tr_b16 v[42:43], v6 offset:512
    v_mfma_f32_16x16x32_bf16 v[160:163], v[48:51], v[104:107], v[160:163]
    buffer_load_dwordx4 v8, s[8:11], s30 offen offset:0 lds
    ds_read_b64_tr_b16 v[44:45], v7 offset:0
    v_mfma_f32_16x16x32_bf16 v[164:167], v[52:55], v[104:107], v[164:167]
    buffer_load_dwordx4 v9, s[8:11], s30 offen offset:1024 lds
    ds_read_b64_tr_b16 v[46:47], v7 offset:512
    v_mfma_f32_16x16x32_bf16 v[168:171], v[56:59], v[104:107], v[168:171]
    buffer_load_dwordx4 v10, s[8:11], s30 offen offset:2048 lds
    ds_read_b128 v[64:67], v2 offset:0
    v_mfma_f32_16x16x32_bf16 v[172:175], v[60:63], v[104:107], v[172:175]
    buffer_load_dwordx4 v11, s[8:11], s30 offen offset:3072 lds
    ds_read_b128 v[68:71], v2 offset:2048
    v_mfma_f32_16x16x32_bf16 v[188:191], v[60:63], v[108:111], v[188:191]
    ds_read_b128 v[72:75], v2 offset:4096
    v_mfma_f32_16x16x32_bf16 v[184:187], v[56:59], v[108:111], v[184:187]
    ds_read_b128 v[76:79], v2 offset:6144
    v_mfma_f32_16x16x32_bf16 v[180:183], v[52:55], v[108:111], v[180:183]
    ds_read_b128 v[80:83], v2 offset:8192
    v_mfma_f32_16x16x32_bf16 v[176:179], v[48:51], v[108:111], v[176:179]
    ds_read_b128 v[84:87], v2 offset:10240
    v_mfma_f32_16x16x32_bf16 v[192:195], v[48:51], v[112:115], v[192:195]
    ds_read_b128 v[88:91], v2 offset:12288
    v_mfma_f32_16x16x32_bf16 v[196:199], v[52:55], v[112:115], v[196:199]
    ds_read_b128 v[92:95], v2 offset:14336
    v_mfma_f32_16x16x32_bf16 v[200:203], v[56:59], v[112:115], v[200:203]
    v_mfma_f32_16x16x32_bf16 v[204:207], v[60:63], v[112:115], v[204:207]
    v_mfma_f32_16x16x32_bf16 v[220:223], v[60:63], v[116:119], v[220:223]
    v_mfma_f32_16x16x32_bf16 v[216:219], v[56:59], v[116:119], v[216:219]
    v_mfma_f32_16x16x32_bf16 v[212:215], v[52:55], v[116:119], v[212:215]
    v_mfma_f32_16x16x32_bf16 v[208:211], v[48:51], v[116:119], v[208:211]
    v_mfma_f32_16x16x32_bf16 v[224:227], v[48:51], v[120:123], v[224:227]
    v_mfma_f32_16x16x32_bf16 v[228:231], v[52:55], v[120:123], v[228:231]
    v_mfma_f32_16x16x32_bf16 v[232:235], v[56:59], v[120:123], v[232:235]
    v_mfma_f32_16x16x32_bf16 v[236:239], v[60:63], v[120:123], v[236:239]
    v_mfma_f32_16x16x32_bf16 v[252:255], v[60:63], v[124:127], v[252:255]
    v_mfma_f32_16x16x32_bf16 v[248:251], v[56:59], v[124:127], v[248:251]
    v_mfma_f32_16x16x32_bf16 v[244:247], v[52:55], v[124:127], v[244:247]
    v_mfma_f32_16x16x32_bf16 v[240:243], v[48:51], v[124:127], v[240:243]
    s_waitcnt lgkmcnt(0)
    s_waitcnt vmcnt(8)
    v_mfma_f32_16x16x32_bf16 v[128:131], v[32:35], v[64:67], v[128:131]
    s_add_u32 m0, s37, 0
    v_mfma_f32_16x16x32_bf16 v[132:135], v[36:39], v[64:67], v[132:135]
    s_add_u32 s57, s35, 3440640
    v_mfma_f32_16x16x32_bf16 v[136:139], v[40:43], v[64:67], v[136:139]
    buffer_load_dwordx4 v12, s[12:15], s57 offen offset:0 lds
    ds_read_b64_tr_b16 v[48:49], v4 offset:4096
    v_mfma_f32_16x16x32_bf16 v[140:143], v[44:47], v[64:67], v[140:143]
    buffer_load_dwordx4 v13, s[12:15], s57 offen offset:1024 lds
    ds_read_b64_tr_b16 v[50:51], v4 offset:4608
    v_mfma_f32_16x16x32_bf16 v[156:159], v[44:47], v[68:71], v[156:159]
    buffer_load_dwordx4 v14, s[12:15], s57 offen offset:2048 lds
    ds_read_b64_tr_b16 v[52:53], v5 offset:4096
    v_mfma_f32_16x16x32_bf16 v[152:155], v[40:43], v[68:71], v[152:155]
    buffer_load_dwordx4 v15, s[12:15], s57 offen offset:3072 lds
    ds_read_b64_tr_b16 v[54:55], v5 offset:4608
    v_mfma_f32_16x16x32_bf16 v[148:151], v[36:39], v[68:71], v[148:151]
    ds_read_b64_tr_b16 v[56:57], v6 offset:4096
    v_mfma_f32_16x16x32_bf16 v[144:147], v[32:35], v[68:71], v[144:147]
    ds_read_b64_tr_b16 v[58:59], v6 offset:4608
    v_mfma_f32_16x16x32_bf16 v[160:163], v[32:35], v[72:75], v[160:163]
    ds_read_b64_tr_b16 v[60:61], v7 offset:4096
    v_mfma_f32_16x16x32_bf16 v[164:167], v[36:39], v[72:75], v[164:167]
    ds_read_b64_tr_b16 v[62:63], v7 offset:4608
    v_mfma_f32_16x16x32_bf16 v[168:171], v[40:43], v[72:75], v[168:171]
    ds_read_b128 v[96:99], v3 offset:0
    v_mfma_f32_16x16x32_bf16 v[172:175], v[44:47], v[72:75], v[172:175]
    ds_read_b128 v[100:103], v3 offset:2048
    v_mfma_f32_16x16x32_bf16 v[188:191], v[44:47], v[76:79], v[188:191]
    ds_read_b128 v[104:107], v3 offset:4096
    v_mfma_f32_16x16x32_bf16 v[184:187], v[40:43], v[76:79], v[184:187]
    ds_read_b128 v[108:111], v3 offset:6144
    v_mfma_f32_16x16x32_bf16 v[180:183], v[36:39], v[76:79], v[180:183]
    ds_read_b128 v[112:115], v3 offset:8192
    v_mfma_f32_16x16x32_bf16 v[176:179], v[32:35], v[76:79], v[176:179]
    ds_read_b128 v[116:119], v3 offset:10240
    v_mfma_f32_16x16x32_bf16 v[192:195], v[32:35], v[80:83], v[192:195]
    ds_read_b128 v[120:123], v3 offset:12288
    v_mfma_f32_16x16x32_bf16 v[196:199], v[36:39], v[80:83], v[196:199]
    ds_read_b128 v[124:127], v3 offset:14336
    v_mfma_f32_16x16x32_bf16 v[200:203], v[40:43], v[80:83], v[200:203]
    v_mfma_f32_16x16x32_bf16 v[204:207], v[44:47], v[80:83], v[204:207]
    v_mfma_f32_16x16x32_bf16 v[220:223], v[44:47], v[84:87], v[220:223]
    v_mfma_f32_16x16x32_bf16 v[216:219], v[40:43], v[84:87], v[216:219]
    v_mfma_f32_16x16x32_bf16 v[212:215], v[36:39], v[84:87], v[212:215]
    v_mfma_f32_16x16x32_bf16 v[208:211], v[32:35], v[84:87], v[208:211]
    v_mfma_f32_16x16x32_bf16 v[224:227], v[32:35], v[88:91], v[224:227]
    v_mfma_f32_16x16x32_bf16 v[228:231], v[36:39], v[88:91], v[228:231]
    v_mfma_f32_16x16x32_bf16 v[232:235], v[40:43], v[88:91], v[232:235]
    v_mfma_f32_16x16x32_bf16 v[236:239], v[44:47], v[88:91], v[236:239]
    v_mfma_f32_16x16x32_bf16 v[252:255], v[44:47], v[92:95], v[252:255]
    v_mfma_f32_16x16x32_bf16 v[248:251], v[40:43], v[92:95], v[248:251]
    v_mfma_f32_16x16x32_bf16 v[244:247], v[36:39], v[92:95], v[244:247]
    v_mfma_f32_16x16x32_bf16 v[240:243], v[32:35], v[92:95], v[240:243]
    s_waitcnt lgkmcnt(0)
    s_waitcnt vmcnt(4)
    s_barrier
    v_mfma_f32_16x16x32_bf16 v[128:131], v[48:51], v[96:99], v[128:131]
    s_add_u32 m0, s37, 4096
    v_mfma_f32_16x16x32_bf16 v[132:135], v[52:55], v[96:99], v[132:135]
    s_add_u32 s57, s35, 3670016
    v_mfma_f32_16x16x32_bf16 v[136:139], v[56:59], v[96:99], v[136:139]
    buffer_load_dwordx4 v12, s[12:15], s57 offen offset:0 lds
    ds_read_b64_tr_b16 v[32:33], v4 offset:8192
    v_mfma_f32_16x16x32_bf16 v[140:143], v[60:63], v[96:99], v[140:143]
    buffer_load_dwordx4 v13, s[12:15], s57 offen offset:1024 lds
    ds_read_b64_tr_b16 v[34:35], v4 offset:8704
    v_mfma_f32_16x16x32_bf16 v[156:159], v[60:63], v[100:103], v[156:159]
    buffer_load_dwordx4 v14, s[12:15], s57 offen offset:2048 lds
    ds_read_b64_tr_b16 v[36:37], v5 offset:8192
    v_mfma_f32_16x16x32_bf16 v[152:155], v[56:59], v[100:103], v[152:155]
    buffer_load_dwordx4 v15, s[12:15], s57 offen offset:3072 lds
    ds_read_b64_tr_b16 v[38:39], v5 offset:8704
    v_mfma_f32_16x16x32_bf16 v[148:151], v[52:55], v[100:103], v[148:151]
    s_add_u32 m0, s36, 0
    ds_read_b64_tr_b16 v[40:41], v6 offset:8192
    v_mfma_f32_16x16x32_bf16 v[144:147], v[48:51], v[100:103], v[144:147]
    s_add_u32 s30, s34, 1024
    ds_read_b64_tr_b16 v[42:43], v6 offset:8704
    v_mfma_f32_16x16x32_bf16 v[160:163], v[48:51], v[104:107], v[160:163]
    buffer_load_dwordx4 v8, s[8:11], s30 offen offset:0 lds
    ds_read_b64_tr_b16 v[44:45], v7 offset:8192
    v_mfma_f32_16x16x32_bf16 v[164:167], v[52:55], v[104:107], v[164:167]
    buffer_load_dwordx4 v9, s[8:11], s30 offen offset:1024 lds
    ds_read_b64_tr_b16 v[46:47], v7 offset:8704
    v_mfma_f32_16x16x32_bf16 v[168:171], v[56:59], v[104:107], v[168:171]
    buffer_load_dwordx4 v10, s[8:11], s30 offen offset:2048 lds
    ds_read_b128 v[64:67], v2 offset:16384
    v_mfma_f32_16x16x32_bf16 v[172:175], v[60:63], v[104:107], v[172:175]
    buffer_load_dwordx4 v11, s[8:11], s30 offen offset:3072 lds
    ds_read_b128 v[68:71], v2 offset:18432
    v_mfma_f32_16x16x32_bf16 v[188:191], v[60:63], v[108:111], v[188:191]
    ds_read_b128 v[72:75], v2 offset:20480
    v_mfma_f32_16x16x32_bf16 v[184:187], v[56:59], v[108:111], v[184:187]
    ds_read_b128 v[76:79], v2 offset:22528
    v_mfma_f32_16x16x32_bf16 v[180:183], v[52:55], v[108:111], v[180:183]
    ds_read_b128 v[80:83], v2 offset:24576
    v_mfma_f32_16x16x32_bf16 v[176:179], v[48:51], v[108:111], v[176:179]
    ds_read_b128 v[84:87], v2 offset:26624
    v_mfma_f32_16x16x32_bf16 v[192:195], v[48:51], v[112:115], v[192:195]
    ds_read_b128 v[88:91], v2 offset:28672
    v_mfma_f32_16x16x32_bf16 v[196:199], v[52:55], v[112:115], v[196:199]
    ds_read_b128 v[92:95], v2 offset:30720
    v_mfma_f32_16x16x32_bf16 v[200:203], v[56:59], v[112:115], v[200:203]
    v_mfma_f32_16x16x32_bf16 v[204:207], v[60:63], v[112:115], v[204:207]
    v_mfma_f32_16x16x32_bf16 v[220:223], v[60:63], v[116:119], v[220:223]
    v_mfma_f32_16x16x32_bf16 v[216:219], v[56:59], v[116:119], v[216:219]
    v_mfma_f32_16x16x32_bf16 v[212:215], v[52:55], v[116:119], v[212:215]
    v_mfma_f32_16x16x32_bf16 v[208:211], v[48:51], v[116:119], v[208:211]
    v_mfma_f32_16x16x32_bf16 v[224:227], v[48:51], v[120:123], v[224:227]
    v_mfma_f32_16x16x32_bf16 v[228:231], v[52:55], v[120:123], v[228:231]
    v_mfma_f32_16x16x32_bf16 v[232:235], v[56:59], v[120:123], v[232:235]
    v_mfma_f32_16x16x32_bf16 v[236:239], v[60:63], v[120:123], v[236:239]
    v_mfma_f32_16x16x32_bf16 v[252:255], v[60:63], v[124:127], v[252:255]
    v_mfma_f32_16x16x32_bf16 v[248:251], v[56:59], v[124:127], v[248:251]
    v_mfma_f32_16x16x32_bf16 v[244:247], v[52:55], v[124:127], v[244:247]
    v_mfma_f32_16x16x32_bf16 v[240:243], v[48:51], v[124:127], v[240:243]
    s_waitcnt lgkmcnt(0)
    s_waitcnt vmcnt(8)
    v_mfma_f32_16x16x32_bf16 v[128:131], v[32:35], v[64:67], v[128:131]
    s_add_u32 m0, s37, 8192
    v_mfma_f32_16x16x32_bf16 v[132:135], v[36:39], v[64:67], v[132:135]
    s_add_u32 s57, s35, 3899392
    v_mfma_f32_16x16x32_bf16 v[136:139], v[40:43], v[64:67], v[136:139]
    buffer_load_dwordx4 v12, s[12:15], s57 offen offset:0 lds
    ds_read_b64_tr_b16 v[48:49], v4 offset:0
    v_mfma_f32_16x16x32_bf16 v[140:143], v[44:47], v[64:67], v[140:143]
    buffer_load_dwordx4 v13, s[12:15], s57 offen offset:1024 lds
    ds_read_b64_tr_b16 v[50:51], v4 offset:512
    v_mfma_f32_16x16x32_bf16 v[156:159], v[44:47], v[68:71], v[156:159]
    buffer_load_dwordx4 v14, s[12:15], s57 offen offset:2048 lds
    ds_read_b64_tr_b16 v[52:53], v5 offset:0
    v_mfma_f32_16x16x32_bf16 v[152:155], v[40:43], v[68:71], v[152:155]
    buffer_load_dwordx4 v15, s[12:15], s57 offen offset:3072 lds
    ds_read_b64_tr_b16 v[54:55], v5 offset:512
    v_mfma_f32_16x16x32_bf16 v[148:151], v[36:39], v[68:71], v[148:151]
    ds_read_b64_tr_b16 v[56:57], v6 offset:0
    v_mfma_f32_16x16x32_bf16 v[144:147], v[32:35], v[68:71], v[144:147]
    ds_read_b64_tr_b16 v[58:59], v6 offset:512
    v_mfma_f32_16x16x32_bf16 v[160:163], v[32:35], v[72:75], v[160:163]
    ds_read_b64_tr_b16 v[60:61], v7 offset:0
    v_mfma_f32_16x16x32_bf16 v[164:167], v[36:39], v[72:75], v[164:167]
    ds_read_b64_tr_b16 v[62:63], v7 offset:512
    v_mfma_f32_16x16x32_bf16 v[168:171], v[40:43], v[72:75], v[168:171]
    ds_read_b128 v[96:99], v3 offset:16384
    v_mfma_f32_16x16x32_bf16 v[172:175], v[44:47], v[72:75], v[172:175]
    ds_read_b128 v[100:103], v3 offset:18432
    v_mfma_f32_16x16x32_bf16 v[188:191], v[44:47], v[76:79], v[188:191]
    ds_read_b128 v[104:107], v3 offset:20480
    v_mfma_f32_16x16x32_bf16 v[184:187], v[40:43], v[76:79], v[184:187]
    ds_read_b128 v[108:111], v3 offset:22528
    v_mfma_f32_16x16x32_bf16 v[180:183], v[36:39], v[76:79], v[180:183]
    ds_read_b128 v[112:115], v3 offset:24576
    v_mfma_f32_16x16x32_bf16 v[176:179], v[32:35], v[76:79], v[176:179]
    ds_read_b128 v[116:119], v3 offset:26624
    v_mfma_f32_16x16x32_bf16 v[192:195], v[32:35], v[80:83], v[192:195]
    ds_read_b128 v[120:123], v3 offset:28672
    v_mfma_f32_16x16x32_bf16 v[196:199], v[36:39], v[80:83], v[196:199]
    ds_read_b128 v[124:127], v3 offset:30720
    v_mfma_f32_16x16x32_bf16 v[200:203], v[40:43], v[80:83], v[200:203]
    v_mfma_f32_16x16x32_bf16 v[204:207], v[44:47], v[80:83], v[204:207]
    v_mfma_f32_16x16x32_bf16 v[220:223], v[44:47], v[84:87], v[220:223]
    v_mfma_f32_16x16x32_bf16 v[216:219], v[40:43], v[84:87], v[216:219]
    v_mfma_f32_16x16x32_bf16 v[212:215], v[36:39], v[84:87], v[212:215]
    v_mfma_f32_16x16x32_bf16 v[208:211], v[32:35], v[84:87], v[208:211]
    v_mfma_f32_16x16x32_bf16 v[224:227], v[32:35], v[88:91], v[224:227]
    v_mfma_f32_16x16x32_bf16 v[228:231], v[36:39], v[88:91], v[228:231]
    v_mfma_f32_16x16x32_bf16 v[232:235], v[40:43], v[88:91], v[232:235]
    v_mfma_f32_16x16x32_bf16 v[236:239], v[44:47], v[88:91], v[236:239]
    v_mfma_f32_16x16x32_bf16 v[252:255], v[44:47], v[92:95], v[252:255]
    v_mfma_f32_16x16x32_bf16 v[248:251], v[40:43], v[92:95], v[248:251]
    v_mfma_f32_16x16x32_bf16 v[244:247], v[36:39], v[92:95], v[244:247]
    v_mfma_f32_16x16x32_bf16 v[240:243], v[32:35], v[92:95], v[240:243]
    s_waitcnt lgkmcnt(0)
    s_waitcnt vmcnt(4)
    s_barrier
    v_mfma_f32_16x16x32_bf16 v[128:131], v[48:51], v[96:99], v[128:131]
    s_add_u32 m0, s37, 0
    v_mfma_f32_16x16x32_bf16 v[132:135], v[52:55], v[96:99], v[132:135]
    s_add_u32 s57, s35, 4128768
    v_mfma_f32_16x16x32_bf16 v[136:139], v[56:59], v[96:99], v[136:139]
    buffer_load_dwordx4 v12, s[12:15], s57 offen offset:0 lds
    ds_read_b64_tr_b16 v[32:33], v4 offset:4096
    v_mfma_f32_16x16x32_bf16 v[140:143], v[60:63], v[96:99], v[140:143]
    buffer_load_dwordx4 v13, s[12:15], s57 offen offset:1024 lds
    ds_read_b64_tr_b16 v[34:35], v4 offset:4608
    v_mfma_f32_16x16x32_bf16 v[156:159], v[60:63], v[100:103], v[156:159]
    buffer_load_dwordx4 v14, s[12:15], s57 offen offset:2048 lds
    ds_read_b64_tr_b16 v[36:37], v5 offset:4096
    v_mfma_f32_16x16x32_bf16 v[152:155], v[56:59], v[100:103], v[152:155]
    buffer_load_dwordx4 v15, s[12:15], s57 offen offset:3072 lds
    ds_read_b64_tr_b16 v[38:39], v5 offset:4608
    v_mfma_f32_16x16x32_bf16 v[148:151], v[52:55], v[100:103], v[148:151]
    s_add_u32 m0, s36, 16384
    ds_read_b64_tr_b16 v[40:41], v6 offset:4096
    v_mfma_f32_16x16x32_bf16 v[144:147], v[48:51], v[100:103], v[144:147]
    s_add_u32 s30, s34, 1152
    ds_read_b64_tr_b16 v[42:43], v6 offset:4608
    v_mfma_f32_16x16x32_bf16 v[160:163], v[48:51], v[104:107], v[160:163]
    buffer_load_dwordx4 v8, s[8:11], s30 offen offset:0 lds
    ds_read_b64_tr_b16 v[44:45], v7 offset:4096
    v_mfma_f32_16x16x32_bf16 v[164:167], v[52:55], v[104:107], v[164:167]
    buffer_load_dwordx4 v9, s[8:11], s30 offen offset:1024 lds
    ds_read_b64_tr_b16 v[46:47], v7 offset:4608
    v_mfma_f32_16x16x32_bf16 v[168:171], v[56:59], v[104:107], v[168:171]
    buffer_load_dwordx4 v10, s[8:11], s30 offen offset:2048 lds
    ds_read_b128 v[64:67], v2 offset:0
    v_mfma_f32_16x16x32_bf16 v[172:175], v[60:63], v[104:107], v[172:175]
    buffer_load_dwordx4 v11, s[8:11], s30 offen offset:3072 lds
    ds_read_b128 v[68:71], v2 offset:2048
    v_mfma_f32_16x16x32_bf16 v[188:191], v[60:63], v[108:111], v[188:191]
    s_mul_i32 s32, s68, 2048
    ds_read_b128 v[72:75], v2 offset:4096
    v_mfma_f32_16x16x32_bf16 v[184:187], v[56:59], v[108:111], v[184:187]
    buffer_load_dword v16, v23, s[44:47], s32 offen
    ds_read_b128 v[76:79], v2 offset:6144
    v_mfma_f32_16x16x32_bf16 v[180:183], v[52:55], v[108:111], v[180:183]
    ds_read_b128 v[80:83], v2 offset:8192
    v_mfma_f32_16x16x32_bf16 v[176:179], v[48:51], v[108:111], v[176:179]
    ds_read_b128 v[84:87], v2 offset:10240
    v_mfma_f32_16x16x32_bf16 v[192:195], v[48:51], v[112:115], v[192:195]
    ds_read_b128 v[88:91], v2 offset:12288
    v_mfma_f32_16x16x32_bf16 v[196:199], v[52:55], v[112:115], v[196:199]
    ds_read_b128 v[92:95], v2 offset:14336
    v_mfma_f32_16x16x32_bf16 v[200:203], v[56:59], v[112:115], v[200:203]
    v_mfma_f32_16x16x32_bf16 v[204:207], v[60:63], v[112:115], v[204:207]
    v_mfma_f32_16x16x32_bf16 v[220:223], v[60:63], v[116:119], v[220:223]
    v_mfma_f32_16x16x32_bf16 v[216:219], v[56:59], v[116:119], v[216:219]
    v_mfma_f32_16x16x32_bf16 v[212:215], v[52:55], v[116:119], v[212:215]
    v_mfma_f32_16x16x32_bf16 v[208:211], v[48:51], v[116:119], v[208:211]
    v_mfma_f32_16x16x32_bf16 v[224:227], v[48:51], v[120:123], v[224:227]
    v_mfma_f32_16x16x32_bf16 v[228:231], v[52:55], v[120:123], v[228:231]
    v_mfma_f32_16x16x32_bf16 v[232:235], v[56:59], v[120:123], v[232:235]
    v_mfma_f32_16x16x32_bf16 v[236:239], v[60:63], v[120:123], v[236:239]
    v_mfma_f32_16x16x32_bf16 v[252:255], v[60:63], v[124:127], v[252:255]
    v_mfma_f32_16x16x32_bf16 v[248:251], v[56:59], v[124:127], v[248:251]
    v_mfma_f32_16x16x32_bf16 v[244:247], v[52:55], v[124:127], v[244:247]
    v_mfma_f32_16x16x32_bf16 v[240:243], v[48:51], v[124:127], v[240:243]
    s_waitcnt lgkmcnt(0)
    s_waitcnt vmcnt(9)
    v_mfma_f32_16x16x32_bf16 v[128:131], v[32:35], v[64:67], v[128:131]
    s_add_u32 m0, s37, 4096
    v_mfma_f32_16x16x32_bf16 v[132:135], v[36:39], v[64:67], v[132:135]
    s_add_u32 s57, s35, 4358144
    v_mfma_f32_16x16x32_bf16 v[136:139], v[40:43], v[64:67], v[136:139]
    buffer_load_dwordx4 v12, s[12:15], s57 offen offset:0 lds
    ds_read_b64_tr_b16 v[48:49], v4 offset:8192
    v_mfma_f32_16x16x32_bf16 v[140:143], v[44:47], v[64:67], v[140:143]
    buffer_load_dwordx4 v13, s[12:15], s57 offen offset:1024 lds
    ds_read_b64_tr_b16 v[50:51], v4 offset:8704
    v_mfma_f32_16x16x32_bf16 v[156:159], v[44:47], v[68:71], v[156:159]
    buffer_load_dwordx4 v14, s[12:15], s57 offen offset:2048 lds
    ds_read_b64_tr_b16 v[52:53], v5 offset:8192
    v_mfma_f32_16x16x32_bf16 v[152:155], v[40:43], v[68:71], v[152:155]
    buffer_load_dwordx4 v15, s[12:15], s57 offen offset:3072 lds
    ds_read_b64_tr_b16 v[54:55], v5 offset:8704
    v_mfma_f32_16x16x32_bf16 v[148:151], v[36:39], v[68:71], v[148:151]
    ds_read_b64_tr_b16 v[56:57], v6 offset:8192
    v_mfma_f32_16x16x32_bf16 v[144:147], v[32:35], v[68:71], v[144:147]
    ds_read_b64_tr_b16 v[58:59], v6 offset:8704
    v_mfma_f32_16x16x32_bf16 v[160:163], v[32:35], v[72:75], v[160:163]
    ds_read_b64_tr_b16 v[60:61], v7 offset:8192
    v_mfma_f32_16x16x32_bf16 v[164:167], v[36:39], v[72:75], v[164:167]
    ds_read_b64_tr_b16 v[62:63], v7 offset:8704
    v_mfma_f32_16x16x32_bf16 v[168:171], v[40:43], v[72:75], v[168:171]
    ds_read_b128 v[96:99], v3 offset:0
    v_mfma_f32_16x16x32_bf16 v[172:175], v[44:47], v[72:75], v[172:175]
    ds_read_b128 v[100:103], v3 offset:2048
    v_mfma_f32_16x16x32_bf16 v[188:191], v[44:47], v[76:79], v[188:191]
    ds_read_b128 v[104:107], v3 offset:4096
    v_mfma_f32_16x16x32_bf16 v[184:187], v[40:43], v[76:79], v[184:187]
    ds_read_b128 v[108:111], v3 offset:6144
    v_mfma_f32_16x16x32_bf16 v[180:183], v[36:39], v[76:79], v[180:183]
    ds_read_b128 v[112:115], v3 offset:8192
    v_mfma_f32_16x16x32_bf16 v[176:179], v[32:35], v[76:79], v[176:179]
    ds_read_b128 v[116:119], v3 offset:10240
    v_mfma_f32_16x16x32_bf16 v[192:195], v[32:35], v[80:83], v[192:195]
    ds_read_b128 v[120:123], v3 offset:12288
    v_mfma_f32_16x16x32_bf16 v[196:199], v[36:39], v[80:83], v[196:199]
    ds_read_b128 v[124:127], v3 offset:14336
    v_mfma_f32_16x16x32_bf16 v[200:203], v[40:43], v[80:83], v[200:203]
    v_mfma_f32_16x16x32_bf16 v[204:207], v[44:47], v[80:83], v[204:207]
    v_mfma_f32_16x16x32_bf16 v[220:223], v[44:47], v[84:87], v[220:223]
    v_mfma_f32_16x16x32_bf16 v[216:219], v[40:43], v[84:87], v[216:219]
    v_mfma_f32_16x16x32_bf16 v[212:215], v[36:39], v[84:87], v[212:215]
    v_mfma_f32_16x16x32_bf16 v[208:211], v[32:35], v[84:87], v[208:211]
    v_mfma_f32_16x16x32_bf16 v[224:227], v[32:35], v[88:91], v[224:227]
    v_mfma_f32_16x16x32_bf16 v[228:231], v[36:39], v[88:91], v[228:231]
    v_mfma_f32_16x16x32_bf16 v[232:235], v[40:43], v[88:91], v[232:235]
    v_mfma_f32_16x16x32_bf16 v[236:239], v[44:47], v[88:91], v[236:239]
    v_mfma_f32_16x16x32_bf16 v[252:255], v[44:47], v[92:95], v[252:255]
    v_mfma_f32_16x16x32_bf16 v[248:251], v[40:43], v[92:95], v[248:251]
    v_mfma_f32_16x16x32_bf16 v[244:247], v[36:39], v[92:95], v[244:247]
    v_mfma_f32_16x16x32_bf16 v[240:243], v[32:35], v[92:95], v[240:243]
    s_waitcnt lgkmcnt(0)
    s_waitcnt vmcnt(5)
    s_barrier
    v_mfma_f32_16x16x32_bf16 v[128:131], v[48:51], v[96:99], v[128:131]
    s_add_u32 m0, s37, 8192
    v_mfma_f32_16x16x32_bf16 v[132:135], v[52:55], v[96:99], v[132:135]
    s_add_u32 s57, s35, 4587520
    v_mfma_f32_16x16x32_bf16 v[136:139], v[56:59], v[96:99], v[136:139]
    buffer_load_dwordx4 v12, s[12:15], s57 offen offset:0 lds
    ds_read_b64_tr_b16 v[32:33], v4 offset:0
    v_mfma_f32_16x16x32_bf16 v[140:143], v[60:63], v[96:99], v[140:143]
    buffer_load_dwordx4 v13, s[12:15], s57 offen offset:1024 lds
    ds_read_b64_tr_b16 v[34:35], v4 offset:512
    v_mfma_f32_16x16x32_bf16 v[156:159], v[60:63], v[100:103], v[156:159]
    buffer_load_dwordx4 v14, s[12:15], s57 offen offset:2048 lds
    ds_read_b64_tr_b16 v[36:37], v5 offset:0
    v_mfma_f32_16x16x32_bf16 v[152:155], v[56:59], v[100:103], v[152:155]
    buffer_load_dwordx4 v15, s[12:15], s57 offen offset:3072 lds
    ds_read_b64_tr_b16 v[38:39], v5 offset:512
    v_mfma_f32_16x16x32_bf16 v[148:151], v[52:55], v[100:103], v[148:151]
    s_add_u32 m0, s36, 0
    ds_read_b64_tr_b16 v[40:41], v6 offset:0
    v_mfma_f32_16x16x32_bf16 v[144:147], v[48:51], v[100:103], v[144:147]
    s_add_u32 s30, s34, 1280
    ds_read_b64_tr_b16 v[42:43], v6 offset:512
    v_mfma_f32_16x16x32_bf16 v[160:163], v[48:51], v[104:107], v[160:163]
    buffer_load_dwordx4 v8, s[8:11], s30 offen offset:0 lds
    ds_read_b64_tr_b16 v[44:45], v7 offset:0
    v_mfma_f32_16x16x32_bf16 v[164:167], v[52:55], v[104:107], v[164:167]
    buffer_load_dwordx4 v9, s[8:11], s30 offen offset:1024 lds
    ds_read_b64_tr_b16 v[46:47], v7 offset:512
    v_mfma_f32_16x16x32_bf16 v[168:171], v[56:59], v[104:107], v[168:171]
    buffer_load_dwordx4 v10, s[8:11], s30 offen offset:2048 lds
    ds_read_b128 v[64:67], v2 offset:16384
    v_mfma_f32_16x16x32_bf16 v[172:175], v[60:63], v[104:107], v[172:175]
    buffer_load_dwordx4 v11, s[8:11], s30 offen offset:3072 lds
    ds_read_b128 v[68:71], v2 offset:18432
    v_mfma_f32_16x16x32_bf16 v[188:191], v[60:63], v[108:111], v[188:191]
    ds_read_b128 v[72:75], v2 offset:20480
    v_mfma_f32_16x16x32_bf16 v[184:187], v[56:59], v[108:111], v[184:187]
    ds_read_b128 v[76:79], v2 offset:22528
    v_mfma_f32_16x16x32_bf16 v[180:183], v[52:55], v[108:111], v[180:183]
    ds_read_b128 v[80:83], v2 offset:24576
    v_mfma_f32_16x16x32_bf16 v[176:179], v[48:51], v[108:111], v[176:179]
    ds_read_b128 v[84:87], v2 offset:26624
    v_mfma_f32_16x16x32_bf16 v[192:195], v[48:51], v[112:115], v[192:195]
    ds_read_b128 v[88:91], v2 offset:28672
    v_mfma_f32_16x16x32_bf16 v[196:199], v[52:55], v[112:115], v[196:199]
    ds_read_b128 v[92:95], v2 offset:30720
    v_mfma_f32_16x16x32_bf16 v[200:203], v[56:59], v[112:115], v[200:203]
    v_mfma_f32_16x16x32_bf16 v[204:207], v[60:63], v[112:115], v[204:207]
    v_mfma_f32_16x16x32_bf16 v[220:223], v[60:63], v[116:119], v[220:223]
    v_mfma_f32_16x16x32_bf16 v[216:219], v[56:59], v[116:119], v[216:219]
    v_mfma_f32_16x16x32_bf16 v[212:215], v[52:55], v[116:119], v[212:215]
    v_mfma_f32_16x16x32_bf16 v[208:211], v[48:51], v[116:119], v[208:211]
    v_mfma_f32_16x16x32_bf16 v[224:227], v[48:51], v[120:123], v[224:227]
    v_mfma_f32_16x16x32_bf16 v[228:231], v[52:55], v[120:123], v[228:231]
    v_mfma_f32_16x16x32_bf16 v[232:235], v[56:59], v[120:123], v[232:235]
    v_mfma_f32_16x16x32_bf16 v[236:239], v[60:63], v[120:123], v[236:239]
    v_mfma_f32_16x16x32_bf16 v[252:255], v[60:63], v[124:127], v[252:255]
    v_mfma_f32_16x16x32_bf16 v[248:251], v[56:59], v[124:127], v[248:251]
    v_mfma_f32_16x16x32_bf16 v[244:247], v[52:55], v[124:127], v[244:247]
    v_mfma_f32_16x16x32_bf16 v[240:243], v[48:51], v[124:127], v[240:243]
    s_waitcnt lgkmcnt(0)
    s_waitcnt vmcnt(8)
    v_mfma_f32_16x16x32_bf16 v[128:131], v[32:35], v[64:67], v[128:131]
    s_add_u32 m0, s37, 0
    v_mfma_f32_16x16x32_bf16 v[132:135], v[36:39], v[64:67], v[132:135]
    s_add_u32 s57, s35, 4816896
    v_mfma_f32_16x16x32_bf16 v[136:139], v[40:43], v[64:67], v[136:139]
    buffer_load_dwordx4 v12, s[12:15], s57 offen offset:0 lds
    ds_read_b64_tr_b16 v[48:49], v4 offset:4096
    v_mfma_f32_16x16x32_bf16 v[140:143], v[44:47], v[64:67], v[140:143]
    buffer_load_dwordx4 v13, s[12:15], s57 offen offset:1024 lds
    ds_read_b64_tr_b16 v[50:51], v4 offset:4608
    v_mfma_f32_16x16x32_bf16 v[156:159], v[44:47], v[68:71], v[156:159]
    buffer_load_dwordx4 v14, s[12:15], s57 offen offset:2048 lds
    ds_read_b64_tr_b16 v[52:53], v5 offset:4096
    v_mfma_f32_16x16x32_bf16 v[152:155], v[40:43], v[68:71], v[152:155]
    buffer_load_dwordx4 v15, s[12:15], s57 offen offset:3072 lds
    ds_read_b64_tr_b16 v[54:55], v5 offset:4608
    v_mfma_f32_16x16x32_bf16 v[148:151], v[36:39], v[68:71], v[148:151]
    ds_read_b64_tr_b16 v[56:57], v6 offset:4096
    v_mfma_f32_16x16x32_bf16 v[144:147], v[32:35], v[68:71], v[144:147]
    ds_read_b64_tr_b16 v[58:59], v6 offset:4608
    v_mfma_f32_16x16x32_bf16 v[160:163], v[32:35], v[72:75], v[160:163]
    ds_read_b64_tr_b16 v[60:61], v7 offset:4096
    v_mfma_f32_16x16x32_bf16 v[164:167], v[36:39], v[72:75], v[164:167]
    ds_read_b64_tr_b16 v[62:63], v7 offset:4608
    v_mfma_f32_16x16x32_bf16 v[168:171], v[40:43], v[72:75], v[168:171]
    ds_read_b128 v[96:99], v3 offset:16384
    v_mfma_f32_16x16x32_bf16 v[172:175], v[44:47], v[72:75], v[172:175]
    ds_read_b128 v[100:103], v3 offset:18432
    v_mfma_f32_16x16x32_bf16 v[188:191], v[44:47], v[76:79], v[188:191]
    ds_read_b128 v[104:107], v3 offset:20480
    v_mfma_f32_16x16x32_bf16 v[184:187], v[40:43], v[76:79], v[184:187]
    ds_read_b128 v[108:111], v3 offset:22528
    v_mfma_f32_16x16x32_bf16 v[180:183], v[36:39], v[76:79], v[180:183]
    ds_read_b128 v[112:115], v3 offset:24576
    v_mfma_f32_16x16x32_bf16 v[176:179], v[32:35], v[76:79], v[176:179]
    ds_read_b128 v[116:119], v3 offset:26624
    v_mfma_f32_16x16x32_bf16 v[192:195], v[32:35], v[80:83], v[192:195]
    ds_read_b128 v[120:123], v3 offset:28672
    v_mfma_f32_16x16x32_bf16 v[196:199], v[36:39], v[80:83], v[196:199]
    ds_read_b128 v[124:127], v3 offset:30720
    v_mfma_f32_16x16x32_bf16 v[200:203], v[40:43], v[80:83], v[200:203]
    v_mfma_f32_16x16x32_bf16 v[204:207], v[44:47], v[80:83], v[204:207]
    v_mfma_f32_16x16x32_bf16 v[220:223], v[44:47], v[84:87], v[220:223]
    v_mfma_f32_16x16x32_bf16 v[216:219], v[40:43], v[84:87], v[216:219]
    v_mfma_f32_16x16x32_bf16 v[212:215], v[36:39], v[84:87], v[212:215]
    v_mfma_f32_16x16x32_bf16 v[208:211], v[32:35], v[84:87], v[208:211]
    v_mfma_f32_16x16x32_bf16 v[224:227], v[32:35], v[88:91], v[224:227]
    v_mfma_f32_16x16x32_bf16 v[228:231], v[36:39], v[88:91], v[228:231]
    v_mfma_f32_16x16x32_bf16 v[232:235], v[40:43], v[88:91], v[232:235]
    v_mfma_f32_16x16x32_bf16 v[236:239], v[44:47], v[88:91], v[236:239]
    v_mfma_f32_16x16x32_bf16 v[252:255], v[44:47], v[92:95], v[252:255]
    v_mfma_f32_16x16x32_bf16 v[248:251], v[40:43], v[92:95], v[248:251]
    v_mfma_f32_16x16x32_bf16 v[244:247], v[36:39], v[92:95], v[244:247]
    v_mfma_f32_16x16x32_bf16 v[240:243], v[32:35], v[92:95], v[240:243]
    s_waitcnt lgkmcnt(0)
    s_waitcnt vmcnt(4)
    s_barrier
    v_mfma_f32_16x16x32_bf16 v[128:131], v[48:51], v[96:99], v[128:131]
    s_add_u32 m0, s37, 4096
    v_mfma_f32_16x16x32_bf16 v[132:135], v[52:55], v[96:99], v[132:135]
    s_add_u32 s57, s35, 5046272
    v_mfma_f32_16x16x32_bf16 v[136:139], v[56:59], v[96:99], v[136:139]
    buffer_load_dwordx4 v12, s[12:15], s57 offen offset:0 lds
    ds_read_b64_tr_b16 v[32:33], v4 offset:8192
    v_mfma_f32_16x16x32_bf16 v[140:143], v[60:63], v[96:99], v[140:143]
    buffer_load_dwordx4 v13, s[12:15], s57 offen offset:1024 lds
    ds_read_b64_tr_b16 v[34:35], v4 offset:8704
    v_mfma_f32_16x16x32_bf16 v[156:159], v[60:63], v[100:103], v[156:159]
    buffer_load_dwordx4 v14, s[12:15], s57 offen offset:2048 lds
    ds_read_b64_tr_b16 v[36:37], v5 offset:8192
    v_mfma_f32_16x16x32_bf16 v[152:155], v[56:59], v[100:103], v[152:155]
    buffer_load_dwordx4 v15, s[12:15], s57 offen offset:3072 lds
    ds_read_b64_tr_b16 v[38:39], v5 offset:8704
    v_mfma_f32_16x16x32_bf16 v[148:151], v[52:55], v[100:103], v[148:151]
    s_add_u32 m0, s36, 16384
    ds_read_b64_tr_b16 v[40:41], v6 offset:8192
    v_mfma_f32_16x16x32_bf16 v[144:147], v[48:51], v[100:103], v[144:147]
    s_add_u32 s30, s34, 1408
    ds_read_b64_tr_b16 v[42:43], v6 offset:8704
    v_mfma_f32_16x16x32_bf16 v[160:163], v[48:51], v[104:107], v[160:163]
    buffer_load_dwordx4 v8, s[8:11], s30 offen offset:0 lds
    ds_read_b64_tr_b16 v[44:45], v7 offset:8192
    v_mfma_f32_16x16x32_bf16 v[164:167], v[52:55], v[104:107], v[164:167]
    buffer_load_dwordx4 v9, s[8:11], s30 offen offset:1024 lds
    ds_read_b64_tr_b16 v[46:47], v7 offset:8704
    v_mfma_f32_16x16x32_bf16 v[168:171], v[56:59], v[104:107], v[168:171]
    buffer_load_dwordx4 v10, s[8:11], s30 offen offset:2048 lds
    ds_read_b128 v[64:67], v2 offset:0
    v_mfma_f32_16x16x32_bf16 v[172:175], v[60:63], v[104:107], v[172:175]
    buffer_load_dwordx4 v11, s[8:11], s30 offen offset:3072 lds
    ds_read_b128 v[68:71], v2 offset:2048
    v_mfma_f32_16x16x32_bf16 v[188:191], v[60:63], v[108:111], v[188:191]
    s_mul_i32 s32, s68, 2048
    ds_read_b128 v[72:75], v2 offset:4096
    v_mfma_f32_16x16x32_bf16 v[184:187], v[56:59], v[108:111], v[184:187]
    s_add_u32 s32, s32, 1835008
    ds_read_b128 v[76:79], v2 offset:6144
    v_mfma_f32_16x16x32_bf16 v[180:183], v[52:55], v[108:111], v[180:183]
    buffer_load_dword v16, v23, s[44:47], s32 offen
    ds_read_b128 v[80:83], v2 offset:8192
    v_mfma_f32_16x16x32_bf16 v[176:179], v[48:51], v[108:111], v[176:179]
    ds_read_b128 v[84:87], v2 offset:10240
    v_mfma_f32_16x16x32_bf16 v[192:195], v[48:51], v[112:115], v[192:195]
    ds_read_b128 v[88:91], v2 offset:12288
    v_mfma_f32_16x16x32_bf16 v[196:199], v[52:55], v[112:115], v[196:199]
    ds_read_b128 v[92:95], v2 offset:14336
    v_mfma_f32_16x16x32_bf16 v[200:203], v[56:59], v[112:115], v[200:203]
    v_mfma_f32_16x16x32_bf16 v[204:207], v[60:63], v[112:115], v[204:207]
    v_mfma_f32_16x16x32_bf16 v[220:223], v[60:63], v[116:119], v[220:223]
    v_mfma_f32_16x16x32_bf16 v[216:219], v[56:59], v[116:119], v[216:219]
    v_mfma_f32_16x16x32_bf16 v[212:215], v[52:55], v[116:119], v[212:215]
    v_mfma_f32_16x16x32_bf16 v[208:211], v[48:51], v[116:119], v[208:211]
    v_mfma_f32_16x16x32_bf16 v[224:227], v[48:51], v[120:123], v[224:227]
    v_mfma_f32_16x16x32_bf16 v[228:231], v[52:55], v[120:123], v[228:231]
    v_mfma_f32_16x16x32_bf16 v[232:235], v[56:59], v[120:123], v[232:235]
    v_mfma_f32_16x16x32_bf16 v[236:239], v[60:63], v[120:123], v[236:239]
    v_mfma_f32_16x16x32_bf16 v[252:255], v[60:63], v[124:127], v[252:255]
    v_mfma_f32_16x16x32_bf16 v[248:251], v[56:59], v[124:127], v[248:251]
    v_mfma_f32_16x16x32_bf16 v[244:247], v[52:55], v[124:127], v[244:247]
    v_mfma_f32_16x16x32_bf16 v[240:243], v[48:51], v[124:127], v[240:243]
    s_waitcnt lgkmcnt(0)
    s_waitcnt vmcnt(9)
    v_mfma_f32_16x16x32_bf16 v[128:131], v[32:35], v[64:67], v[128:131]
    s_add_u32 m0, s37, 8192
    v_mfma_f32_16x16x32_bf16 v[132:135], v[36:39], v[64:67], v[132:135]
    s_add_u32 s57, s35, 5275648
    v_mfma_f32_16x16x32_bf16 v[136:139], v[40:43], v[64:67], v[136:139]
    buffer_load_dwordx4 v12, s[12:15], s57 offen offset:0 lds
    ds_read_b64_tr_b16 v[48:49], v4 offset:0
    v_mfma_f32_16x16x32_bf16 v[140:143], v[44:47], v[64:67], v[140:143]
    buffer_load_dwordx4 v13, s[12:15], s57 offen offset:1024 lds
    ds_read_b64_tr_b16 v[50:51], v4 offset:512
    v_mfma_f32_16x16x32_bf16 v[156:159], v[44:47], v[68:71], v[156:159]
    buffer_load_dwordx4 v14, s[12:15], s57 offen offset:2048 lds
    ds_read_b64_tr_b16 v[52:53], v5 offset:0
    v_mfma_f32_16x16x32_bf16 v[152:155], v[40:43], v[68:71], v[152:155]
    buffer_load_dwordx4 v15, s[12:15], s57 offen offset:3072 lds
    ds_read_b64_tr_b16 v[54:55], v5 offset:512
    v_mfma_f32_16x16x32_bf16 v[148:151], v[36:39], v[68:71], v[148:151]
    ds_read_b64_tr_b16 v[56:57], v6 offset:0
    v_mfma_f32_16x16x32_bf16 v[144:147], v[32:35], v[68:71], v[144:147]
    ds_read_b64_tr_b16 v[58:59], v6 offset:512
    v_mfma_f32_16x16x32_bf16 v[160:163], v[32:35], v[72:75], v[160:163]
    ds_read_b64_tr_b16 v[60:61], v7 offset:0
    v_mfma_f32_16x16x32_bf16 v[164:167], v[36:39], v[72:75], v[164:167]
    ds_read_b64_tr_b16 v[62:63], v7 offset:512
    v_mfma_f32_16x16x32_bf16 v[168:171], v[40:43], v[72:75], v[168:171]
    ds_read_b128 v[96:99], v3 offset:0
    v_mfma_f32_16x16x32_bf16 v[172:175], v[44:47], v[72:75], v[172:175]
    ds_read_b128 v[100:103], v3 offset:2048
    v_mfma_f32_16x16x32_bf16 v[188:191], v[44:47], v[76:79], v[188:191]
    ds_read_b128 v[104:107], v3 offset:4096
    v_mfma_f32_16x16x32_bf16 v[184:187], v[40:43], v[76:79], v[184:187]
    ds_read_b128 v[108:111], v3 offset:6144
    v_mfma_f32_16x16x32_bf16 v[180:183], v[36:39], v[76:79], v[180:183]
    ds_read_b128 v[112:115], v3 offset:8192
    v_mfma_f32_16x16x32_bf16 v[176:179], v[32:35], v[76:79], v[176:179]
    ds_read_b128 v[116:119], v3 offset:10240
    v_mfma_f32_16x16x32_bf16 v[192:195], v[32:35], v[80:83], v[192:195]
    ds_read_b128 v[120:123], v3 offset:12288
    v_mfma_f32_16x16x32_bf16 v[196:199], v[36:39], v[80:83], v[196:199]
    ds_read_b128 v[124:127], v3 offset:14336
    v_mfma_f32_16x16x32_bf16 v[200:203], v[40:43], v[80:83], v[200:203]
    v_mfma_f32_16x16x32_bf16 v[204:207], v[44:47], v[80:83], v[204:207]
    v_mfma_f32_16x16x32_bf16 v[220:223], v[44:47], v[84:87], v[220:223]
    v_mfma_f32_16x16x32_bf16 v[216:219], v[40:43], v[84:87], v[216:219]
    v_mfma_f32_16x16x32_bf16 v[212:215], v[36:39], v[84:87], v[212:215]
    v_mfma_f32_16x16x32_bf16 v[208:211], v[32:35], v[84:87], v[208:211]
    v_mfma_f32_16x16x32_bf16 v[224:227], v[32:35], v[88:91], v[224:227]
    v_mfma_f32_16x16x32_bf16 v[228:231], v[36:39], v[88:91], v[228:231]
    v_mfma_f32_16x16x32_bf16 v[232:235], v[40:43], v[88:91], v[232:235]
    v_mfma_f32_16x16x32_bf16 v[236:239], v[44:47], v[88:91], v[236:239]
    v_mfma_f32_16x16x32_bf16 v[252:255], v[44:47], v[92:95], v[252:255]
    v_mfma_f32_16x16x32_bf16 v[248:251], v[40:43], v[92:95], v[248:251]
    v_mfma_f32_16x16x32_bf16 v[244:247], v[36:39], v[92:95], v[244:247]
    v_mfma_f32_16x16x32_bf16 v[240:243], v[32:35], v[92:95], v[240:243]
    s_waitcnt lgkmcnt(0)
    s_waitcnt vmcnt(5)
    s_barrier
    v_mfma_f32_16x16x32_bf16 v[128:131], v[48:51], v[96:99], v[128:131]
    s_add_u32 m0, s37, 0
    v_mfma_f32_16x16x32_bf16 v[132:135], v[52:55], v[96:99], v[132:135]
    s_add_u32 s57, s35, 5505024
    v_mfma_f32_16x16x32_bf16 v[136:139], v[56:59], v[96:99], v[136:139]
    buffer_load_dwordx4 v12, s[12:15], s57 offen offset:0 lds
    ds_read_b64_tr_b16 v[32:33], v4 offset:4096
    v_mfma_f32_16x16x32_bf16 v[140:143], v[60:63], v[96:99], v[140:143]
    buffer_load_dwordx4 v13, s[12:15], s57 offen offset:1024 lds
    ds_read_b64_tr_b16 v[34:35], v4 offset:4608
    v_mfma_f32_16x16x32_bf16 v[156:159], v[60:63], v[100:103], v[156:159]
    buffer_load_dwordx4 v14, s[12:15], s57 offen offset:2048 lds
    ds_read_b64_tr_b16 v[36:37], v5 offset:4096
    v_mfma_f32_16x16x32_bf16 v[152:155], v[56:59], v[100:103], v[152:155]
    buffer_load_dwordx4 v15, s[12:15], s57 offen offset:3072 lds
    ds_read_b64_tr_b16 v[38:39], v5 offset:4608
    v_mfma_f32_16x16x32_bf16 v[148:151], v[52:55], v[100:103], v[148:151]
    s_add_u32 m0, s36, 0
    ds_read_b64_tr_b16 v[40:41], v6 offset:4096
    v_mfma_f32_16x16x32_bf16 v[144:147], v[48:51], v[100:103], v[144:147]
    s_add_u32 s30, s34, 1536
    ds_read_b64_tr_b16 v[42:43], v6 offset:4608
    v_mfma_f32_16x16x32_bf16 v[160:163], v[48:51], v[104:107], v[160:163]
    buffer_load_dwordx4 v8, s[8:11], s30 offen offset:0 lds
    ds_read_b64_tr_b16 v[44:45], v7 offset:4096
    v_mfma_f32_16x16x32_bf16 v[164:167], v[52:55], v[104:107], v[164:167]
    buffer_load_dwordx4 v9, s[8:11], s30 offen offset:1024 lds
    ds_read_b64_tr_b16 v[46:47], v7 offset:4608
    v_mfma_f32_16x16x32_bf16 v[168:171], v[56:59], v[104:107], v[168:171]
    buffer_load_dwordx4 v10, s[8:11], s30 offen offset:2048 lds
    ds_read_b128 v[64:67], v2 offset:16384
    v_mfma_f32_16x16x32_bf16 v[172:175], v[60:63], v[104:107], v[172:175]
    buffer_load_dwordx4 v11, s[8:11], s30 offen offset:3072 lds
    ds_read_b128 v[68:71], v2 offset:18432
    v_mfma_f32_16x16x32_bf16 v[188:191], v[60:63], v[108:111], v[188:191]
    ds_read_b128 v[72:75], v2 offset:20480
    v_mfma_f32_16x16x32_bf16 v[184:187], v[56:59], v[108:111], v[184:187]
    ds_read_b128 v[76:79], v2 offset:22528
    v_mfma_f32_16x16x32_bf16 v[180:183], v[52:55], v[108:111], v[180:183]
    ds_read_b128 v[80:83], v2 offset:24576
    v_mfma_f32_16x16x32_bf16 v[176:179], v[48:51], v[108:111], v[176:179]
    ds_read_b128 v[84:87], v2 offset:26624
    v_mfma_f32_16x16x32_bf16 v[192:195], v[48:51], v[112:115], v[192:195]
    ds_read_b128 v[88:91], v2 offset:28672
    v_mfma_f32_16x16x32_bf16 v[196:199], v[52:55], v[112:115], v[196:199]
    ds_read_b128 v[92:95], v2 offset:30720
    v_mfma_f32_16x16x32_bf16 v[200:203], v[56:59], v[112:115], v[200:203]
    v_mfma_f32_16x16x32_bf16 v[204:207], v[60:63], v[112:115], v[204:207]
    v_mfma_f32_16x16x32_bf16 v[220:223], v[60:63], v[116:119], v[220:223]
    v_mfma_f32_16x16x32_bf16 v[216:219], v[56:59], v[116:119], v[216:219]
    v_mfma_f32_16x16x32_bf16 v[212:215], v[52:55], v[116:119], v[212:215]
    v_mfma_f32_16x16x32_bf16 v[208:211], v[48:51], v[116:119], v[208:211]
    v_mfma_f32_16x16x32_bf16 v[224:227], v[48:51], v[120:123], v[224:227]
    v_mfma_f32_16x16x32_bf16 v[228:231], v[52:55], v[120:123], v[228:231]
    v_mfma_f32_16x16x32_bf16 v[232:235], v[56:59], v[120:123], v[232:235]
    v_mfma_f32_16x16x32_bf16 v[236:239], v[60:63], v[120:123], v[236:239]
    v_mfma_f32_16x16x32_bf16 v[252:255], v[60:63], v[124:127], v[252:255]
    v_mfma_f32_16x16x32_bf16 v[248:251], v[56:59], v[124:127], v[248:251]
    v_mfma_f32_16x16x32_bf16 v[244:247], v[52:55], v[124:127], v[244:247]
    v_mfma_f32_16x16x32_bf16 v[240:243], v[48:51], v[124:127], v[240:243]
    s_waitcnt lgkmcnt(0)
    s_waitcnt vmcnt(8)
    v_mfma_f32_16x16x32_bf16 v[128:131], v[32:35], v[64:67], v[128:131]
    s_add_u32 m0, s37, 4096
    v_mfma_f32_16x16x32_bf16 v[132:135], v[36:39], v[64:67], v[132:135]
    s_add_u32 s57, s35, 5734400
    v_mfma_f32_16x16x32_bf16 v[136:139], v[40:43], v[64:67], v[136:139]
    buffer_load_dwordx4 v12, s[12:15], s57 offen offset:0 lds
    ds_read_b64_tr_b16 v[48:49], v4 offset:8192
    v_mfma_f32_16x16x32_bf16 v[140:143], v[44:47], v[64:67], v[140:143]
    buffer_load_dwordx4 v13, s[12:15], s57 offen offset:1024 lds
    ds_read_b64_tr_b16 v[50:51], v4 offset:8704
    v_mfma_f32_16x16x32_bf16 v[156:159], v[44:47], v[68:71], v[156:159]
    buffer_load_dwordx4 v14, s[12:15], s57 offen offset:2048 lds
    ds_read_b64_tr_b16 v[52:53], v5 offset:8192
    v_mfma_f32_16x16x32_bf16 v[152:155], v[40:43], v[68:71], v[152:155]
    buffer_load_dwordx4 v15, s[12:15], s57 offen offset:3072 lds
    ds_read_b64_tr_b16 v[54:55], v5 offset:8704
    v_mfma_f32_16x16x32_bf16 v[148:151], v[36:39], v[68:71], v[148:151]
    ds_read_b64_tr_b16 v[56:57], v6 offset:8192
    v_mfma_f32_16x16x32_bf16 v[144:147], v[32:35], v[68:71], v[144:147]
    ds_read_b64_tr_b16 v[58:59], v6 offset:8704
    v_mfma_f32_16x16x32_bf16 v[160:163], v[32:35], v[72:75], v[160:163]
    ds_read_b64_tr_b16 v[60:61], v7 offset:8192
    v_mfma_f32_16x16x32_bf16 v[164:167], v[36:39], v[72:75], v[164:167]
    ds_read_b64_tr_b16 v[62:63], v7 offset:8704
    v_mfma_f32_16x16x32_bf16 v[168:171], v[40:43], v[72:75], v[168:171]
    ds_read_b128 v[96:99], v3 offset:16384
    v_mfma_f32_16x16x32_bf16 v[172:175], v[44:47], v[72:75], v[172:175]
    ds_read_b128 v[100:103], v3 offset:18432
    v_mfma_f32_16x16x32_bf16 v[188:191], v[44:47], v[76:79], v[188:191]
    ds_read_b128 v[104:107], v3 offset:20480
    v_mfma_f32_16x16x32_bf16 v[184:187], v[40:43], v[76:79], v[184:187]
    ds_read_b128 v[108:111], v3 offset:22528
    v_mfma_f32_16x16x32_bf16 v[180:183], v[36:39], v[76:79], v[180:183]
    ds_read_b128 v[112:115], v3 offset:24576
    v_mfma_f32_16x16x32_bf16 v[176:179], v[32:35], v[76:79], v[176:179]
    ds_read_b128 v[116:119], v3 offset:26624
    v_mfma_f32_16x16x32_bf16 v[192:195], v[32:35], v[80:83], v[192:195]
    ds_read_b128 v[120:123], v3 offset:28672
    v_mfma_f32_16x16x32_bf16 v[196:199], v[36:39], v[80:83], v[196:199]
    ds_read_b128 v[124:127], v3 offset:30720
    v_mfma_f32_16x16x32_bf16 v[200:203], v[40:43], v[80:83], v[200:203]
    v_mfma_f32_16x16x32_bf16 v[204:207], v[44:47], v[80:83], v[204:207]
    v_mfma_f32_16x16x32_bf16 v[220:223], v[44:47], v[84:87], v[220:223]
    v_mfma_f32_16x16x32_bf16 v[216:219], v[40:43], v[84:87], v[216:219]
    v_mfma_f32_16x16x32_bf16 v[212:215], v[36:39], v[84:87], v[212:215]
    v_mfma_f32_16x16x32_bf16 v[208:211], v[32:35], v[84:87], v[208:211]
    v_mfma_f32_16x16x32_bf16 v[224:227], v[32:35], v[88:91], v[224:227]
    v_mfma_f32_16x16x32_bf16 v[228:231], v[36:39], v[88:91], v[228:231]
    v_mfma_f32_16x16x32_bf16 v[232:235], v[40:43], v[88:91], v[232:235]
    v_mfma_f32_16x16x32_bf16 v[236:239], v[44:47], v[88:91], v[236:239]
    v_mfma_f32_16x16x32_bf16 v[252:255], v[44:47], v[92:95], v[252:255]
    v_mfma_f32_16x16x32_bf16 v[248:251], v[40:43], v[92:95], v[248:251]
    v_mfma_f32_16x16x32_bf16 v[244:247], v[36:39], v[92:95], v[244:247]
    v_mfma_f32_16x16x32_bf16 v[240:243], v[32:35], v[92:95], v[240:243]
    s_waitcnt lgkmcnt(0)
    s_waitcnt vmcnt(4)
    s_barrier
    v_mfma_f32_16x16x32_bf16 v[128:131], v[48:51], v[96:99], v[128:131]
    s_add_u32 m0, s37, 8192
    v_mfma_f32_16x16x32_bf16 v[132:135], v[52:55], v[96:99], v[132:135]
    s_add_u32 s57, s35, 5963776
    v_mfma_f32_16x16x32_bf16 v[136:139], v[56:59], v[96:99], v[136:139]
    buffer_load_dwordx4 v12, s[12:15], s57 offen offset:0 lds
    ds_read_b64_tr_b16 v[32:33], v4 offset:0
    v_mfma_f32_16x16x32_bf16 v[140:143], v[60:63], v[96:99], v[140:143]
    buffer_load_dwordx4 v13, s[12:15], s57 offen offset:1024 lds
    ds_read_b64_tr_b16 v[34:35], v4 offset:512
    v_mfma_f32_16x16x32_bf16 v[156:159], v[60:63], v[100:103], v[156:159]
    buffer_load_dwordx4 v14, s[12:15], s57 offen offset:2048 lds
    ds_read_b64_tr_b16 v[36:37], v5 offset:0
    v_mfma_f32_16x16x32_bf16 v[152:155], v[56:59], v[100:103], v[152:155]
    buffer_load_dwordx4 v15, s[12:15], s57 offen offset:3072 lds
    ds_read_b64_tr_b16 v[38:39], v5 offset:512
    v_mfma_f32_16x16x32_bf16 v[148:151], v[52:55], v[100:103], v[148:151]
    s_add_u32 m0, s36, 16384
    ds_read_b64_tr_b16 v[40:41], v6 offset:0
    v_mfma_f32_16x16x32_bf16 v[144:147], v[48:51], v[100:103], v[144:147]
    s_add_u32 s30, s34, 1664
    ds_read_b64_tr_b16 v[42:43], v6 offset:512
    v_mfma_f32_16x16x32_bf16 v[160:163], v[48:51], v[104:107], v[160:163]
    buffer_load_dwordx4 v8, s[8:11], s30 offen offset:0 lds
    ds_read_b64_tr_b16 v[44:45], v7 offset:0
    v_mfma_f32_16x16x32_bf16 v[164:167], v[52:55], v[104:107], v[164:167]
    buffer_load_dwordx4 v9, s[8:11], s30 offen offset:1024 lds
    ds_read_b64_tr_b16 v[46:47], v7 offset:512
    v_mfma_f32_16x16x32_bf16 v[168:171], v[56:59], v[104:107], v[168:171]
    buffer_load_dwordx4 v10, s[8:11], s30 offen offset:2048 lds
    ds_read_b128 v[64:67], v2 offset:0
    v_mfma_f32_16x16x32_bf16 v[172:175], v[60:63], v[104:107], v[172:175]
    buffer_load_dwordx4 v11, s[8:11], s30 offen offset:3072 lds
    ds_read_b128 v[68:71], v2 offset:2048
    v_mfma_f32_16x16x32_bf16 v[188:191], v[60:63], v[108:111], v[188:191]
    s_mul_i32 s32, s68, 2048
    ds_read_b128 v[72:75], v2 offset:4096
    v_mfma_f32_16x16x32_bf16 v[184:187], v[56:59], v[108:111], v[184:187]
    s_add_u32 s32, s32, 3670016
    ds_read_b128 v[76:79], v2 offset:6144
    v_mfma_f32_16x16x32_bf16 v[180:183], v[52:55], v[108:111], v[180:183]
    buffer_load_dword v16, v23, s[44:47], s32 offen
    ds_read_b128 v[80:83], v2 offset:8192
    v_mfma_f32_16x16x32_bf16 v[176:179], v[48:51], v[108:111], v[176:179]
    ds_read_b128 v[84:87], v2 offset:10240
    v_mfma_f32_16x16x32_bf16 v[192:195], v[48:51], v[112:115], v[192:195]
    ds_read_b128 v[88:91], v2 offset:12288
    v_mfma_f32_16x16x32_bf16 v[196:199], v[52:55], v[112:115], v[196:199]
    ds_read_b128 v[92:95], v2 offset:14336
    v_mfma_f32_16x16x32_bf16 v[200:203], v[56:59], v[112:115], v[200:203]
    v_mfma_f32_16x16x32_bf16 v[204:207], v[60:63], v[112:115], v[204:207]
    v_mfma_f32_16x16x32_bf16 v[220:223], v[60:63], v[116:119], v[220:223]
    v_mfma_f32_16x16x32_bf16 v[216:219], v[56:59], v[116:119], v[216:219]
    v_mfma_f32_16x16x32_bf16 v[212:215], v[52:55], v[116:119], v[212:215]
    v_mfma_f32_16x16x32_bf16 v[208:211], v[48:51], v[116:119], v[208:211]
    v_mfma_f32_16x16x32_bf16 v[224:227], v[48:51], v[120:123], v[224:227]
    v_mfma_f32_16x16x32_bf16 v[228:231], v[52:55], v[120:123], v[228:231]
    v_mfma_f32_16x16x32_bf16 v[232:235], v[56:59], v[120:123], v[232:235]
    v_mfma_f32_16x16x32_bf16 v[236:239], v[60:63], v[120:123], v[236:239]
    v_mfma_f32_16x16x32_bf16 v[252:255], v[60:63], v[124:127], v[252:255]
    v_mfma_f32_16x16x32_bf16 v[248:251], v[56:59], v[124:127], v[248:251]
    v_mfma_f32_16x16x32_bf16 v[244:247], v[52:55], v[124:127], v[244:247]
    v_mfma_f32_16x16x32_bf16 v[240:243], v[48:51], v[124:127], v[240:243]
    s_waitcnt lgkmcnt(0)
    s_waitcnt vmcnt(9)
    v_mfma_f32_16x16x32_bf16 v[128:131], v[32:35], v[64:67], v[128:131]
    s_add_u32 m0, s37, 0
    v_mfma_f32_16x16x32_bf16 v[132:135], v[36:39], v[64:67], v[132:135]
    s_add_u32 s57, s35, 6193152
    v_mfma_f32_16x16x32_bf16 v[136:139], v[40:43], v[64:67], v[136:139]
    buffer_load_dwordx4 v12, s[12:15], s57 offen offset:0 lds
    ds_read_b64_tr_b16 v[48:49], v4 offset:4096
    v_mfma_f32_16x16x32_bf16 v[140:143], v[44:47], v[64:67], v[140:143]
    buffer_load_dwordx4 v13, s[12:15], s57 offen offset:1024 lds
    ds_read_b64_tr_b16 v[50:51], v4 offset:4608
    v_mfma_f32_16x16x32_bf16 v[156:159], v[44:47], v[68:71], v[156:159]
    buffer_load_dwordx4 v14, s[12:15], s57 offen offset:2048 lds
    ds_read_b64_tr_b16 v[52:53], v5 offset:4096
    v_mfma_f32_16x16x32_bf16 v[152:155], v[40:43], v[68:71], v[152:155]
    buffer_load_dwordx4 v15, s[12:15], s57 offen offset:3072 lds
    ds_read_b64_tr_b16 v[54:55], v5 offset:4608
    v_mfma_f32_16x16x32_bf16 v[148:151], v[36:39], v[68:71], v[148:151]
    ds_read_b64_tr_b16 v[56:57], v6 offset:4096
    v_mfma_f32_16x16x32_bf16 v[144:147], v[32:35], v[68:71], v[144:147]
    ds_read_b64_tr_b16 v[58:59], v6 offset:4608
    v_mfma_f32_16x16x32_bf16 v[160:163], v[32:35], v[72:75], v[160:163]
    ds_read_b64_tr_b16 v[60:61], v7 offset:4096
    v_mfma_f32_16x16x32_bf16 v[164:167], v[36:39], v[72:75], v[164:167]
    ds_read_b64_tr_b16 v[62:63], v7 offset:4608
    v_mfma_f32_16x16x32_bf16 v[168:171], v[40:43], v[72:75], v[168:171]
    ds_read_b128 v[96:99], v3 offset:0
    v_mfma_f32_16x16x32_bf16 v[172:175], v[44:47], v[72:75], v[172:175]
    ds_read_b128 v[100:103], v3 offset:2048
    v_mfma_f32_16x16x32_bf16 v[188:191], v[44:47], v[76:79], v[188:191]
    ds_read_b128 v[104:107], v3 offset:4096
    v_mfma_f32_16x16x32_bf16 v[184:187], v[40:43], v[76:79], v[184:187]
    ds_read_b128 v[108:111], v3 offset:6144
    v_mfma_f32_16x16x32_bf16 v[180:183], v[36:39], v[76:79], v[180:183]
    ds_read_b128 v[112:115], v3 offset:8192
    v_mfma_f32_16x16x32_bf16 v[176:179], v[32:35], v[76:79], v[176:179]
    ds_read_b128 v[116:119], v3 offset:10240
    v_mfma_f32_16x16x32_bf16 v[192:195], v[32:35], v[80:83], v[192:195]
    ds_read_b128 v[120:123], v3 offset:12288
    v_mfma_f32_16x16x32_bf16 v[196:199], v[36:39], v[80:83], v[196:199]
    ds_read_b128 v[124:127], v3 offset:14336
    v_mfma_f32_16x16x32_bf16 v[200:203], v[40:43], v[80:83], v[200:203]
    v_mfma_f32_16x16x32_bf16 v[204:207], v[44:47], v[80:83], v[204:207]
    v_mfma_f32_16x16x32_bf16 v[220:223], v[44:47], v[84:87], v[220:223]
    v_mfma_f32_16x16x32_bf16 v[216:219], v[40:43], v[84:87], v[216:219]
    v_mfma_f32_16x16x32_bf16 v[212:215], v[36:39], v[84:87], v[212:215]
    v_mfma_f32_16x16x32_bf16 v[208:211], v[32:35], v[84:87], v[208:211]
    v_mfma_f32_16x16x32_bf16 v[224:227], v[32:35], v[88:91], v[224:227]
    v_mfma_f32_16x16x32_bf16 v[228:231], v[36:39], v[88:91], v[228:231]
    v_mfma_f32_16x16x32_bf16 v[232:235], v[40:43], v[88:91], v[232:235]
    v_mfma_f32_16x16x32_bf16 v[236:239], v[44:47], v[88:91], v[236:239]
    v_mfma_f32_16x16x32_bf16 v[252:255], v[44:47], v[92:95], v[252:255]
    v_mfma_f32_16x16x32_bf16 v[248:251], v[40:43], v[92:95], v[248:251]
    v_mfma_f32_16x16x32_bf16 v[244:247], v[36:39], v[92:95], v[244:247]
    v_mfma_f32_16x16x32_bf16 v[240:243], v[32:35], v[92:95], v[240:243]
    s_waitcnt lgkmcnt(0)
    s_waitcnt vmcnt(5)
    s_barrier
    v_mfma_f32_16x16x32_bf16 v[128:131], v[48:51], v[96:99], v[128:131]
    s_add_u32 m0, s37, 4096
    v_mfma_f32_16x16x32_bf16 v[132:135], v[52:55], v[96:99], v[132:135]
    s_add_u32 s57, s35, 6422528
    v_mfma_f32_16x16x32_bf16 v[136:139], v[56:59], v[96:99], v[136:139]
    buffer_load_dwordx4 v12, s[12:15], s57 offen offset:0 lds
    ds_read_b64_tr_b16 v[32:33], v4 offset:8192
    v_mfma_f32_16x16x32_bf16 v[140:143], v[60:63], v[96:99], v[140:143]
    buffer_load_dwordx4 v13, s[12:15], s57 offen offset:1024 lds
    ds_read_b64_tr_b16 v[34:35], v4 offset:8704
    v_mfma_f32_16x16x32_bf16 v[156:159], v[60:63], v[100:103], v[156:159]
    buffer_load_dwordx4 v14, s[12:15], s57 offen offset:2048 lds
    ds_read_b64_tr_b16 v[36:37], v5 offset:8192
    v_mfma_f32_16x16x32_bf16 v[152:155], v[56:59], v[100:103], v[152:155]
    buffer_load_dwordx4 v15, s[12:15], s57 offen offset:3072 lds
    ds_read_b64_tr_b16 v[38:39], v5 offset:8704
    v_mfma_f32_16x16x32_bf16 v[148:151], v[52:55], v[100:103], v[148:151]
    s_add_u32 m0, s36, 0
    ds_read_b64_tr_b16 v[40:41], v6 offset:8192
    v_mfma_f32_16x16x32_bf16 v[144:147], v[48:51], v[100:103], v[144:147]
    s_add_u32 s30, s34, 1792
    ds_read_b64_tr_b16 v[42:43], v6 offset:8704
    v_mfma_f32_16x16x32_bf16 v[160:163], v[48:51], v[104:107], v[160:163]
    buffer_load_dwordx4 v8, s[8:11], s30 offen offset:0 lds
    ds_read_b64_tr_b16 v[44:45], v7 offset:8192
    v_mfma_f32_16x16x32_bf16 v[164:167], v[52:55], v[104:107], v[164:167]
    buffer_load_dwordx4 v9, s[8:11], s30 offen offset:1024 lds
    ds_read_b64_tr_b16 v[46:47], v7 offset:8704
    v_mfma_f32_16x16x32_bf16 v[168:171], v[56:59], v[104:107], v[168:171]
    buffer_load_dwordx4 v10, s[8:11], s30 offen offset:2048 lds
    ds_read_b128 v[64:67], v2 offset:16384
    v_mfma_f32_16x16x32_bf16 v[172:175], v[60:63], v[104:107], v[172:175]
    buffer_load_dwordx4 v11, s[8:11], s30 offen offset:3072 lds
    ds_read_b128 v[68:71], v2 offset:18432
    v_mfma_f32_16x16x32_bf16 v[188:191], v[60:63], v[108:111], v[188:191]
    ds_read_b128 v[72:75], v2 offset:20480
    v_mfma_f32_16x16x32_bf16 v[184:187], v[56:59], v[108:111], v[184:187]
    ds_read_b128 v[76:79], v2 offset:22528
    v_mfma_f32_16x16x32_bf16 v[180:183], v[52:55], v[108:111], v[180:183]
    ds_read_b128 v[80:83], v2 offset:24576
    v_mfma_f32_16x16x32_bf16 v[176:179], v[48:51], v[108:111], v[176:179]
    ds_read_b128 v[84:87], v2 offset:26624
    v_mfma_f32_16x16x32_bf16 v[192:195], v[48:51], v[112:115], v[192:195]
    ds_read_b128 v[88:91], v2 offset:28672
    v_mfma_f32_16x16x32_bf16 v[196:199], v[52:55], v[112:115], v[196:199]
    ds_read_b128 v[92:95], v2 offset:30720
    v_mfma_f32_16x16x32_bf16 v[200:203], v[56:59], v[112:115], v[200:203]
    v_mfma_f32_16x16x32_bf16 v[204:207], v[60:63], v[112:115], v[204:207]
    v_mfma_f32_16x16x32_bf16 v[220:223], v[60:63], v[116:119], v[220:223]
    v_mfma_f32_16x16x32_bf16 v[216:219], v[56:59], v[116:119], v[216:219]
    v_mfma_f32_16x16x32_bf16 v[212:215], v[52:55], v[116:119], v[212:215]
    v_mfma_f32_16x16x32_bf16 v[208:211], v[48:51], v[116:119], v[208:211]
    v_mfma_f32_16x16x32_bf16 v[224:227], v[48:51], v[120:123], v[224:227]
    v_mfma_f32_16x16x32_bf16 v[228:231], v[52:55], v[120:123], v[228:231]
    v_mfma_f32_16x16x32_bf16 v[232:235], v[56:59], v[120:123], v[232:235]
    v_mfma_f32_16x16x32_bf16 v[236:239], v[60:63], v[120:123], v[236:239]
    v_mfma_f32_16x16x32_bf16 v[252:255], v[60:63], v[124:127], v[252:255]
    v_mfma_f32_16x16x32_bf16 v[248:251], v[56:59], v[124:127], v[248:251]
    v_mfma_f32_16x16x32_bf16 v[244:247], v[52:55], v[124:127], v[244:247]
    v_mfma_f32_16x16x32_bf16 v[240:243], v[48:51], v[124:127], v[240:243]
    s_waitcnt lgkmcnt(0)
    s_waitcnt vmcnt(8)
    v_mfma_f32_16x16x32_bf16 v[128:131], v[32:35], v[64:67], v[128:131]
    s_add_u32 m0, s37, 8192
    v_mfma_f32_16x16x32_bf16 v[132:135], v[36:39], v[64:67], v[132:135]
    s_add_u32 s57, s35, 6651904
    v_mfma_f32_16x16x32_bf16 v[136:139], v[40:43], v[64:67], v[136:139]
    buffer_load_dwordx4 v12, s[12:15], s57 offen offset:0 lds
    ds_read_b64_tr_b16 v[48:49], v4 offset:0
    v_mfma_f32_16x16x32_bf16 v[140:143], v[44:47], v[64:67], v[140:143]
    buffer_load_dwordx4 v13, s[12:15], s57 offen offset:1024 lds
    ds_read_b64_tr_b16 v[50:51], v4 offset:512
    v_mfma_f32_16x16x32_bf16 v[156:159], v[44:47], v[68:71], v[156:159]
    buffer_load_dwordx4 v14, s[12:15], s57 offen offset:2048 lds
    ds_read_b64_tr_b16 v[52:53], v5 offset:0
    v_mfma_f32_16x16x32_bf16 v[152:155], v[40:43], v[68:71], v[152:155]
    buffer_load_dwordx4 v15, s[12:15], s57 offen offset:3072 lds
    ds_read_b64_tr_b16 v[54:55], v5 offset:512
    v_mfma_f32_16x16x32_bf16 v[148:151], v[36:39], v[68:71], v[148:151]
    ds_read_b64_tr_b16 v[56:57], v6 offset:0
    v_mfma_f32_16x16x32_bf16 v[144:147], v[32:35], v[68:71], v[144:147]
    ds_read_b64_tr_b16 v[58:59], v6 offset:512
    v_mfma_f32_16x16x32_bf16 v[160:163], v[32:35], v[72:75], v[160:163]
    ds_read_b64_tr_b16 v[60:61], v7 offset:0
    v_mfma_f32_16x16x32_bf16 v[164:167], v[36:39], v[72:75], v[164:167]
    ds_read_b64_tr_b16 v[62:63], v7 offset:512
    v_mfma_f32_16x16x32_bf16 v[168:171], v[40:43], v[72:75], v[168:171]
    ds_read_b128 v[96:99], v3 offset:16384
    v_mfma_f32_16x16x32_bf16 v[172:175], v[44:47], v[72:75], v[172:175]
    ds_read_b128 v[100:103], v3 offset:18432
    v_mfma_f32_16x16x32_bf16 v[188:191], v[44:47], v[76:79], v[188:191]
    ds_read_b128 v[104:107], v3 offset:20480
    v_mfma_f32_16x16x32_bf16 v[184:187], v[40:43], v[76:79], v[184:187]
    ds_read_b128 v[108:111], v3 offset:22528
    v_mfma_f32_16x16x32_bf16 v[180:183], v[36:39], v[76:79], v[180:183]
    ds_read_b128 v[112:115], v3 offset:24576
    v_mfma_f32_16x16x32_bf16 v[176:179], v[32:35], v[76:79], v[176:179]
    ds_read_b128 v[116:119], v3 offset:26624
    v_mfma_f32_16x16x32_bf16 v[192:195], v[32:35], v[80:83], v[192:195]
    ds_read_b128 v[120:123], v3 offset:28672
    v_mfma_f32_16x16x32_bf16 v[196:199], v[36:39], v[80:83], v[196:199]
    ds_read_b128 v[124:127], v3 offset:30720
    v_mfma_f32_16x16x32_bf16 v[200:203], v[40:43], v[80:83], v[200:203]
    v_mfma_f32_16x16x32_bf16 v[204:207], v[44:47], v[80:83], v[204:207]
    v_mfma_f32_16x16x32_bf16 v[220:223], v[44:47], v[84:87], v[220:223]
    v_mfma_f32_16x16x32_bf16 v[216:219], v[40:43], v[84:87], v[216:219]
    v_mfma_f32_16x16x32_bf16 v[212:215], v[36:39], v[84:87], v[212:215]
    v_mfma_f32_16x16x32_bf16 v[208:211], v[32:35], v[84:87], v[208:211]
    v_mfma_f32_16x16x32_bf16 v[224:227], v[32:35], v[88:91], v[224:227]
    v_mfma_f32_16x16x32_bf16 v[228:231], v[36:39], v[88:91], v[228:231]
    v_mfma_f32_16x16x32_bf16 v[232:235], v[40:43], v[88:91], v[232:235]
    v_mfma_f32_16x16x32_bf16 v[236:239], v[44:47], v[88:91], v[236:239]
    v_mfma_f32_16x16x32_bf16 v[252:255], v[44:47], v[92:95], v[252:255]
    v_mfma_f32_16x16x32_bf16 v[248:251], v[40:43], v[92:95], v[248:251]
    v_mfma_f32_16x16x32_bf16 v[244:247], v[36:39], v[92:95], v[244:247]
    v_mfma_f32_16x16x32_bf16 v[240:243], v[32:35], v[92:95], v[240:243]
    s_waitcnt lgkmcnt(0)
    s_waitcnt vmcnt(4)
    s_barrier
    v_mfma_f32_16x16x32_bf16 v[128:131], v[48:51], v[96:99], v[128:131]
    s_add_u32 m0, s37, 0
    v_mfma_f32_16x16x32_bf16 v[132:135], v[52:55], v[96:99], v[132:135]
    s_add_u32 s57, s35, 6881280
    v_mfma_f32_16x16x32_bf16 v[136:139], v[56:59], v[96:99], v[136:139]
    buffer_load_dwordx4 v12, s[12:15], s57 offen offset:0 lds
    ds_read_b64_tr_b16 v[32:33], v4 offset:4096
    v_mfma_f32_16x16x32_bf16 v[140:143], v[60:63], v[96:99], v[140:143]
    buffer_load_dwordx4 v13, s[12:15], s57 offen offset:1024 lds
    ds_read_b64_tr_b16 v[34:35], v4 offset:4608
    v_mfma_f32_16x16x32_bf16 v[156:159], v[60:63], v[100:103], v[156:159]
    buffer_load_dwordx4 v14, s[12:15], s57 offen offset:2048 lds
    ds_read_b64_tr_b16 v[36:37], v5 offset:4096
    v_mfma_f32_16x16x32_bf16 v[152:155], v[56:59], v[100:103], v[152:155]
    buffer_load_dwordx4 v15, s[12:15], s57 offen offset:3072 lds
    ds_read_b64_tr_b16 v[38:39], v5 offset:4608
    v_mfma_f32_16x16x32_bf16 v[148:151], v[52:55], v[100:103], v[148:151]
    s_add_u32 m0, s36, 16384
    ds_read_b64_tr_b16 v[40:41], v6 offset:4096
    v_mfma_f32_16x16x32_bf16 v[144:147], v[48:51], v[100:103], v[144:147]
    s_add_u32 s30, s34, 1920
    ds_read_b64_tr_b16 v[42:43], v6 offset:4608
    v_mfma_f32_16x16x32_bf16 v[160:163], v[48:51], v[104:107], v[160:163]
    buffer_load_dwordx4 v8, s[8:11], s30 offen offset:0 lds
    ds_read_b64_tr_b16 v[44:45], v7 offset:4096
    v_mfma_f32_16x16x32_bf16 v[164:167], v[52:55], v[104:107], v[164:167]
    buffer_load_dwordx4 v9, s[8:11], s30 offen offset:1024 lds
    ds_read_b64_tr_b16 v[46:47], v7 offset:4608
    v_mfma_f32_16x16x32_bf16 v[168:171], v[56:59], v[104:107], v[168:171]
    buffer_load_dwordx4 v10, s[8:11], s30 offen offset:2048 lds
    ds_read_b128 v[64:67], v2 offset:0
    v_mfma_f32_16x16x32_bf16 v[172:175], v[60:63], v[104:107], v[172:175]
    buffer_load_dwordx4 v11, s[8:11], s30 offen offset:3072 lds
    ds_read_b128 v[68:71], v2 offset:2048
    v_mfma_f32_16x16x32_bf16 v[188:191], v[60:63], v[108:111], v[188:191]
    s_mul_i32 s32, s68, 2048
    ds_read_b128 v[72:75], v2 offset:4096
    v_mfma_f32_16x16x32_bf16 v[184:187], v[56:59], v[108:111], v[184:187]
    s_add_u32 s32, s32, 5505024
    ds_read_b128 v[76:79], v2 offset:6144
    v_mfma_f32_16x16x32_bf16 v[180:183], v[52:55], v[108:111], v[180:183]
    buffer_load_dword v16, v23, s[44:47], s32 offen
    ds_read_b128 v[80:83], v2 offset:8192
    v_mfma_f32_16x16x32_bf16 v[176:179], v[48:51], v[108:111], v[176:179]
    ds_read_b128 v[84:87], v2 offset:10240
    v_mfma_f32_16x16x32_bf16 v[192:195], v[48:51], v[112:115], v[192:195]
    ds_read_b128 v[88:91], v2 offset:12288
    v_mfma_f32_16x16x32_bf16 v[196:199], v[52:55], v[112:115], v[196:199]
    ds_read_b128 v[92:95], v2 offset:14336
    v_mfma_f32_16x16x32_bf16 v[200:203], v[56:59], v[112:115], v[200:203]
    v_mfma_f32_16x16x32_bf16 v[204:207], v[60:63], v[112:115], v[204:207]
    v_mfma_f32_16x16x32_bf16 v[220:223], v[60:63], v[116:119], v[220:223]
    v_mfma_f32_16x16x32_bf16 v[216:219], v[56:59], v[116:119], v[216:219]
    v_mfma_f32_16x16x32_bf16 v[212:215], v[52:55], v[116:119], v[212:215]
    v_mfma_f32_16x16x32_bf16 v[208:211], v[48:51], v[116:119], v[208:211]
    v_mfma_f32_16x16x32_bf16 v[224:227], v[48:51], v[120:123], v[224:227]
    v_mfma_f32_16x16x32_bf16 v[228:231], v[52:55], v[120:123], v[228:231]
    v_mfma_f32_16x16x32_bf16 v[232:235], v[56:59], v[120:123], v[232:235]
    v_mfma_f32_16x16x32_bf16 v[236:239], v[60:63], v[120:123], v[236:239]
    v_mfma_f32_16x16x32_bf16 v[252:255], v[60:63], v[124:127], v[252:255]
    v_mfma_f32_16x16x32_bf16 v[248:251], v[56:59], v[124:127], v[248:251]
    v_mfma_f32_16x16x32_bf16 v[244:247], v[52:55], v[124:127], v[244:247]
    v_mfma_f32_16x16x32_bf16 v[240:243], v[48:51], v[124:127], v[240:243]
    s_waitcnt lgkmcnt(0)
    s_waitcnt vmcnt(9)
    v_mfma_f32_16x16x32_bf16 v[128:131], v[32:35], v[64:67], v[128:131]
    s_add_u32 m0, s37, 4096
    v_mfma_f32_16x16x32_bf16 v[132:135], v[36:39], v[64:67], v[132:135]
    s_add_u32 s57, s35, 7110656
    v_mfma_f32_16x16x32_bf16 v[136:139], v[40:43], v[64:67], v[136:139]
    buffer_load_dwordx4 v12, s[12:15], s57 offen offset:0 lds
    ds_read_b64_tr_b16 v[48:49], v4 offset:8192
    v_mfma_f32_16x16x32_bf16 v[140:143], v[44:47], v[64:67], v[140:143]
    buffer_load_dwordx4 v13, s[12:15], s57 offen offset:1024 lds
    ds_read_b64_tr_b16 v[50:51], v4 offset:8704
    v_mfma_f32_16x16x32_bf16 v[156:159], v[44:47], v[68:71], v[156:159]
    buffer_load_dwordx4 v14, s[12:15], s57 offen offset:2048 lds
    ds_read_b64_tr_b16 v[52:53], v5 offset:8192
    v_mfma_f32_16x16x32_bf16 v[152:155], v[40:43], v[68:71], v[152:155]
    buffer_load_dwordx4 v15, s[12:15], s57 offen offset:3072 lds
    ds_read_b64_tr_b16 v[54:55], v5 offset:8704
    v_mfma_f32_16x16x32_bf16 v[148:151], v[36:39], v[68:71], v[148:151]
    ds_read_b64_tr_b16 v[56:57], v6 offset:8192
    v_mfma_f32_16x16x32_bf16 v[144:147], v[32:35], v[68:71], v[144:147]
    ds_read_b64_tr_b16 v[58:59], v6 offset:8704
    v_mfma_f32_16x16x32_bf16 v[160:163], v[32:35], v[72:75], v[160:163]
    ds_read_b64_tr_b16 v[60:61], v7 offset:8192
    v_mfma_f32_16x16x32_bf16 v[164:167], v[36:39], v[72:75], v[164:167]
    ds_read_b64_tr_b16 v[62:63], v7 offset:8704
    v_mfma_f32_16x16x32_bf16 v[168:171], v[40:43], v[72:75], v[168:171]
    ds_read_b128 v[96:99], v3 offset:0
    v_mfma_f32_16x16x32_bf16 v[172:175], v[44:47], v[72:75], v[172:175]
    ds_read_b128 v[100:103], v3 offset:2048
    v_mfma_f32_16x16x32_bf16 v[188:191], v[44:47], v[76:79], v[188:191]
    ds_read_b128 v[104:107], v3 offset:4096
    v_mfma_f32_16x16x32_bf16 v[184:187], v[40:43], v[76:79], v[184:187]
    ds_read_b128 v[108:111], v3 offset:6144
    v_mfma_f32_16x16x32_bf16 v[180:183], v[36:39], v[76:79], v[180:183]
    ds_read_b128 v[112:115], v3 offset:8192
    v_mfma_f32_16x16x32_bf16 v[176:179], v[32:35], v[76:79], v[176:179]
    ds_read_b128 v[116:119], v3 offset:10240
    v_mfma_f32_16x16x32_bf16 v[192:195], v[32:35], v[80:83], v[192:195]
    ds_read_b128 v[120:123], v3 offset:12288
    v_mfma_f32_16x16x32_bf16 v[196:199], v[36:39], v[80:83], v[196:199]
    ds_read_b128 v[124:127], v3 offset:14336
    v_mfma_f32_16x16x32_bf16 v[200:203], v[40:43], v[80:83], v[200:203]
    v_mfma_f32_16x16x32_bf16 v[204:207], v[44:47], v[80:83], v[204:207]
    v_mfma_f32_16x16x32_bf16 v[220:223], v[44:47], v[84:87], v[220:223]
    v_mfma_f32_16x16x32_bf16 v[216:219], v[40:43], v[84:87], v[216:219]
    v_mfma_f32_16x16x32_bf16 v[212:215], v[36:39], v[84:87], v[212:215]
    v_mfma_f32_16x16x32_bf16 v[208:211], v[32:35], v[84:87], v[208:211]
    v_mfma_f32_16x16x32_bf16 v[224:227], v[32:35], v[88:91], v[224:227]
    v_mfma_f32_16x16x32_bf16 v[228:231], v[36:39], v[88:91], v[228:231]
    v_mfma_f32_16x16x32_bf16 v[232:235], v[40:43], v[88:91], v[232:235]
    v_mfma_f32_16x16x32_bf16 v[236:239], v[44:47], v[88:91], v[236:239]
    v_mfma_f32_16x16x32_bf16 v[252:255], v[44:47], v[92:95], v[252:255]
    v_mfma_f32_16x16x32_bf16 v[248:251], v[40:43], v[92:95], v[248:251]
    v_mfma_f32_16x16x32_bf16 v[244:247], v[36:39], v[92:95], v[244:247]
    v_mfma_f32_16x16x32_bf16 v[240:243], v[32:35], v[92:95], v[240:243]
    s_waitcnt lgkmcnt(0)
    s_waitcnt vmcnt(5)
    s_barrier
    v_mfma_f32_16x16x32_bf16 v[128:131], v[48:51], v[96:99], v[128:131]
    v_mfma_f32_16x16x32_bf16 v[132:135], v[52:55], v[96:99], v[132:135]
    v_mfma_f32_16x16x32_bf16 v[136:139], v[56:59], v[96:99], v[136:139]
    ds_read_b64_tr_b16 v[32:33], v4 offset:0
    v_mfma_f32_16x16x32_bf16 v[140:143], v[60:63], v[96:99], v[140:143]
    ds_read_b64_tr_b16 v[34:35], v4 offset:512
    v_mfma_f32_16x16x32_bf16 v[156:159], v[60:63], v[100:103], v[156:159]
    ds_read_b64_tr_b16 v[36:37], v5 offset:0
    v_mfma_f32_16x16x32_bf16 v[152:155], v[56:59], v[100:103], v[152:155]
    ds_read_b64_tr_b16 v[38:39], v5 offset:512
    v_mfma_f32_16x16x32_bf16 v[148:151], v[52:55], v[100:103], v[148:151]
    ds_read_b64_tr_b16 v[40:41], v6 offset:0
    v_mfma_f32_16x16x32_bf16 v[144:147], v[48:51], v[100:103], v[144:147]
    ds_read_b64_tr_b16 v[42:43], v6 offset:512
    v_mfma_f32_16x16x32_bf16 v[160:163], v[48:51], v[104:107], v[160:163]
    ds_read_b64_tr_b16 v[44:45], v7 offset:0
    v_mfma_f32_16x16x32_bf16 v[164:167], v[52:55], v[104:107], v[164:167]
    ds_read_b64_tr_b16 v[46:47], v7 offset:512
    v_mfma_f32_16x16x32_bf16 v[168:171], v[56:59], v[104:107], v[168:171]
    ds_read_b128 v[64:67], v2 offset:16384
    v_mfma_f32_16x16x32_bf16 v[172:175], v[60:63], v[104:107], v[172:175]
    ds_read_b128 v[68:71], v2 offset:18432
    v_mfma_f32_16x16x32_bf16 v[188:191], v[60:63], v[108:111], v[188:191]
    ds_read_b128 v[72:75], v2 offset:20480
    v_mfma_f32_16x16x32_bf16 v[184:187], v[56:59], v[108:111], v[184:187]
    ds_read_b128 v[76:79], v2 offset:22528
    v_mfma_f32_16x16x32_bf16 v[180:183], v[52:55], v[108:111], v[180:183]
    ds_read_b128 v[80:83], v2 offset:24576
    v_mfma_f32_16x16x32_bf16 v[176:179], v[48:51], v[108:111], v[176:179]
    ds_read_b128 v[84:87], v2 offset:26624
    v_mfma_f32_16x16x32_bf16 v[192:195], v[48:51], v[112:115], v[192:195]
    ds_read_b128 v[88:91], v2 offset:28672
    v_mfma_f32_16x16x32_bf16 v[196:199], v[52:55], v[112:115], v[196:199]
    ds_read_b128 v[92:95], v2 offset:30720
    v_mfma_f32_16x16x32_bf16 v[200:203], v[56:59], v[112:115], v[200:203]
    v_mfma_f32_16x16x32_bf16 v[204:207], v[60:63], v[112:115], v[204:207]
    v_mfma_f32_16x16x32_bf16 v[220:223], v[60:63], v[116:119], v[220:223]
    v_mfma_f32_16x16x32_bf16 v[216:219], v[56:59], v[116:119], v[216:219]
    v_mfma_f32_16x16x32_bf16 v[212:215], v[52:55], v[116:119], v[212:215]
    v_mfma_f32_16x16x32_bf16 v[208:211], v[48:51], v[116:119], v[208:211]
    v_mfma_f32_16x16x32_bf16 v[224:227], v[48:51], v[120:123], v[224:227]
    v_mfma_f32_16x16x32_bf16 v[228:231], v[52:55], v[120:123], v[228:231]
    v_mfma_f32_16x16x32_bf16 v[232:235], v[56:59], v[120:123], v[232:235]
    v_mfma_f32_16x16x32_bf16 v[236:239], v[60:63], v[120:123], v[236:239]
    v_mfma_f32_16x16x32_bf16 v[252:255], v[60:63], v[124:127], v[252:255]
    v_mfma_f32_16x16x32_bf16 v[248:251], v[56:59], v[124:127], v[248:251]
    v_mfma_f32_16x16x32_bf16 v[244:247], v[52:55], v[124:127], v[244:247]
    v_mfma_f32_16x16x32_bf16 v[240:243], v[48:51], v[124:127], v[240:243]
    s_waitcnt lgkmcnt(0)
    s_waitcnt vmcnt(0)
    v_mfma_f32_16x16x32_bf16 v[128:131], v[32:35], v[64:67], v[128:131]
    v_mfma_f32_16x16x32_bf16 v[132:135], v[36:39], v[64:67], v[132:135]
    v_mfma_f32_16x16x32_bf16 v[136:139], v[40:43], v[64:67], v[136:139]
    ds_read_b64_tr_b16 v[48:49], v4 offset:4096
    v_mfma_f32_16x16x32_bf16 v[140:143], v[44:47], v[64:67], v[140:143]
    ds_read_b64_tr_b16 v[50:51], v4 offset:4608
    v_mfma_f32_16x16x32_bf16 v[156:159], v[44:47], v[68:71], v[156:159]
    ds_read_b64_tr_b16 v[52:53], v5 offset:4096
    v_mfma_f32_16x16x32_bf16 v[152:155], v[40:43], v[68:71], v[152:155]
    ds_read_b64_tr_b16 v[54:55], v5 offset:4608
    v_mfma_f32_16x16x32_bf16 v[148:151], v[36:39], v[68:71], v[148:151]
    ds_read_b64_tr_b16 v[56:57], v6 offset:4096
    v_mfma_f32_16x16x32_bf16 v[144:147], v[32:35], v[68:71], v[144:147]
    ds_read_b64_tr_b16 v[58:59], v6 offset:4608
    v_mfma_f32_16x16x32_bf16 v[160:163], v[32:35], v[72:75], v[160:163]
    ds_read_b64_tr_b16 v[60:61], v7 offset:4096
    v_mfma_f32_16x16x32_bf16 v[164:167], v[36:39], v[72:75], v[164:167]
    ds_read_b64_tr_b16 v[62:63], v7 offset:4608
    v_mfma_f32_16x16x32_bf16 v[168:171], v[40:43], v[72:75], v[168:171]
    ds_read_b128 v[96:99], v3 offset:16384
    v_mfma_f32_16x16x32_bf16 v[172:175], v[44:47], v[72:75], v[172:175]
    ds_read_b128 v[100:103], v3 offset:18432
    v_mfma_f32_16x16x32_bf16 v[188:191], v[44:47], v[76:79], v[188:191]
    ds_read_b128 v[104:107], v3 offset:20480
    v_mfma_f32_16x16x32_bf16 v[184:187], v[40:43], v[76:79], v[184:187]
    ds_read_b128 v[108:111], v3 offset:22528
    v_mfma_f32_16x16x32_bf16 v[180:183], v[36:39], v[76:79], v[180:183]
    ds_read_b128 v[112:115], v3 offset:24576
    v_mfma_f32_16x16x32_bf16 v[176:179], v[32:35], v[76:79], v[176:179]
    ds_read_b128 v[116:119], v3 offset:26624
    v_mfma_f32_16x16x32_bf16 v[192:195], v[32:35], v[80:83], v[192:195]
    ds_read_b128 v[120:123], v3 offset:28672
    v_mfma_f32_16x16x32_bf16 v[196:199], v[36:39], v[80:83], v[196:199]
    ds_read_b128 v[124:127], v3 offset:30720
    v_mfma_f32_16x16x32_bf16 v[200:203], v[40:43], v[80:83], v[200:203]
    v_mfma_f32_16x16x32_bf16 v[204:207], v[44:47], v[80:83], v[204:207]
    v_mfma_f32_16x16x32_bf16 v[220:223], v[44:47], v[84:87], v[220:223]
    v_mfma_f32_16x16x32_bf16 v[216:219], v[40:43], v[84:87], v[216:219]
    v_mfma_f32_16x16x32_bf16 v[212:215], v[36:39], v[84:87], v[212:215]
    v_mfma_f32_16x16x32_bf16 v[208:211], v[32:35], v[84:87], v[208:211]
    v_mfma_f32_16x16x32_bf16 v[224:227], v[32:35], v[88:91], v[224:227]
    v_mfma_f32_16x16x32_bf16 v[228:231], v[36:39], v[88:91], v[228:231]
    v_mfma_f32_16x16x32_bf16 v[232:235], v[40:43], v[88:91], v[232:235]
    v_mfma_f32_16x16x32_bf16 v[236:239], v[44:47], v[88:91], v[236:239]
    v_mfma_f32_16x16x32_bf16 v[252:255], v[44:47], v[92:95], v[252:255]
    v_mfma_f32_16x16x32_bf16 v[248:251], v[40:43], v[92:95], v[248:251]
    v_mfma_f32_16x16x32_bf16 v[244:247], v[36:39], v[92:95], v[244:247]
    v_mfma_f32_16x16x32_bf16 v[240:243], v[32:35], v[92:95], v[240:243]
    s_waitcnt lgkmcnt(0)
    v_mfma_f32_16x16x32_bf16 v[128:131], v[48:51], v[96:99], v[128:131]
    v_mfma_f32_16x16x32_bf16 v[132:135], v[52:55], v[96:99], v[132:135]
    v_mfma_f32_16x16x32_bf16 v[136:139], v[56:59], v[96:99], v[136:139]
    v_mfma_f32_16x16x32_bf16 v[140:143], v[60:63], v[96:99], v[140:143]
    v_mfma_f32_16x16x32_bf16 v[156:159], v[60:63], v[100:103], v[156:159]
    v_mfma_f32_16x16x32_bf16 v[152:155], v[56:59], v[100:103], v[152:155]
    v_mfma_f32_16x16x32_bf16 v[148:151], v[52:55], v[100:103], v[148:151]
    v_mfma_f32_16x16x32_bf16 v[144:147], v[48:51], v[100:103], v[144:147]
    v_mfma_f32_16x16x32_bf16 v[160:163], v[48:51], v[104:107], v[160:163]
    v_mfma_f32_16x16x32_bf16 v[164:167], v[52:55], v[104:107], v[164:167]
    v_mfma_f32_16x16x32_bf16 v[168:171], v[56:59], v[104:107], v[168:171]
    v_mfma_f32_16x16x32_bf16 v[172:175], v[60:63], v[104:107], v[172:175]
    v_mfma_f32_16x16x32_bf16 v[188:191], v[60:63], v[108:111], v[188:191]
    v_mfma_f32_16x16x32_bf16 v[184:187], v[56:59], v[108:111], v[184:187]
    v_mfma_f32_16x16x32_bf16 v[180:183], v[52:55], v[108:111], v[180:183]
    v_mfma_f32_16x16x32_bf16 v[176:179], v[48:51], v[108:111], v[176:179]
    v_mfma_f32_16x16x32_bf16 v[192:195], v[48:51], v[112:115], v[192:195]
    v_mfma_f32_16x16x32_bf16 v[196:199], v[52:55], v[112:115], v[196:199]
    v_mfma_f32_16x16x32_bf16 v[200:203], v[56:59], v[112:115], v[200:203]
    v_mfma_f32_16x16x32_bf16 v[204:207], v[60:63], v[112:115], v[204:207]
    v_mfma_f32_16x16x32_bf16 v[220:223], v[60:63], v[116:119], v[220:223]
    v_mfma_f32_16x16x32_bf16 v[216:219], v[56:59], v[116:119], v[216:219]
    v_mfma_f32_16x16x32_bf16 v[212:215], v[52:55], v[116:119], v[212:215]
    v_mfma_f32_16x16x32_bf16 v[208:211], v[48:51], v[116:119], v[208:211]
    v_mfma_f32_16x16x32_bf16 v[224:227], v[48:51], v[120:123], v[224:227]
    v_mfma_f32_16x16x32_bf16 v[228:231], v[52:55], v[120:123], v[228:231]
    v_mfma_f32_16x16x32_bf16 v[232:235], v[56:59], v[120:123], v[232:235]
    v_mfma_f32_16x16x32_bf16 v[236:239], v[60:63], v[120:123], v[236:239]
    v_mfma_f32_16x16x32_bf16 v[252:255], v[60:63], v[124:127], v[252:255]
    v_mfma_f32_16x16x32_bf16 v[248:251], v[56:59], v[124:127], v[248:251]
    v_mfma_f32_16x16x32_bf16 v[244:247], v[52:55], v[124:127], v[244:247]
    v_mfma_f32_16x16x32_bf16 v[240:243], v[48:51], v[124:127], v[240:243]
    s_setprio 2
    v_mov_b32 v19, 0
    buffer_load_dword v18, v19, s[20:23], 0 offen sc1
    s_mul_i32 s28, s26, 112
    s_lshl_b32 s29, s27, 3
    s_add_u32 s28, s28, s29
    s_lshl_b32 s29, s3, 1
    s_add_u32 s28, s28, s29
    s_lshl_b32 s28, s28, 13
    s_add_u32 s57, s28, 8388608
    s_add_u32 s58, s57, 4096
    s_add_u32 s59, s57, 8192
    s_add_u32 s60, s57, 12288
    s_mov_b32 s40, 0x3fb8aa3b
    s_mov_b32 s41, 0x3fb8aa3b
    v_lshlrev_b32 v20, 4, v0
    v_pk_mul_f32 v[32:33], v[128:129], s[40:41]
    v_pk_mul_f32 v[34:35], v[130:131], s[40:41]
    v_pk_mul_f32 v[36:37], v[132:133], s[40:41]
    v_pk_mul_f32 v[38:39], v[134:135], s[40:41]
    v_exp_f32 v32, v32
    v_exp_f32 v33, v33
    v_exp_f32 v34, v34
    v_exp_f32 v35, v35
    v_exp_f32 v36, v36
    v_exp_f32 v37, v37
    v_exp_f32 v38, v38
    v_exp_f32 v39, v39
    v_pk_add_f32 v[40:41], v[32:33], 2.0 op_sel_hi:[1,0]
    v_pk_add_f32 v[42:43], v[34:35], 2.0 op_sel_hi:[1,0]
    v_pk_add_f32 v[44:45], v[36:37], 2.0 op_sel_hi:[1,0]
    v_pk_add_f32 v[46:47], v[38:39], 2.0 op_sel_hi:[1,0]
    v_pk_fma_f32 v[40:41], v[32:33], v[40:41], 2.0 op_sel_hi:[1,1,0]
    v_pk_fma_f32 v[42:43], v[34:35], v[42:43], 2.0 op_sel_hi:[1,1,0]
    v_pk_fma_f32 v[44:45], v[36:37], v[44:45], 2.0 op_sel_hi:[1,1,0]
    v_pk_fma_f32 v[46:47], v[38:39], v[46:47], 2.0 op_sel_hi:[1,1,0]
    v_rcp_f32 v40, v40
    v_rcp_f32 v41, v41
    v_rcp_f32 v42, v42
    v_rcp_f32 v43, v43
    v_rcp_f32 v44, v44
    v_rcp_f32 v45, v45
    v_rcp_f32 v46, v46
    v_rcp_f32 v47, v47
    v_pk_fma_f32 v[40:41], v[40:41], -2.0, 1.0 op_sel_hi:[1,0,0]
    v_pk_fma_f32 v[42:43], v[42:43], -2.0, 1.0 op_sel_hi:[1,0,0]
    v_pk_fma_f32 v[44:45], v[44:45], -2.0, 1.0 op_sel_hi:[1,0,0]
    v_pk_fma_f32 v[46:47], v[46:47], -2.0, 1.0 op_sel_hi:[1,0,0]
    v_pk_mul_f32 v[32:33], v[128:129], v[40:41]
    v_pk_mul_f32 v[34:35], v[130:131], v[42:43]
    v_pk_mul_f32 v[36:37], v[132:133], v[44:45]
    v_pk_mul_f32 v[38:39], v[134:135], v[46:47]
    v_cvt_pk_bf16_f32 v48, v32, v33
    v_cvt_pk_bf16_f32 v49, v34, v35
    v_cvt_pk_bf16_f32 v50, v36, v37
    v_cvt_pk_bf16_f32 v51, v38, v39
    buffer_store_dwordx4 v[48:51], v20, s[4:7], s57 offen offset:0 sc1
    v_pk_mul_f32 v[32:33], v[144:145], s[40:41]
    v_pk_mul_f32 v[34:35], v[146:147], s[40:41]
    v_pk_mul_f32 v[36:37], v[148:149], s[40:41]
    v_pk_mul_f32 v[38:39], v[150:151], s[40:41]
    v_exp_f32 v32, v32
    v_exp_f32 v33, v33
    v_exp_f32 v34, v34
    v_exp_f32 v35, v35
    v_exp_f32 v36, v36
    v_exp_f32 v37, v37
    v_exp_f32 v38, v38
    v_exp_f32 v39, v39
    v_pk_add_f32 v[40:41], v[32:33], 2.0 op_sel_hi:[1,0]
    v_pk_add_f32 v[42:43], v[34:35], 2.0 op_sel_hi:[1,0]
    v_pk_add_f32 v[44:45], v[36:37], 2.0 op_sel_hi:[1,0]
    v_pk_add_f32 v[46:47], v[38:39], 2.0 op_sel_hi:[1,0]
    v_pk_fma_f32 v[40:41], v[32:33], v[40:41], 2.0 op_sel_hi:[1,1,0]
    v_pk_fma_f32 v[42:43], v[34:35], v[42:43], 2.0 op_sel_hi:[1,1,0]
    v_pk_fma_f32 v[44:45], v[36:37], v[44:45], 2.0 op_sel_hi:[1,1,0]
    v_pk_fma_f32 v[46:47], v[38:39], v[46:47], 2.0 op_sel_hi:[1,1,0]
    v_rcp_f32 v40, v40
    v_rcp_f32 v41, v41
    v_rcp_f32 v42, v42
    v_rcp_f32 v43, v43
    v_rcp_f32 v44, v44
    v_rcp_f32 v45, v45
    v_rcp_f32 v46, v46
    v_rcp_f32 v47, v47
    v_pk_fma_f32 v[40:41], v[40:41], -2.0, 1.0 op_sel_hi:[1,0,0]
    v_pk_fma_f32 v[42:43], v[42:43], -2.0, 1.0 op_sel_hi:[1,0,0]
    v_pk_fma_f32 v[44:45], v[44:45], -2.0, 1.0 op_sel_hi:[1,0,0]
    v_pk_fma_f32 v[46:47], v[46:47], -2.0, 1.0 op_sel_hi:[1,0,0]
    v_pk_mul_f32 v[32:33], v[144:145], v[40:41]
    v_pk_mul_f32 v[34:35], v[146:147], v[42:43]
    v_pk_mul_f32 v[36:37], v[148:149], v[44:45]
    v_pk_mul_f32 v[38:39], v[150:151], v[46:47]
    v_cvt_pk_bf16_f32 v52, v32, v33
    v_cvt_pk_bf16_f32 v53, v34, v35
    v_cvt_pk_bf16_f32 v54, v36, v37
    v_cvt_pk_bf16_f32 v55, v38, v39
    buffer_store_dwordx4 v[52:55], v20, s[4:7], s57 offen offset:1024 sc1
    v_pk_mul_f32 v[32:33], v[160:161], s[40:41]
    v_pk_mul_f32 v[34:35], v[162:163], s[40:41]
    v_pk_mul_f32 v[36:37], v[164:165], s[40:41]
    v_pk_mul_f32 v[38:39], v[166:167], s[40:41]
    v_exp_f32 v32, v32
    v_exp_f32 v33, v33
    v_exp_f32 v34, v34
    v_exp_f32 v35, v35
    v_exp_f32 v36, v36
    v_exp_f32 v37, v37
    v_exp_f32 v38, v38
    v_exp_f32 v39, v39
    v_pk_add_f32 v[40:41], v[32:33], 2.0 op_sel_hi:[1,0]
    v_pk_add_f32 v[42:43], v[34:35], 2.0 op_sel_hi:[1,0]
    v_pk_add_f32 v[44:45], v[36:37], 2.0 op_sel_hi:[1,0]
    v_pk_add_f32 v[46:47], v[38:39], 2.0 op_sel_hi:[1,0]
    v_pk_fma_f32 v[40:41], v[32:33], v[40:41], 2.0 op_sel_hi:[1,1,0]
    v_pk_fma_f32 v[42:43], v[34:35], v[42:43], 2.0 op_sel_hi:[1,1,0]
    v_pk_fma_f32 v[44:45], v[36:37], v[44:45], 2.0 op_sel_hi:[1,1,0]
    v_pk_fma_f32 v[46:47], v[38:39], v[46:47], 2.0 op_sel_hi:[1,1,0]
    v_rcp_f32 v40, v40
    v_rcp_f32 v41, v41
    v_rcp_f32 v42, v42
    v_rcp_f32 v43, v43
    v_rcp_f32 v44, v44
    v_rcp_f32 v45, v45
    v_rcp_f32 v46, v46
    v_rcp_f32 v47, v47
    v_pk_fma_f32 v[40:41], v[40:41], -2.0, 1.0 op_sel_hi:[1,0,0]
    v_pk_fma_f32 v[42:43], v[42:43], -2.0, 1.0 op_sel_hi:[1,0,0]
    v_pk_fma_f32 v[44:45], v[44:45], -2.0, 1.0 op_sel_hi:[1,0,0]
    v_pk_fma_f32 v[46:47], v[46:47], -2.0, 1.0 op_sel_hi:[1,0,0]
    v_pk_mul_f32 v[32:33], v[160:161], v[40:41]
    v_pk_mul_f32 v[34:35], v[162:163], v[42:43]
    v_pk_mul_f32 v[36:37], v[164:165], v[44:45]
    v_pk_mul_f32 v[38:39], v[166:167], v[46:47]
    v_cvt_pk_bf16_f32 v56, v32, v33
    v_cvt_pk_bf16_f32 v57, v34, v35
    v_cvt_pk_bf16_f32 v58, v36, v37
    v_cvt_pk_bf16_f32 v59, v38, v39
    buffer_store_dwordx4 v[56:59], v20, s[4:7], s57 offen offset:2048 sc1
    v_pk_mul_f32 v[32:33], v[176:177], s[40:41]
    v_pk_mul_f32 v[34:35], v[178:179], s[40:41]
    v_pk_mul_f32 v[36:37], v[180:181], s[40:41]
    v_pk_mul_f32 v[38:39], v[182:183], s[40:41]
    v_exp_f32 v32, v32
    v_exp_f32 v33, v33
    v_exp_f32 v34, v34
    v_exp_f32 v35, v35
    v_exp_f32 v36, v36
    v_exp_f32 v37, v37
    v_exp_f32 v38, v38
    v_exp_f32 v39, v39
    v_pk_add_f32 v[40:41], v[32:33], 2.0 op_sel_hi:[1,0]
    v_pk_add_f32 v[42:43], v[34:35], 2.0 op_sel_hi:[1,0]
    v_pk_add_f32 v[44:45], v[36:37], 2.0 op_sel_hi:[1,0]
    v_pk_add_f32 v[46:47], v[38:39], 2.0 op_sel_hi:[1,0]
    v_pk_fma_f32 v[40:41], v[32:33], v[40:41], 2.0 op_sel_hi:[1,1,0]
    v_pk_fma_f32 v[42:43], v[34:35], v[42:43], 2.0 op_sel_hi:[1,1,0]
    v_pk_fma_f32 v[44:45], v[36:37], v[44:45], 2.0 op_sel_hi:[1,1,0]
    v_pk_fma_f32 v[46:47], v[38:39], v[46:47], 2.0 op_sel_hi:[1,1,0]
    v_rcp_f32 v40, v40
    v_rcp_f32 v41, v41
    v_rcp_f32 v42, v42
    v_rcp_f32 v43, v43
    v_rcp_f32 v44, v44
    v_rcp_f32 v45, v45
    v_rcp_f32 v46, v46
    v_rcp_f32 v47, v47
    v_pk_fma_f32 v[40:41], v[40:41], -2.0, 1.0 op_sel_hi:[1,0,0]
    v_pk_fma_f32 v[42:43], v[42:43], -2.0, 1.0 op_sel_hi:[1,0,0]
    v_pk_fma_f32 v[44:45], v[44:45], -2.0, 1.0 op_sel_hi:[1,0,0]
    v_pk_fma_f32 v[46:47], v[46:47], -2.0, 1.0 op_sel_hi:[1,0,0]
    v_pk_mul_f32 v[32:33], v[176:177], v[40:41]
    v_pk_mul_f32 v[34:35], v[178:179], v[42:43]
    v_pk_mul_f32 v[36:37], v[180:181], v[44:45]
    v_pk_mul_f32 v[38:39], v[182:183], v[46:47]
    v_cvt_pk_bf16_f32 v60, v32, v33
    v_cvt_pk_bf16_f32 v61, v34, v35
    v_cvt_pk_bf16_f32 v62, v36, v37
    v_cvt_pk_bf16_f32 v63, v38, v39
    buffer_store_dwordx4 v[60:63], v20, s[4:7], s57 offen offset:3072 sc1
    v_pk_mul_f32 v[32:33], v[192:193], s[40:41]
    v_pk_mul_f32 v[34:35], v[194:195], s[40:41]
    v_pk_mul_f32 v[36:37], v[196:197], s[40:41]
    v_pk_mul_f32 v[38:39], v[198:199], s[40:41]
    v_exp_f32 v32, v32
    v_exp_f32 v33, v33
    v_exp_f32 v34, v34
    v_exp_f32 v35, v35
    v_exp_f32 v36, v36
    v_exp_f32 v37, v37
    v_exp_f32 v38, v38
    v_exp_f32 v39, v39
    v_pk_add_f32 v[40:41], v[32:33], 2.0 op_sel_hi:[1,0]
    v_pk_add_f32 v[42:43], v[34:35], 2.0 op_sel_hi:[1,0]
    v_pk_add_f32 v[44:45], v[36:37], 2.0 op_sel_hi:[1,0]
    v_pk_add_f32 v[46:47], v[38:39], 2.0 op_sel_hi:[1,0]
    v_pk_fma_f32 v[40:41], v[32:33], v[40:41], 2.0 op_sel_hi:[1,1,0]
    v_pk_fma_f32 v[42:43], v[34:35], v[42:43], 2.0 op_sel_hi:[1,1,0]
    v_pk_fma_f32 v[44:45], v[36:37], v[44:45], 2.0 op_sel_hi:[1,1,0]
    v_pk_fma_f32 v[46:47], v[38:39], v[46:47], 2.0 op_sel_hi:[1,1,0]
    v_rcp_f32 v40, v40
    v_rcp_f32 v41, v41
    v_rcp_f32 v42, v42
    v_rcp_f32 v43, v43
    v_rcp_f32 v44, v44
    v_rcp_f32 v45, v45
    v_rcp_f32 v46, v46
    v_rcp_f32 v47, v47
    v_pk_fma_f32 v[40:41], v[40:41], -2.0, 1.0 op_sel_hi:[1,0,0]
    v_pk_fma_f32 v[42:43], v[42:43], -2.0, 1.0 op_sel_hi:[1,0,0]
    v_pk_fma_f32 v[44:45], v[44:45], -2.0, 1.0 op_sel_hi:[1,0,0]
    v_pk_fma_f32 v[46:47], v[46:47], -2.0, 1.0 op_sel_hi:[1,0,0]
    v_pk_mul_f32 v[32:33], v[192:193], v[40:41]
    v_pk_mul_f32 v[34:35], v[194:195], v[42:43]
    v_pk_mul_f32 v[36:37], v[196:197], v[44:45]
    v_pk_mul_f32 v[38:39], v[198:199], v[46:47]
    v_cvt_pk_bf16_f32 v48, v32, v33
    v_cvt_pk_bf16_f32 v49, v34, v35
    v_cvt_pk_bf16_f32 v50, v36, v37
    v_cvt_pk_bf16_f32 v51, v38, v39
    buffer_store_dwordx4 v[48:51], v20, s[4:7], s58 offen offset:0 sc1
    v_pk_mul_f32 v[32:33], v[208:209], s[40:41]
    v_pk_mul_f32 v[34:35], v[210:211], s[40:41]
    v_pk_mul_f32 v[36:37], v[212:213], s[40:41]
    v_pk_mul_f32 v[38:39], v[214:215], s[40:41]
    v_exp_f32 v32, v32
    v_exp_f32 v33, v33
    v_exp_f32 v34, v34
    v_exp_f32 v35, v35
    v_exp_f32 v36, v36
    v_exp_f32 v37, v37
    v_exp_f32 v38, v38
    v_exp_f32 v39, v39
    v_pk_add_f32 v[40:41], v[32:33], 2.0 op_sel_hi:[1,0]
    v_pk_add_f32 v[42:43], v[34:35], 2.0 op_sel_hi:[1,0]
    v_pk_add_f32 v[44:45], v[36:37], 2.0 op_sel_hi:[1,0]
    v_pk_add_f32 v[46:47], v[38:39], 2.0 op_sel_hi:[1,0]
    v_pk_fma_f32 v[40:41], v[32:33], v[40:41], 2.0 op_sel_hi:[1,1,0]
    v_pk_fma_f32 v[42:43], v[34:35], v[42:43], 2.0 op_sel_hi:[1,1,0]
    v_pk_fma_f32 v[44:45], v[36:37], v[44:45], 2.0 op_sel_hi:[1,1,0]
    v_pk_fma_f32 v[46:47], v[38:39], v[46:47], 2.0 op_sel_hi:[1,1,0]
    v_rcp_f32 v40, v40
    v_rcp_f32 v41, v41
    v_rcp_f32 v42, v42
    v_rcp_f32 v43, v43
    v_rcp_f32 v44, v44
    v_rcp_f32 v45, v45
    v_rcp_f32 v46, v46
    v_rcp_f32 v47, v47
    v_pk_fma_f32 v[40:41], v[40:41], -2.0, 1.0 op_sel_hi:[1,0,0]
    v_pk_fma_f32 v[42:43], v[42:43], -2.0, 1.0 op_sel_hi:[1,0,0]
    v_pk_fma_f32 v[44:45], v[44:45], -2.0, 1.0 op_sel_hi:[1,0,0]
    v_pk_fma_f32 v[46:47], v[46:47], -2.0, 1.0 op_sel_hi:[1,0,0]
    v_pk_mul_f32 v[32:33], v[208:209], v[40:41]
    v_pk_mul_f32 v[34:35], v[210:211], v[42:43]
    v_pk_mul_f32 v[36:37], v[212:213], v[44:45]
    v_pk_mul_f32 v[38:39], v[214:215], v[46:47]
    v_cvt_pk_bf16_f32 v52, v32, v33
    v_cvt_pk_bf16_f32 v53, v34, v35
    v_cvt_pk_bf16_f32 v54, v36, v37
    v_cvt_pk_bf16_f32 v55, v38, v39
    buffer_store_dwordx4 v[52:55], v20, s[4:7], s58 offen offset:1024 sc1
    v_pk_mul_f32 v[32:33], v[224:225], s[40:41]
    v_pk_mul_f32 v[34:35], v[226:227], s[40:41]
    v_pk_mul_f32 v[36:37], v[228:229], s[40:41]
    v_pk_mul_f32 v[38:39], v[230:231], s[40:41]
    v_exp_f32 v32, v32
    v_exp_f32 v33, v33
    v_exp_f32 v34, v34
    v_exp_f32 v35, v35
    v_exp_f32 v36, v36
    v_exp_f32 v37, v37
    v_exp_f32 v38, v38
    v_exp_f32 v39, v39
    v_pk_add_f32 v[40:41], v[32:33], 2.0 op_sel_hi:[1,0]
    v_pk_add_f32 v[42:43], v[34:35], 2.0 op_sel_hi:[1,0]
    v_pk_add_f32 v[44:45], v[36:37], 2.0 op_sel_hi:[1,0]
    v_pk_add_f32 v[46:47], v[38:39], 2.0 op_sel_hi:[1,0]
    v_pk_fma_f32 v[40:41], v[32:33], v[40:41], 2.0 op_sel_hi:[1,1,0]
    v_pk_fma_f32 v[42:43], v[34:35], v[42:43], 2.0 op_sel_hi:[1,1,0]
    v_pk_fma_f32 v[44:45], v[36:37], v[44:45], 2.0 op_sel_hi:[1,1,0]
    v_pk_fma_f32 v[46:47], v[38:39], v[46:47], 2.0 op_sel_hi:[1,1,0]
    v_rcp_f32 v40, v40
    v_rcp_f32 v41, v41
    v_rcp_f32 v42, v42
    v_rcp_f32 v43, v43
    v_rcp_f32 v44, v44
    v_rcp_f32 v45, v45
    v_rcp_f32 v46, v46
    v_rcp_f32 v47, v47
    v_pk_fma_f32 v[40:41], v[40:41], -2.0, 1.0 op_sel_hi:[1,0,0]
    v_pk_fma_f32 v[42:43], v[42:43], -2.0, 1.0 op_sel_hi:[1,0,0]
    v_pk_fma_f32 v[44:45], v[44:45], -2.0, 1.0 op_sel_hi:[1,0,0]
    v_pk_fma_f32 v[46:47], v[46:47], -2.0, 1.0 op_sel_hi:[1,0,0]
    v_pk_mul_f32 v[32:33], v[224:225], v[40:41]
    v_pk_mul_f32 v[34:35], v[226:227], v[42:43]
    v_pk_mul_f32 v[36:37], v[228:229], v[44:45]
    v_pk_mul_f32 v[38:39], v[230:231], v[46:47]
    v_cvt_pk_bf16_f32 v56, v32, v33
    v_cvt_pk_bf16_f32 v57, v34, v35
    v_cvt_pk_bf16_f32 v58, v36, v37
    v_cvt_pk_bf16_f32 v59, v38, v39
    buffer_store_dwordx4 v[56:59], v20, s[4:7], s58 offen offset:2048 sc1
    v_pk_mul_f32 v[32:33], v[240:241], s[40:41]
    v_pk_mul_f32 v[34:35], v[242:243], s[40:41]
    v_pk_mul_f32 v[36:37], v[244:245], s[40:41]
    v_pk_mul_f32 v[38:39], v[246:247], s[40:41]
    v_exp_f32 v32, v32
    v_exp_f32 v33, v33
    v_exp_f32 v34, v34
    v_exp_f32 v35, v35
    v_exp_f32 v36, v36
    v_exp_f32 v37, v37
    v_exp_f32 v38, v38
    v_exp_f32 v39, v39
    v_pk_add_f32 v[40:41], v[32:33], 2.0 op_sel_hi:[1,0]
    v_pk_add_f32 v[42:43], v[34:35], 2.0 op_sel_hi:[1,0]
    v_pk_add_f32 v[44:45], v[36:37], 2.0 op_sel_hi:[1,0]
    v_pk_add_f32 v[46:47], v[38:39], 2.0 op_sel_hi:[1,0]
    v_pk_fma_f32 v[40:41], v[32:33], v[40:41], 2.0 op_sel_hi:[1,1,0]
    v_pk_fma_f32 v[42:43], v[34:35], v[42:43], 2.0 op_sel_hi:[1,1,0]
    v_pk_fma_f32 v[44:45], v[36:37], v[44:45], 2.0 op_sel_hi:[1,1,0]
    v_pk_fma_f32 v[46:47], v[38:39], v[46:47], 2.0 op_sel_hi:[1,1,0]
    v_rcp_f32 v40, v40
    v_rcp_f32 v41, v41
    v_rcp_f32 v42, v42
    v_rcp_f32 v43, v43
    v_rcp_f32 v44, v44
    v_rcp_f32 v45, v45
    v_rcp_f32 v46, v46
    v_rcp_f32 v47, v47
    v_pk_fma_f32 v[40:41], v[40:41], -2.0, 1.0 op_sel_hi:[1,0,0]
    v_pk_fma_f32 v[42:43], v[42:43], -2.0, 1.0 op_sel_hi:[1,0,0]
    v_pk_fma_f32 v[44:45], v[44:45], -2.0, 1.0 op_sel_hi:[1,0,0]
    v_pk_fma_f32 v[46:47], v[46:47], -2.0, 1.0 op_sel_hi:[1,0,0]
    v_pk_mul_f32 v[32:33], v[240:241], v[40:41]
    v_pk_mul_f32 v[34:35], v[242:243], v[42:43]
    v_pk_mul_f32 v[36:37], v[244:245], v[44:45]
    v_pk_mul_f32 v[38:39], v[246:247], v[46:47]
    v_cvt_pk_bf16_f32 v60, v32, v33
    v_cvt_pk_bf16_f32 v61, v34, v35
    v_cvt_pk_bf16_f32 v62, v36, v37
    v_cvt_pk_bf16_f32 v63, v38, v39
    buffer_store_dwordx4 v[60:63], v20, s[4:7], s58 offen offset:3072 sc1
    v_pk_mul_f32 v[32:33], v[136:137], s[40:41]
    v_pk_mul_f32 v[34:35], v[138:139], s[40:41]
    v_pk_mul_f32 v[36:37], v[140:141], s[40:41]
    v_pk_mul_f32 v[38:39], v[142:143], s[40:41]
    v_exp_f32 v32, v32
    v_exp_f32 v33, v33
    v_exp_f32 v34, v34
    v_exp_f32 v35, v35
    v_exp_f32 v36, v36
    v_exp_f32 v37, v37
    v_exp_f32 v38, v38
    v_exp_f32 v39, v39
    v_pk_add_f32 v[40:41], v[32:33], 2.0 op_sel_hi:[1,0]
    v_pk_add_f32 v[42:43], v[34:35], 2.0 op_sel_hi:[1,0]
    v_pk_add_f32 v[44:45], v[36:37], 2.0 op_sel_hi:[1,0]
    v_pk_add_f32 v[46:47], v[38:39], 2.0 op_sel_hi:[1,0]
    v_pk_fma_f32 v[40:41], v[32:33], v[40:41], 2.0 op_sel_hi:[1,1,0]
    v_pk_fma_f32 v[42:43], v[34:35], v[42:43], 2.0 op_sel_hi:[1,1,0]
    v_pk_fma_f32 v[44:45], v[36:37], v[44:45], 2.0 op_sel_hi:[1,1,0]
    v_pk_fma_f32 v[46:47], v[38:39], v[46:47], 2.0 op_sel_hi:[1,1,0]
    v_rcp_f32 v40, v40
    v_rcp_f32 v41, v41
    v_rcp_f32 v42, v42
    v_rcp_f32 v43, v43
    v_rcp_f32 v44, v44
    v_rcp_f32 v45, v45
    v_rcp_f32 v46, v46
    v_rcp_f32 v47, v47
    v_pk_fma_f32 v[40:41], v[40:41], -2.0, 1.0 op_sel_hi:[1,0,0]
    v_pk_fma_f32 v[42:43], v[42:43], -2.0, 1.0 op_sel_hi:[1,0,0]
    v_pk_fma_f32 v[44:45], v[44:45], -2.0, 1.0 op_sel_hi:[1,0,0]
    v_pk_fma_f32 v[46:47], v[46:47], -2.0, 1.0 op_sel_hi:[1,0,0]
    v_pk_mul_f32 v[32:33], v[136:137], v[40:41]
    v_pk_mul_f32 v[34:35], v[138:139], v[42:43]
    v_pk_mul_f32 v[36:37], v[140:141], v[44:45]
    v_pk_mul_f32 v[38:39], v[142:143], v[46:47]
    v_cvt_pk_bf16_f32 v48, v32, v33
    v_cvt_pk_bf16_f32 v49, v34, v35
    v_cvt_pk_bf16_f32 v50, v36, v37
    v_cvt_pk_bf16_f32 v51, v38, v39
    buffer_store_dwordx4 v[48:51], v20, s[4:7], s59 offen offset:0 sc1
    v_pk_mul_f32 v[32:33], v[152:153], s[40:41]
    v_pk_mul_f32 v[34:35], v[154:155], s[40:41]
    v_pk_mul_f32 v[36:37], v[156:157], s[40:41]
    v_pk_mul_f32 v[38:39], v[158:159], s[40:41]
    v_exp_f32 v32, v32
    v_exp_f32 v33, v33
    v_exp_f32 v34, v34
    v_exp_f32 v35, v35
    v_exp_f32 v36, v36
    v_exp_f32 v37, v37
    v_exp_f32 v38, v38
    v_exp_f32 v39, v39
    v_pk_add_f32 v[40:41], v[32:33], 2.0 op_sel_hi:[1,0]
    v_pk_add_f32 v[42:43], v[34:35], 2.0 op_sel_hi:[1,0]
    v_pk_add_f32 v[44:45], v[36:37], 2.0 op_sel_hi:[1,0]
    v_pk_add_f32 v[46:47], v[38:39], 2.0 op_sel_hi:[1,0]
    v_pk_fma_f32 v[40:41], v[32:33], v[40:41], 2.0 op_sel_hi:[1,1,0]
    v_pk_fma_f32 v[42:43], v[34:35], v[42:43], 2.0 op_sel_hi:[1,1,0]
    v_pk_fma_f32 v[44:45], v[36:37], v[44:45], 2.0 op_sel_hi:[1,1,0]
    v_pk_fma_f32 v[46:47], v[38:39], v[46:47], 2.0 op_sel_hi:[1,1,0]
    v_rcp_f32 v40, v40
    v_rcp_f32 v41, v41
    v_rcp_f32 v42, v42
    v_rcp_f32 v43, v43
    v_rcp_f32 v44, v44
    v_rcp_f32 v45, v45
    v_rcp_f32 v46, v46
    v_rcp_f32 v47, v47
    v_pk_fma_f32 v[40:41], v[40:41], -2.0, 1.0 op_sel_hi:[1,0,0]
    v_pk_fma_f32 v[42:43], v[42:43], -2.0, 1.0 op_sel_hi:[1,0,0]
    v_pk_fma_f32 v[44:45], v[44:45], -2.0, 1.0 op_sel_hi:[1,0,0]
    v_pk_fma_f32 v[46:47], v[46:47], -2.0, 1.0 op_sel_hi:[1,0,0]
    v_pk_mul_f32 v[32:33], v[152:153], v[40:41]
    v_pk_mul_f32 v[34:35], v[154:155], v[42:43]
    v_pk_mul_f32 v[36:37], v[156:157], v[44:45]
    v_pk_mul_f32 v[38:39], v[158:159], v[46:47]
    v_cvt_pk_bf16_f32 v52, v32, v33
    v_cvt_pk_bf16_f32 v53, v34, v35
    v_cvt_pk_bf16_f32 v54, v36, v37
    v_cvt_pk_bf16_f32 v55, v38, v39
    buffer_store_dwordx4 v[52:55], v20, s[4:7], s59 offen offset:1024 sc1
    v_pk_mul_f32 v[32:33], v[168:169], s[40:41]
    v_pk_mul_f32 v[34:35], v[170:171], s[40:41]
    v_pk_mul_f32 v[36:37], v[172:173], s[40:41]
    v_pk_mul_f32 v[38:39], v[174:175], s[40:41]
    v_exp_f32 v32, v32
    v_exp_f32 v33, v33
    v_exp_f32 v34, v34
    v_exp_f32 v35, v35
    v_exp_f32 v36, v36
    v_exp_f32 v37, v37
    v_exp_f32 v38, v38
    v_exp_f32 v39, v39
    v_pk_add_f32 v[40:41], v[32:33], 2.0 op_sel_hi:[1,0]
    v_pk_add_f32 v[42:43], v[34:35], 2.0 op_sel_hi:[1,0]
    v_pk_add_f32 v[44:45], v[36:37], 2.0 op_sel_hi:[1,0]
    v_pk_add_f32 v[46:47], v[38:39], 2.0 op_sel_hi:[1,0]
    v_pk_fma_f32 v[40:41], v[32:33], v[40:41], 2.0 op_sel_hi:[1,1,0]
    v_pk_fma_f32 v[42:43], v[34:35], v[42:43], 2.0 op_sel_hi:[1,1,0]
    v_pk_fma_f32 v[44:45], v[36:37], v[44:45], 2.0 op_sel_hi:[1,1,0]
    v_pk_fma_f32 v[46:47], v[38:39], v[46:47], 2.0 op_sel_hi:[1,1,0]
    v_rcp_f32 v40, v40
    v_rcp_f32 v41, v41
    v_rcp_f32 v42, v42
    v_rcp_f32 v43, v43
    v_rcp_f32 v44, v44
    v_rcp_f32 v45, v45
    v_rcp_f32 v46, v46
    v_rcp_f32 v47, v47
    v_pk_fma_f32 v[40:41], v[40:41], -2.0, 1.0 op_sel_hi:[1,0,0]
    v_pk_fma_f32 v[42:43], v[42:43], -2.0, 1.0 op_sel_hi:[1,0,0]
    v_pk_fma_f32 v[44:45], v[44:45], -2.0, 1.0 op_sel_hi:[1,0,0]
    v_pk_fma_f32 v[46:47], v[46:47], -2.0, 1.0 op_sel_hi:[1,0,0]
    v_pk_mul_f32 v[32:33], v[168:169], v[40:41]
    v_pk_mul_f32 v[34:35], v[170:171], v[42:43]
    v_pk_mul_f32 v[36:37], v[172:173], v[44:45]
    v_pk_mul_f32 v[38:39], v[174:175], v[46:47]
    v_cvt_pk_bf16_f32 v56, v32, v33
    v_cvt_pk_bf16_f32 v57, v34, v35
    v_cvt_pk_bf16_f32 v58, v36, v37
    v_cvt_pk_bf16_f32 v59, v38, v39
    buffer_store_dwordx4 v[56:59], v20, s[4:7], s59 offen offset:2048 sc1
    v_pk_mul_f32 v[32:33], v[184:185], s[40:41]
    v_pk_mul_f32 v[34:35], v[186:187], s[40:41]
    v_pk_mul_f32 v[36:37], v[188:189], s[40:41]
    v_pk_mul_f32 v[38:39], v[190:191], s[40:41]
    v_exp_f32 v32, v32
    v_exp_f32 v33, v33
    v_exp_f32 v34, v34
    v_exp_f32 v35, v35
    v_exp_f32 v36, v36
    v_exp_f32 v37, v37
    v_exp_f32 v38, v38
    v_exp_f32 v39, v39
    v_pk_add_f32 v[40:41], v[32:33], 2.0 op_sel_hi:[1,0]
    v_pk_add_f32 v[42:43], v[34:35], 2.0 op_sel_hi:[1,0]
    v_pk_add_f32 v[44:45], v[36:37], 2.0 op_sel_hi:[1,0]
    v_pk_add_f32 v[46:47], v[38:39], 2.0 op_sel_hi:[1,0]
    v_pk_fma_f32 v[40:41], v[32:33], v[40:41], 2.0 op_sel_hi:[1,1,0]
    v_pk_fma_f32 v[42:43], v[34:35], v[42:43], 2.0 op_sel_hi:[1,1,0]
    v_pk_fma_f32 v[44:45], v[36:37], v[44:45], 2.0 op_sel_hi:[1,1,0]
    v_pk_fma_f32 v[46:47], v[38:39], v[46:47], 2.0 op_sel_hi:[1,1,0]
    v_rcp_f32 v40, v40
    v_rcp_f32 v41, v41
    v_rcp_f32 v42, v42
    v_rcp_f32 v43, v43
    v_rcp_f32 v44, v44
    v_rcp_f32 v45, v45
    v_rcp_f32 v46, v46
    v_rcp_f32 v47, v47
    v_pk_fma_f32 v[40:41], v[40:41], -2.0, 1.0 op_sel_hi:[1,0,0]
    v_pk_fma_f32 v[42:43], v[42:43], -2.0, 1.0 op_sel_hi:[1,0,0]
    v_pk_fma_f32 v[44:45], v[44:45], -2.0, 1.0 op_sel_hi:[1,0,0]
    v_pk_fma_f32 v[46:47], v[46:47], -2.0, 1.0 op_sel_hi:[1,0,0]
    v_pk_mul_f32 v[32:33], v[184:185], v[40:41]
    v_pk_mul_f32 v[34:35], v[186:187], v[42:43]
    v_pk_mul_f32 v[36:37], v[188:189], v[44:45]
    v_pk_mul_f32 v[38:39], v[190:191], v[46:47]
    v_cvt_pk_bf16_f32 v60, v32, v33
    v_cvt_pk_bf16_f32 v61, v34, v35
    v_cvt_pk_bf16_f32 v62, v36, v37
    v_cvt_pk_bf16_f32 v63, v38, v39
    buffer_store_dwordx4 v[60:63], v20, s[4:7], s59 offen offset:3072 sc1
    v_pk_mul_f32 v[32:33], v[200:201], s[40:41]
    v_pk_mul_f32 v[34:35], v[202:203], s[40:41]
    v_pk_mul_f32 v[36:37], v[204:205], s[40:41]
    v_pk_mul_f32 v[38:39], v[206:207], s[40:41]
    v_exp_f32 v32, v32
    v_exp_f32 v33, v33
    v_exp_f32 v34, v34
    v_exp_f32 v35, v35
    v_exp_f32 v36, v36
    v_exp_f32 v37, v37
    v_exp_f32 v38, v38
    v_exp_f32 v39, v39
    v_pk_add_f32 v[40:41], v[32:33], 2.0 op_sel_hi:[1,0]
    v_pk_add_f32 v[42:43], v[34:35], 2.0 op_sel_hi:[1,0]
    v_pk_add_f32 v[44:45], v[36:37], 2.0 op_sel_hi:[1,0]
    v_pk_add_f32 v[46:47], v[38:39], 2.0 op_sel_hi:[1,0]
    v_pk_fma_f32 v[40:41], v[32:33], v[40:41], 2.0 op_sel_hi:[1,1,0]
    v_pk_fma_f32 v[42:43], v[34:35], v[42:43], 2.0 op_sel_hi:[1,1,0]
    v_pk_fma_f32 v[44:45], v[36:37], v[44:45], 2.0 op_sel_hi:[1,1,0]
    v_pk_fma_f32 v[46:47], v[38:39], v[46:47], 2.0 op_sel_hi:[1,1,0]
    v_rcp_f32 v40, v40
    v_rcp_f32 v41, v41
    v_rcp_f32 v42, v42
    v_rcp_f32 v43, v43
    v_rcp_f32 v44, v44
    v_rcp_f32 v45, v45
    v_rcp_f32 v46, v46
    v_rcp_f32 v47, v47
    v_pk_fma_f32 v[40:41], v[40:41], -2.0, 1.0 op_sel_hi:[1,0,0]
    v_pk_fma_f32 v[42:43], v[42:43], -2.0, 1.0 op_sel_hi:[1,0,0]
    v_pk_fma_f32 v[44:45], v[44:45], -2.0, 1.0 op_sel_hi:[1,0,0]
    v_pk_fma_f32 v[46:47], v[46:47], -2.0, 1.0 op_sel_hi:[1,0,0]
    v_pk_mul_f32 v[32:33], v[200:201], v[40:41]
    v_pk_mul_f32 v[34:35], v[202:203], v[42:43]
    v_pk_mul_f32 v[36:37], v[204:205], v[44:45]
    v_pk_mul_f32 v[38:39], v[206:207], v[46:47]
    v_cvt_pk_bf16_f32 v48, v32, v33
    v_cvt_pk_bf16_f32 v49, v34, v35
    v_cvt_pk_bf16_f32 v50, v36, v37
    v_cvt_pk_bf16_f32 v51, v38, v39
    buffer_store_dwordx4 v[48:51], v20, s[4:7], s60 offen offset:0 sc1
    v_pk_mul_f32 v[32:33], v[216:217], s[40:41]
    v_pk_mul_f32 v[34:35], v[218:219], s[40:41]
    v_pk_mul_f32 v[36:37], v[220:221], s[40:41]
    v_pk_mul_f32 v[38:39], v[222:223], s[40:41]
    v_exp_f32 v32, v32
    v_exp_f32 v33, v33
    v_exp_f32 v34, v34
    v_exp_f32 v35, v35
    v_exp_f32 v36, v36
    v_exp_f32 v37, v37
    v_exp_f32 v38, v38
    v_exp_f32 v39, v39
    v_pk_add_f32 v[40:41], v[32:33], 2.0 op_sel_hi:[1,0]
    v_pk_add_f32 v[42:43], v[34:35], 2.0 op_sel_hi:[1,0]
    v_pk_add_f32 v[44:45], v[36:37], 2.0 op_sel_hi:[1,0]
    v_pk_add_f32 v[46:47], v[38:39], 2.0 op_sel_hi:[1,0]
    v_pk_fma_f32 v[40:41], v[32:33], v[40:41], 2.0 op_sel_hi:[1,1,0]
    v_pk_fma_f32 v[42:43], v[34:35], v[42:43], 2.0 op_sel_hi:[1,1,0]
    v_pk_fma_f32 v[44:45], v[36:37], v[44:45], 2.0 op_sel_hi:[1,1,0]
    v_pk_fma_f32 v[46:47], v[38:39], v[46:47], 2.0 op_sel_hi:[1,1,0]
    v_rcp_f32 v40, v40
    v_rcp_f32 v41, v41
    v_rcp_f32 v42, v42
    v_rcp_f32 v43, v43
    v_rcp_f32 v44, v44
    v_rcp_f32 v45, v45
    v_rcp_f32 v46, v46
    v_rcp_f32 v47, v47
    v_pk_fma_f32 v[40:41], v[40:41], -2.0, 1.0 op_sel_hi:[1,0,0]
    v_pk_fma_f32 v[42:43], v[42:43], -2.0, 1.0 op_sel_hi:[1,0,0]
    v_pk_fma_f32 v[44:45], v[44:45], -2.0, 1.0 op_sel_hi:[1,0,0]
    v_pk_fma_f32 v[46:47], v[46:47], -2.0, 1.0 op_sel_hi:[1,0,0]
    v_pk_mul_f32 v[32:33], v[216:217], v[40:41]
    v_pk_mul_f32 v[34:35], v[218:219], v[42:43]
    v_pk_mul_f32 v[36:37], v[220:221], v[44:45]
    v_pk_mul_f32 v[38:39], v[222:223], v[46:47]
    v_cvt_pk_bf16_f32 v52, v32, v33
    v_cvt_pk_bf16_f32 v53, v34, v35
    v_cvt_pk_bf16_f32 v54, v36, v37
    v_cvt_pk_bf16_f32 v55, v38, v39
    buffer_store_dwordx4 v[52:55], v20, s[4:7], s60 offen offset:1024 sc1
    v_pk_mul_f32 v[32:33], v[232:233], s[40:41]
    v_pk_mul_f32 v[34:35], v[234:235], s[40:41]
    v_pk_mul_f32 v[36:37], v[236:237], s[40:41]
    v_pk_mul_f32 v[38:39], v[238:239], s[40:41]
    v_exp_f32 v32, v32
    v_exp_f32 v33, v33
    v_exp_f32 v34, v34
    v_exp_f32 v35, v35
    v_exp_f32 v36, v36
    v_exp_f32 v37, v37
    v_exp_f32 v38, v38
    v_exp_f32 v39, v39
    v_pk_add_f32 v[40:41], v[32:33], 2.0 op_sel_hi:[1,0]
    v_pk_add_f32 v[42:43], v[34:35], 2.0 op_sel_hi:[1,0]
    v_pk_add_f32 v[44:45], v[36:37], 2.0 op_sel_hi:[1,0]
    v_pk_add_f32 v[46:47], v[38:39], 2.0 op_sel_hi:[1,0]
    v_pk_fma_f32 v[40:41], v[32:33], v[40:41], 2.0 op_sel_hi:[1,1,0]
    v_pk_fma_f32 v[42:43], v[34:35], v[42:43], 2.0 op_sel_hi:[1,1,0]
    v_pk_fma_f32 v[44:45], v[36:37], v[44:45], 2.0 op_sel_hi:[1,1,0]
    v_pk_fma_f32 v[46:47], v[38:39], v[46:47], 2.0 op_sel_hi:[1,1,0]
    v_rcp_f32 v40, v40
    v_rcp_f32 v41, v41
    v_rcp_f32 v42, v42
    v_rcp_f32 v43, v43
    v_rcp_f32 v44, v44
    v_rcp_f32 v45, v45
    v_rcp_f32 v46, v46
    v_rcp_f32 v47, v47
    v_pk_fma_f32 v[40:41], v[40:41], -2.0, 1.0 op_sel_hi:[1,0,0]
    v_pk_fma_f32 v[42:43], v[42:43], -2.0, 1.0 op_sel_hi:[1,0,0]
    v_pk_fma_f32 v[44:45], v[44:45], -2.0, 1.0 op_sel_hi:[1,0,0]
    v_pk_fma_f32 v[46:47], v[46:47], -2.0, 1.0 op_sel_hi:[1,0,0]
    v_pk_mul_f32 v[32:33], v[232:233], v[40:41]
    v_pk_mul_f32 v[34:35], v[234:235], v[42:43]
    v_pk_mul_f32 v[36:37], v[236:237], v[44:45]
    v_pk_mul_f32 v[38:39], v[238:239], v[46:47]
    v_cvt_pk_bf16_f32 v56, v32, v33
    v_cvt_pk_bf16_f32 v57, v34, v35
    v_cvt_pk_bf16_f32 v58, v36, v37
    v_cvt_pk_bf16_f32 v59, v38, v39
    buffer_store_dwordx4 v[56:59], v20, s[4:7], s60 offen offset:2048 sc1
    v_pk_mul_f32 v[32:33], v[248:249], s[40:41]
    v_pk_mul_f32 v[34:35], v[250:251], s[40:41]
    v_pk_mul_f32 v[36:37], v[252:253], s[40:41]
    v_pk_mul_f32 v[38:39], v[254:255], s[40:41]
    v_exp_f32 v32, v32
    v_exp_f32 v33, v33
    v_exp_f32 v34, v34
    v_exp_f32 v35, v35
    v_exp_f32 v36, v36
    v_exp_f32 v37, v37
    v_exp_f32 v38, v38
    v_exp_f32 v39, v39
    v_pk_add_f32 v[40:41], v[32:33], 2.0 op_sel_hi:[1,0]
    v_pk_add_f32 v[42:43], v[34:35], 2.0 op_sel_hi:[1,0]
    v_pk_add_f32 v[44:45], v[36:37], 2.0 op_sel_hi:[1,0]
    v_pk_add_f32 v[46:47], v[38:39], 2.0 op_sel_hi:[1,0]
    v_pk_fma_f32 v[40:41], v[32:33], v[40:41], 2.0 op_sel_hi:[1,1,0]
    v_pk_fma_f32 v[42:43], v[34:35], v[42:43], 2.0 op_sel_hi:[1,1,0]
    v_pk_fma_f32 v[44:45], v[36:37], v[44:45], 2.0 op_sel_hi:[1,1,0]
    v_pk_fma_f32 v[46:47], v[38:39], v[46:47], 2.0 op_sel_hi:[1,1,0]
    v_rcp_f32 v40, v40
    v_rcp_f32 v41, v41
    v_rcp_f32 v42, v42
    v_rcp_f32 v43, v43
    v_rcp_f32 v44, v44
    v_rcp_f32 v45, v45
    v_rcp_f32 v46, v46
    v_rcp_f32 v47, v47
    v_pk_fma_f32 v[40:41], v[40:41], -2.0, 1.0 op_sel_hi:[1,0,0]
    v_pk_fma_f32 v[42:43], v[42:43], -2.0, 1.0 op_sel_hi:[1,0,0]
    v_pk_fma_f32 v[44:45], v[44:45], -2.0, 1.0 op_sel_hi:[1,0,0]
    v_pk_fma_f32 v[46:47], v[46:47], -2.0, 1.0 op_sel_hi:[1,0,0]
    v_pk_mul_f32 v[32:33], v[248:249], v[40:41]
    v_pk_mul_f32 v[34:35], v[250:251], v[42:43]
    v_pk_mul_f32 v[36:37], v[252:253], v[44:45]
    v_pk_mul_f32 v[38:39], v[254:255], v[46:47]
    v_cvt_pk_bf16_f32 v60, v32, v33
    v_cvt_pk_bf16_f32 v61, v34, v35
    v_cvt_pk_bf16_f32 v62, v36, v37
    v_cvt_pk_bf16_f32 v63, v38, v39
    buffer_store_dwordx4 v[60:63], v20, s[4:7], s60 offen offset:3072 sc1
    s_lshl_b32 s28, s26, 7
    s_lshl_b32 s29, s27, 2
    s_add_u32 s28, s28, s29
    s_add_u32 s28, s28, 128
    s_waitcnt vmcnt(0) lgkmcnt(0)
    s_cmp_lg_u32 s3, 0
    s_cbranch_scc1 L_sig0_4
    v_readfirstlane_b32 s31, v18
    s_nop 2
    s_cmp_lg_u32 s31, 0
    s_cbranch_scc1 L_rdyok_5
    v_mov_b32 v22, 0
    s_bfm_b64 exec, 1, 0
    s_mov_b32 s39, 200000
L_poll_6:
    buffer_load_dword v18, v22, s[20:23], 0 offen sc1
    s_waitcnt vmcnt(0)
    v_cmp_ne_u32 vcc, 0, v18
    s_nop 3
    s_cmp_eq_u64 vcc, exec
    s_cbranch_scc1 L_polld_7
    s_sleep 4
    s_sub_u32 s39, s39, 1
    s_cmp_lg_u32 s39, 0
    s_cbranch_scc1 L_poll_6
L_polld_7:
    s_mov_b64 exec, -1
L_rdyok_5:
L_sig0_4:
    s_barrier
    s_cmp_lg_u32 s3, 0
    s_cbranch_scc1 L_sig_3
    v_mov_b32 v21, 1
    v_mov_b32 v22, 0
    s_mov_b64 exec, 1
    buffer_store_dword v21, v22, s[4:7], s28 offen sc1
    s_mov_b64 exec, -1
L_sig_3:
    s_branch L_final
L_kv:
    s_setprio 3
    s_mov_b32 s12, s76
    s_mov_b32 s13, s77
    s_mov_b32 s14, 65536
    s_mov_b32 s15, 0x20000
    s_mov_b32 s16, s78
    s_mov_b32 s17, s79
    s_mov_b32 s18, 65536
    s_mov_b32 s19, 0x20000
    s_mov_b32 s44, s90
    s_mov_b32 s45, s91
    s_mov_b32 s46, 2048
    s_mov_b32 s47, 0x20000
    s_sub_u32 s28, s25, 28
    s_lshl_b32 s28, s28, 3
    s_add_u32 s27, s28, s24
    v_lshrrev_b32 v48, 3, v0
    v_lshlrev_b32 v48, 11, v48
    v_lshrrev_b32 v49, 4, v0
    v_and_b32 v50, 7, v0
    v_xor_b32 v49, v49, v50
    v_xor_b32 v50, 0, v49
    v_lshlrev_b32 v50, 4, v50
    v_add_u32 v50, v48, v50
    v_add_u32 v8, 0, v50
    v_xor_b32 v50, 4, v49
    v_lshlrev_b32 v50, 4, v50
    v_add_u32 v50, v48, v50
    v_add_u32 v9, 15360, v50
    v_lshlrev_b32 v14, 4, v0
    s_lshl_b32 s28, s27, 2
    s_add_u32 s28, s28, s3
    s_lshl_b32 s34, s28, 15
    s_lshl_b32 s36, s3, 11
    s_lshl_b32 s35, s3, 10
    s_add_u32 s37, s35, 8192
    s_waitcnt lgkmcnt(0)
    s_lshr_b32 s28, s27, 3
    s_lshl_b32 s28, s28, 2
    s_lshr_b32 s29, s27, 1
    s_and_b32 s29, s29, 3
    s_add_u32 s61, s28, s29
    s_mov_b32 s61, 0
    s_and_b32 s28, s3, 1
    s_lshl_b32 s28, s28, 10
    s_add_u32 m0, s28, 65536
    s_nop 0
    buffer_load_dwordx4 v14, s[44:47], s28 offen lds
    s_add_u32 m0, s36, 0
    s_add_u32 s30, s34, 0
    buffer_load_dwordx4 v8, s[8:11], s30 offen offset:0 lds
    buffer_load_dwordx4 v9, s[8:11], s30 offen offset:1024 lds
    s_add_u32 m0, s37, 0
    s_add_u32 s30, s35, 0
    buffer_load_dwordx4 v14, s[12:15], s30 offen lds
    s_add_u32 m0, s37, 4096
    s_nop 0
    buffer_load_dwordx4 v14, s[16:19], s30 offen lds
    s_add_u32 m0, s36, 16384
    s_add_u32 s30, s34, 128
    buffer_load_dwordx4 v8, s[8:11], s30 offen offset:0 lds
    buffer_load_dwordx4 v9, s[8:11], s30 offen offset:1024 lds
    s_add_u32 m0, s37, 16384
    s_add_u32 s30, s35, 4096
    buffer_load_dwordx4 v14, s[12:15], s30 offen lds
    s_add_u32 m0, s37, 20480
    s_nop 0
    buffer_load_dwordx4 v14, s[16:19], s30 offen lds
    s_add_u32 m0, s36, 32768
    s_add_u32 s30, s34, 256
    buffer_load_dwordx4 v8, s[8:11], s30 offen offset:0 lds
    buffer_load_dwordx4 v9, s[8:11], s30 offen offset:1024 lds
    s_add_u32 m0, s37, 32768
    s_add_u32 s30, s35, 8192
    buffer_load_dwordx4 v14, s[12:15], s30 offen lds
    s_add_u32 m0, s37, 36864
    s_nop 0
    buffer_load_dwordx4 v14, s[16:19], s30 offen lds
    s_and_b32 s28, s3, 1
    s_lshl_b32 s28, s28, 12
    v_and_b32 v48, 31, v0
    v_lshrrev_b32 v49, 1, v48
    v_and_b32 v49, 7, v49
    v_lshrrev_b32 v50, 5, v0
    v_xor_b32 v49, v49, v50
    v_lshlrev_b32 v48, 7, v48
    v_add_u32 v48, s28, v48
    v_xor_b32 v50, 0, v49
    v_lshlrev_b32 v50, 4, v50
    v_add_u32 v2, v48, v50
    v_xor_b32 v50, 2, v49
    v_lshlrev_b32 v50, 4, v50
    v_add_u32 v3, v48, v50
    v_xor_b32 v50, 4, v49
    v_lshlrev_b32 v50, 4, v50
    v_add_u32 v4, v48, v50
    v_xor_b32 v50, 6, v49
    v_lshlrev_b32 v50, 4, v50
    v_add_u32 v5, v48, v50
    s_lshr_b32 s28, s3, 1
    s_lshl_b32 s28, s28, 12
    s_add_u32 s28, s28, 8192
    v_lshrrev_b32 v48, 5, v0
    v_lshlrev_b32 v48, 3, v48
    v_bfe_u32 v49, v0, 2, 2
    v_add_u32 v48, v48, v49
    v_lshlrev_b32 v48, 6, v48
    v_bfe_u32 v49, v0, 4, 1
    v_lshlrev_b32 v49, 5, v49
    v_add_u32 v48, v48, v49
    v_and_b32 v49, 3, v0
    v_lshlrev_b32 v49, 3, v49
    v_add_u32 v48, v48, v49
    v_add_u32 v6, s28, v48
    v_lshrrev_b32 v15, 5, v0
    v_lshlrev_b32 v15, 4, v15
    v_add_u32 v15, 0x10000, v15
    v_mov_b32 v128, 0
    v_mov_b32 v144, 0
    v_mov_b32 v129, 0
    v_mov_b32 v145, 0
    v_mov_b32 v130, 0
    v_mov_b32 v146, 0
    v_mov_b32 v131, 0
    v_mov_b32 v147, 0
    v_mov_b32 v132, 0
    v_mov_b32 v148, 0
    v_mov_b32 v133, 0
    v_mov_b32 v149, 0
    v_mov_b32 v134, 0
    v_mov_b32 v150, 0
    v_mov_b32 v135, 0
    v_mov_b32 v151, 0
    v_mov_b32 v136, 0
    v_mov_b32 v152, 0
    v_mov_b32 v137, 0
    v_mov_b32 v153, 0
    v_mov_b32 v138, 0
    v_mov_b32 v154, 0
    v_mov_b32 v139, 0
    v_mov_b32 v155, 0
    v_mov_b32 v140, 0
    v_mov_b32 v156, 0
    v_mov_b32 v141, 0
    v_mov_b32 v157, 0
    v_mov_b32 v142, 0
    v_mov_b32 v158, 0
    v_mov_b32 v143, 0
    v_mov_b32 v159, 0
    s_cmp_ge_u32 s3, 2
    s_cbranch_scc1 L_kv_v
    s_waitcnt vmcnt(8)
    s_barrier
    s_add_u32 s31, s61, 0
    s_and_b32 s31, s31, 15
    s_lshl_b32 s31, s31, 7
    v_add_u32 v7, s31, v15
    ds_read_b128 v[64:67], v2 offset:0
    ds_read_b64_tr_b16 v[72:73], v6 offset:0
    ds_read_b64_tr_b16 v[74:75], v6 offset:256
    ds_read_b128 v[80:83], v7 offset:0
    s_waitcnt lgkmcnt(0)
    ds_read_b128 v[68:71], v3 offset:0
    ds_read_b64_tr_b16 v[76:77], v6 offset:1024
    ds_read_b64_tr_b16 v[78:79], v6 offset:1280
    ds_read_b128 v[84:87], v7 offset:32
    v_mfma_f32_32x32x16_bf16 v[128:143], v[72:75], v[64:67], v[128:143]
    v_mfma_f32_32x32x16_bf16 v[144:159], v[80:83], v[64:67], v[144:159]
    s_waitcnt lgkmcnt(0)
    ds_read_b128 v[64:67], v4 offset:0
    ds_read_b64_tr_b16 v[72:73], v6 offset:2048
    ds_read_b64_tr_b16 v[74:75], v6 offset:2304
    ds_read_b128 v[80:83], v7 offset:64
    v_mfma_f32_32x32x16_bf16 v[128:143], v[76:79], v[68:71], v[128:143]
    v_mfma_f32_32x32x16_bf16 v[144:159], v[84:87], v[68:71], v[144:159]
    s_waitcnt lgkmcnt(0)
    ds_read_b128 v[68:71], v5 offset:0
    ds_read_b64_tr_b16 v[76:77], v6 offset:3072
    ds_read_b64_tr_b16 v[78:79], v6 offset:3328
    ds_read_b128 v[84:87], v7 offset:96
    v_mfma_f32_32x32x16_bf16 v[128:143], v[72:75], v[64:67], v[128:143]
    v_mfma_f32_32x32x16_bf16 v[144:159], v[80:83], v[64:67], v[144:159]
    s_waitcnt lgkmcnt(0)
    s_waitcnt vmcnt(4)
    s_barrier
    s_add_u32 s31, s61, 1
    s_and_b32 s31, s31, 15
    s_lshl_b32 s31, s31, 7
    v_add_u32 v7, s31, v15
    ds_read_b128 v[64:67], v2 offset:16384
    ds_read_b64_tr_b16 v[72:73], v6 offset:16384
    ds_read_b64_tr_b16 v[74:75], v6 offset:16640
    ds_read_b128 v[80:83], v7 offset:0
    v_mfma_f32_32x32x16_bf16 v[128:143], v[76:79], v[68:71], v[128:143]
    v_mfma_f32_32x32x16_bf16 v[144:159], v[84:87], v[68:71], v[144:159]
    s_add_u32 m0, s36, 49152
    s_add_u32 s30, s34, 384
    buffer_load_dwordx4 v8, s[8:11], s30 offen offset:0 lds
    buffer_load_dwordx4 v9, s[8:11], s30 offen offset:1024 lds
    s_add_u32 m0, s37, 49152
    s_add_u32 s30, s35, 12288
    buffer_load_dwordx4 v14, s[12:15], s30 offen lds
    s_add_u32 m0, s37, 53248
    s_nop 0
    buffer_load_dwordx4 v14, s[16:19], s30 offen lds
    s_waitcnt lgkmcnt(0)
    ds_read_b128 v[68:71], v3 offset:16384
    ds_read_b64_tr_b16 v[76:77], v6 offset:17408
    ds_read_b64_tr_b16 v[78:79], v6 offset:17664
    ds_read_b128 v[84:87], v7 offset:32
    v_mfma_f32_32x32x16_bf16 v[128:143], v[72:75], v[64:67], v[128:143]
    v_mfma_f32_32x32x16_bf16 v[144:159], v[80:83], v[64:67], v[144:159]
    s_waitcnt lgkmcnt(0)
    ds_read_b128 v[64:67], v4 offset:16384
    ds_read_b64_tr_b16 v[72:73], v6 offset:18432
    ds_read_b64_tr_b16 v[74:75], v6 offset:18688
    ds_read_b128 v[80:83], v7 offset:64
    v_mfma_f32_32x32x16_bf16 v[128:143], v[76:79], v[68:71], v[128:143]
    v_mfma_f32_32x32x16_bf16 v[144:159], v[84:87], v[68:71], v[144:159]
    s_waitcnt lgkmcnt(0)
    ds_read_b128 v[68:71], v5 offset:16384
    ds_read_b64_tr_b16 v[76:77], v6 offset:19456
    ds_read_b64_tr_b16 v[78:79], v6 offset:19712
    ds_read_b128 v[84:87], v7 offset:96
    v_mfma_f32_32x32x16_bf16 v[128:143], v[72:75], v[64:67], v[128:143]
    v_mfma_f32_32x32x16_bf16 v[144:159], v[80:83], v[64:67], v[144:159]
    s_waitcnt lgkmcnt(0)
    s_waitcnt vmcnt(4)
    s_barrier
    s_add_u32 s31, s61, 2
    s_and_b32 s31, s31, 15
    s_lshl_b32 s31, s31, 7
    v_add_u32 v7, s31, v15
    ds_read_b128 v[64:67], v2 offset:32768
    ds_read_b64_tr_b16 v[72:73], v6 offset:32768
    ds_read_b64_tr_b16 v[74:75], v6 offset:33024
    ds_read_b128 v[80:83], v7 offset:0
    v_mfma_f32_32x32x16_bf16 v[128:143], v[76:79], v[68:71], v[128:143]
    v_mfma_f32_32x32x16_bf16 v[144:159], v[84:87], v[68:71], v[144:159]
    s_add_u32 m0, s36, 0
    s_add_u32 s30, s34, 512
    buffer_load_dwordx4 v8, s[8:11], s30 offen offset:0 lds
    buffer_load_dwordx4 v9, s[8:11], s30 offen offset:1024 lds
    s_add_u32 m0, s37, 0
    s_add_u32 s30, s35, 16384
    buffer_load_dwordx4 v14, s[12:15], s30 offen lds
    s_add_u32 m0, s37, 4096
    s_nop 0
    buffer_load_dwordx4 v14, s[16:19], s30 offen lds
    s_waitcnt lgkmcnt(0)
    ds_read_b128 v[68:71], v3 offset:32768
    ds_read_b64_tr_b16 v[76:77], v6 offset:33792
    ds_read_b64_tr_b16 v[78:79], v6 offset:34048
    ds_read_b128 v[84:87], v7 offset:32
    v_mfma_f32_32x32x16_bf16 v[128:143], v[72:75], v[64:67], v[128:143]
    v_mfma_f32_32x32x16_bf16 v[144:159], v[80:83], v[64:67], v[144:159]
    s_waitcnt lgkmcnt(0)
    ds_read_b128 v[64:67], v4 offset:32768
    ds_read_b64_tr_b16 v[72:73], v6 offset:34816
    ds_read_b64_tr_b16 v[74:75], v6 offset:35072
    ds_read_b128 v[80:83], v7 offset:64
    v_mfma_f32_32x32x16_bf16 v[128:143], v[76:79], v[68:71], v[128:143]
    v_mfma_f32_32x32x16_bf16 v[144:159], v[84:87], v[68:71], v[144:159]
    s_waitcnt lgkmcnt(0)
    ds_read_b128 v[68:71], v5 offset:32768
    ds_read_b64_tr_b16 v[76:77], v6 offset:35840
    ds_read_b64_tr_b16 v[78:79], v6 offset:36096
    ds_read_b128 v[84:87], v7 offset:96
    v_mfma_f32_32x32x16_bf16 v[128:143], v[72:75], v[64:67], v[128:143]
    v_mfma_f32_32x32x16_bf16 v[144:159], v[80:83], v[64:67], v[144:159]
    s_waitcnt lgkmcnt(0)
    s_waitcnt vmcnt(4)
    s_barrier
    s_add_u32 s31, s61, 3
    s_and_b32 s31, s31, 15
    s_lshl_b32 s31, s31, 7
    v_add_u32 v7, s31, v15
    ds_read_b128 v[64:67], v2 offset:49152
    ds_read_b64_tr_b16 v[72:73], v6 offset:49152
    ds_read_b64_tr_b16 v[74:75], v6 offset:49408
    ds_read_b128 v[80:83], v7 offset:0
    v_mfma_f32_32x32x16_bf16 v[128:143], v[76:79], v[68:71], v[128:143]
    v_mfma_f32_32x32x16_bf16 v[144:159], v[84:87], v[68:71], v[144:159]
    s_add_u32 m0, s36, 16384
    s_add_u32 s30, s34, 640
    buffer_load_dwordx4 v8, s[8:11], s30 offen offset:0 lds
    buffer_load_dwordx4 v9, s[8:11], s30 offen offset:1024 lds
    s_add_u32 m0, s37, 16384
    s_add_u32 s30, s35, 20480
    buffer_load_dwordx4 v14, s[12:15], s30 offen lds
    s_add_u32 m0, s37, 20480
    s_nop 0
    buffer_load_dwordx4 v14, s[16:19], s30 offen lds
    s_waitcnt lgkmcnt(0)
    ds_read_b128 v[68:71], v3 offset:49152
    ds_read_b64_tr_b16 v[76:77], v6 offset:50176
    ds_read_b64_tr_b16 v[78:79], v6 offset:50432
    ds_read_b128 v[84:87], v7 offset:32
    v_mfma_f32_32x32x16_bf16 v[128:143], v[72:75], v[64:67], v[128:143]
    v_mfma_f32_32x32x16_bf16 v[144:159], v[80:83], v[64:67], v[144:159]
    s_waitcnt lgkmcnt(0)
    ds_read_b128 v[64:67], v4 offset:49152
    ds_read_b64_tr_b16 v[72:73], v6 offset:51200
    ds_read_b64_tr_b16 v[74:75], v6 offset:51456
    ds_read_b128 v[80:83], v7 offset:64
    v_mfma_f32_32x32x16_bf16 v[128:143], v[76:79], v[68:71], v[128:143]
    v_mfma_f32_32x32x16_bf16 v[144:159], v[84:87], v[68:71], v[144:159]
    s_waitcnt lgkmcnt(0)
    ds_read_b128 v[68:71], v5 offset:49152
    ds_read_b64_tr_b16 v[76:77], v6 offset:52224
    ds_read_b64_tr_b16 v[78:79], v6 offset:52480
    ds_read_b128 v[84:87], v7 offset:96
    v_mfma_f32_32x32x16_bf16 v[128:143], v[72:75], v[64:67], v[128:143]
    v_mfma_f32_32x32x16_bf16 v[144:159], v[80:83], v[64:67], v[144:159]
    s_waitcnt lgkmcnt(0)
    s_waitcnt vmcnt(4)
    s_barrier
    s_add_u32 s31, s61, 4
    s_and_b32 s31, s31, 15
    s_lshl_b32 s31, s31, 7
    v_add_u32 v7, s31, v15
    ds_read_b128 v[64:67], v2 offset:0
    ds_read_b64_tr_b16 v[72:73], v6 offset:0
    ds_read_b64_tr_b16 v[74:75], v6 offset:256
    ds_read_b128 v[80:83], v7 offset:0
    v_mfma_f32_32x32x16_bf16 v[128:143], v[76:79], v[68:71], v[128:143]
    v_mfma_f32_32x32x16_bf16 v[144:159], v[84:87], v[68:71], v[144:159]
    s_add_u32 m0, s36, 32768
    s_add_u32 s30, s34, 768
    buffer_load_dwordx4 v8, s[8:11], s30 offen offset:0 lds
    buffer_load_dwordx4 v9, s[8:11], s30 offen offset:1024 lds
    s_add_u32 m0, s37, 32768
    s_add_u32 s30, s35, 24576
    buffer_load_dwordx4 v14, s[12:15], s30 offen lds
    s_add_u32 m0, s37, 36864
    s_nop 0
    buffer_load_dwordx4 v14, s[16:19], s30 offen lds
    s_waitcnt lgkmcnt(0)
    ds_read_b128 v[68:71], v3 offset:0
    ds_read_b64_tr_b16 v[76:77], v6 offset:1024
    ds_read_b64_tr_b16 v[78:79], v6 offset:1280
    ds_read_b128 v[84:87], v7 offset:32
    v_mfma_f32_32x32x16_bf16 v[128:143], v[72:75], v[64:67], v[128:143]
    v_mfma_f32_32x32x16_bf16 v[144:159], v[80:83], v[64:67], v[144:159]
    s_waitcnt lgkmcnt(0)
    ds_read_b128 v[64:67], v4 offset:0
    ds_read_b64_tr_b16 v[72:73], v6 offset:2048
    ds_read_b64_tr_b16 v[74:75], v6 offset:2304
    ds_read_b128 v[80:83], v7 offset:64
    v_mfma_f32_32x32x16_bf16 v[128:143], v[76:79], v[68:71], v[128:143]
    v_mfma_f32_32x32x16_bf16 v[144:159], v[84:87], v[68:71], v[144:159]
    s_waitcnt lgkmcnt(0)
    ds_read_b128 v[68:71], v5 offset:0
    ds_read_b64_tr_b16 v[76:77], v6 offset:3072
    ds_read_b64_tr_b16 v[78:79], v6 offset:3328
    ds_read_b128 v[84:87], v7 offset:96
    v_mfma_f32_32x32x16_bf16 v[128:143], v[72:75], v[64:67], v[128:143]
    v_mfma_f32_32x32x16_bf16 v[144:159], v[80:83], v[64:67], v[144:159]
    s_waitcnt lgkmcnt(0)
    s_waitcnt vmcnt(4)
    s_barrier
    s_add_u32 s31, s61, 5
    s_and_b32 s31, s31, 15
    s_lshl_b32 s31, s31, 7
    v_add_u32 v7, s31, v15
    ds_read_b128 v[64:67], v2 offset:16384
    ds_read_b64_tr_b16 v[72:73], v6 offset:16384
    ds_read_b64_tr_b16 v[74:75], v6 offset:16640
    ds_read_b128 v[80:83], v7 offset:0
    v_mfma_f32_32x32x16_bf16 v[128:143], v[76:79], v[68:71], v[128:143]
    v_mfma_f32_32x32x16_bf16 v[144:159], v[84:87], v[68:71], v[144:159]
    s_add_u32 m0, s36, 49152
    s_add_u32 s30, s34, 896
    buffer_load_dwordx4 v8, s[8:11], s30 offen offset:0 lds
    buffer_load_dwordx4 v9, s[8:11], s30 offen offset:1024 lds
    s_add_u32 m0, s37, 49152
    s_add_u32 s30, s35, 28672
    buffer_load_dwordx4 v14, s[12:15], s30 offen lds
    s_add_u32 m0, s37, 53248
    s_nop 0
    buffer_load_dwordx4 v14, s[16:19], s30 offen lds
    s_waitcnt lgkmcnt(0)
    ds_read_b128 v[68:71], v3 offset:16384
    ds_read_b64_tr_b16 v[76:77], v6 offset:17408
    ds_read_b64_tr_b16 v[78:79], v6 offset:17664
    ds_read_b128 v[84:87], v7 offset:32
    v_mfma_f32_32x32x16_bf16 v[128:143], v[72:75], v[64:67], v[128:143]
    v_mfma_f32_32x32x16_bf16 v[144:159], v[80:83], v[64:67], v[144:159]
    s_waitcnt lgkmcnt(0)
    ds_read_b128 v[64:67], v4 offset:16384
    ds_read_b64_tr_b16 v[72:73], v6 offset:18432
    ds_read_b64_tr_b16 v[74:75], v6 offset:18688
    ds_read_b128 v[80:83], v7 offset:64
    v_mfma_f32_32x32x16_bf16 v[128:143], v[76:79], v[68:71], v[128:143]
    v_mfma_f32_32x32x16_bf16 v[144:159], v[84:87], v[68:71], v[144:159]
    s_waitcnt lgkmcnt(0)
    ds_read_b128 v[68:71], v5 offset:16384
    ds_read_b64_tr_b16 v[76:77], v6 offset:19456
    ds_read_b64_tr_b16 v[78:79], v6 offset:19712
    ds_read_b128 v[84:87], v7 offset:96
    v_mfma_f32_32x32x16_bf16 v[128:143], v[72:75], v[64:67], v[128:143]
    v_mfma_f32_32x32x16_bf16 v[144:159], v[80:83], v[64:67], v[144:159]
    s_waitcnt lgkmcnt(0)
    s_waitcnt vmcnt(4)
    s_barrier
    s_add_u32 s31, s61, 6
    s_and_b32 s31, s31, 15
    s_lshl_b32 s31, s31, 7
    v_add_u32 v7, s31, v15
    ds_read_b128 v[64:67], v2 offset:32768
    ds_read_b64_tr_b16 v[72:73], v6 offset:32768
    ds_read_b64_tr_b16 v[74:75], v6 offset:33024
    ds_read_b128 v[80:83], v7 offset:0
    v_mfma_f32_32x32x16_bf16 v[128:143], v[76:79], v[68:71], v[128:143]
    v_mfma_f32_32x32x16_bf16 v[144:159], v[84:87], v[68:71], v[144:159]
    s_add_u32 m0, s36, 0
    s_add_u32 s30, s34, 1024
    buffer_load_dwordx4 v8, s[8:11], s30 offen offset:0 lds
    buffer_load_dwordx4 v9, s[8:11], s30 offen offset:1024 lds
    s_add_u32 m0, s37, 0
    s_add_u32 s30, s35, 32768
    buffer_load_dwordx4 v14, s[12:15], s30 offen lds
    s_add_u32 m0, s37, 4096
    s_nop 0
    buffer_load_dwordx4 v14, s[16:19], s30 offen lds
    s_waitcnt lgkmcnt(0)
    ds_read_b128 v[68:71], v3 offset:32768
    ds_read_b64_tr_b16 v[76:77], v6 offset:33792
    ds_read_b64_tr_b16 v[78:79], v6 offset:34048
    ds_read_b128 v[84:87], v7 offset:32
    v_mfma_f32_32x32x16_bf16 v[128:143], v[72:75], v[64:67], v[128:143]
    v_mfma_f32_32x32x16_bf16 v[144:159], v[80:83], v[64:67], v[144:159]
    s_waitcnt lgkmcnt(0)
    ds_read_b128 v[64:67], v4 offset:32768
    ds_read_b64_tr_b16 v[72:73], v6 offset:34816
    ds_read_b64_tr_b16 v[74:75], v6 offset:35072
    ds_read_b128 v[80:83], v7 offset:64
    v_mfma_f32_32x32x16_bf16 v[128:143], v[76:79], v[68:71], v[128:143]
    v_mfma_f32_32x32x16_bf16 v[144:159], v[84:87], v[68:71], v[144:159]
    s_waitcnt lgkmcnt(0)
    ds_read_b128 v[68:71], v5 offset:32768
    ds_read_b64_tr_b16 v[76:77], v6 offset:35840
    ds_read_b64_tr_b16 v[78:79], v6 offset:36096
    ds_read_b128 v[84:87], v7 offset:96
    v_mfma_f32_32x32x16_bf16 v[128:143], v[72:75], v[64:67], v[128:143]
    v_mfma_f32_32x32x16_bf16 v[144:159], v[80:83], v[64:67], v[144:159]
    s_waitcnt lgkmcnt(0)
    s_waitcnt vmcnt(4)
    s_barrier
    s_add_u32 s31, s61, 7
    s_and_b32 s31, s31, 15
    s_lshl_b32 s31, s31, 7
    v_add_u32 v7, s31, v15
    ds_read_b128 v[64:67], v2 offset:49152
    ds_read_b64_tr_b16 v[72:73], v6 offset:49152
    ds_read_b64_tr_b16 v[74:75], v6 offset:49408
    ds_read_b128 v[80:83], v7 offset:0
    v_mfma_f32_32x32x16_bf16 v[128:143], v[76:79], v[68:71], v[128:143]
    v_mfma_f32_32x32x16_bf16 v[144:159], v[84:87], v[68:71], v[144:159]
    s_add_u32 m0, s36, 16384
    s_add_u32 s30, s34, 1152
    buffer_load_dwordx4 v8, s[8:11], s30 offen offset:0 lds
    buffer_load_dwordx4 v9, s[8:11], s30 offen offset:1024 lds
    s_add_u32 m0, s37, 16384
    s_add_u32 s30, s35, 36864
    buffer_load_dwordx4 v14, s[12:15], s30 offen lds
    s_add_u32 m0, s37, 20480
    s_nop 0
    buffer_load_dwordx4 v14, s[16:19], s30 offen lds
    s_waitcnt lgkmcnt(0)
    ds_read_b128 v[68:71], v3 offset:49152
    ds_read_b64_tr_b16 v[76:77], v6 offset:50176
    ds_read_b64_tr_b16 v[78:79], v6 offset:50432
    ds_read_b128 v[84:87], v7 offset:32
    v_mfma_f32_32x32x16_bf16 v[128:143], v[72:75], v[64:67], v[128:143]
    v_mfma_f32_32x32x16_bf16 v[144:159], v[80:83], v[64:67], v[144:159]
    s_waitcnt lgkmcnt(0)
    ds_read_b128 v[64:67], v4 offset:49152
    ds_read_b64_tr_b16 v[72:73], v6 offset:51200
    ds_read_b64_tr_b16 v[74:75], v6 offset:51456
    ds_read_b128 v[80:83], v7 offset:64
    v_mfma_f32_32x32x16_bf16 v[128:143], v[76:79], v[68:71], v[128:143]
    v_mfma_f32_32x32x16_bf16 v[144:159], v[84:87], v[68:71], v[144:159]
    s_waitcnt lgkmcnt(0)
    ds_read_b128 v[68:71], v5 offset:49152
    ds_read_b64_tr_b16 v[76:77], v6 offset:52224
    ds_read_b64_tr_b16 v[78:79], v6 offset:52480
    ds_read_b128 v[84:87], v7 offset:96
    v_mfma_f32_32x32x16_bf16 v[128:143], v[72:75], v[64:67], v[128:143]
    v_mfma_f32_32x32x16_bf16 v[144:159], v[80:83], v[64:67], v[144:159]
    s_waitcnt lgkmcnt(0)
    s_waitcnt vmcnt(4)
    s_barrier
    s_add_u32 s31, s61, 8
    s_and_b32 s31, s31, 15
    s_lshl_b32 s31, s31, 7
    v_add_u32 v7, s31, v15
    ds_read_b128 v[64:67], v2 offset:0
    ds_read_b64_tr_b16 v[72:73], v6 offset:0
    ds_read_b64_tr_b16 v[74:75], v6 offset:256
    ds_read_b128 v[80:83], v7 offset:0
    v_mfma_f32_32x32x16_bf16 v[128:143], v[76:79], v[68:71], v[128:143]
    v_mfma_f32_32x32x16_bf16 v[144:159], v[84:87], v[68:71], v[144:159]
    s_add_u32 m0, s36, 32768
    s_add_u32 s30, s34, 1280
    buffer_load_dwordx4 v8, s[8:11], s30 offen offset:0 lds
    buffer_load_dwordx4 v9, s[8:11], s30 offen offset:1024 lds
    s_add_u32 m0, s37, 32768
    s_add_u32 s30, s35, 40960
    buffer_load_dwordx4 v14, s[12:15], s30 offen lds
    s_add_u32 m0, s37, 36864
    s_nop 0
    buffer_load_dwordx4 v14, s[16:19], s30 offen lds
    s_waitcnt lgkmcnt(0)
    ds_read_b128 v[68:71], v3 offset:0
    ds_read_b64_tr_b16 v[76:77], v6 offset:1024
    ds_read_b64_tr_b16 v[78:79], v6 offset:1280
    ds_read_b128 v[84:87], v7 offset:32
    v_mfma_f32_32x32x16_bf16 v[128:143], v[72:75], v[64:67], v[128:143]
    v_mfma_f32_32x32x16_bf16 v[144:159], v[80:83], v[64:67], v[144:159]
    s_waitcnt lgkmcnt(0)
    ds_read_b128 v[64:67], v4 offset:0
    ds_read_b64_tr_b16 v[72:73], v6 offset:2048
    ds_read_b64_tr_b16 v[74:75], v6 offset:2304
    ds_read_b128 v[80:83], v7 offset:64
    v_mfma_f32_32x32x16_bf16 v[128:143], v[76:79], v[68:71], v[128:143]
    v_mfma_f32_32x32x16_bf16 v[144:159], v[84:87], v[68:71], v[144:159]
    s_waitcnt lgkmcnt(0)
    ds_read_b128 v[68:71], v5 offset:0
    ds_read_b64_tr_b16 v[76:77], v6 offset:3072
    ds_read_b64_tr_b16 v[78:79], v6 offset:3328
    ds_read_b128 v[84:87], v7 offset:96
    v_mfma_f32_32x32x16_bf16 v[128:143], v[72:75], v[64:67], v[128:143]
    v_mfma_f32_32x32x16_bf16 v[144:159], v[80:83], v[64:67], v[144:159]
    s_waitcnt lgkmcnt(0)
    s_waitcnt vmcnt(4)
    s_barrier
    s_add_u32 s31, s61, 9
    s_and_b32 s31, s31, 15
    s_lshl_b32 s31, s31, 7
    v_add_u32 v7, s31, v15
    ds_read_b128 v[64:67], v2 offset:16384
    ds_read_b64_tr_b16 v[72:73], v6 offset:16384
    ds_read_b64_tr_b16 v[74:75], v6 offset:16640
    ds_read_b128 v[80:83], v7 offset:0
    v_mfma_f32_32x32x16_bf16 v[128:143], v[76:79], v[68:71], v[128:143]
    v_mfma_f32_32x32x16_bf16 v[144:159], v[84:87], v[68:71], v[144:159]
    s_add_u32 m0, s36, 49152
    s_add_u32 s30, s34, 1408
    buffer_load_dwordx4 v8, s[8:11], s30 offen offset:0 lds
    buffer_load_dwordx4 v9, s[8:11], s30 offen offset:1024 lds
    s_add_u32 m0, s37, 49152
    s_add_u32 s30, s35, 45056
    buffer_load_dwordx4 v14, s[12:15], s30 offen lds
    s_add_u32 m0, s37, 53248
    s_nop 0
    buffer_load_dwordx4 v14, s[16:19], s30 offen lds
    s_waitcnt lgkmcnt(0)
    ds_read_b128 v[68:71], v3 offset:16384
    ds_read_b64_tr_b16 v[76:77], v6 offset:17408
    ds_read_b64_tr_b16 v[78:79], v6 offset:17664
    ds_read_b128 v[84:87], v7 offset:32
    v_mfma_f32_32x32x16_bf16 v[128:143], v[72:75], v[64:67], v[128:143]
    v_mfma_f32_32x32x16_bf16 v[144:159], v[80:83], v[64:67], v[144:159]
    s_waitcnt lgkmcnt(0)
    ds_read_b128 v[64:67], v4 offset:16384
    ds_read_b64_tr_b16 v[72:73], v6 offset:18432
    ds_read_b64_tr_b16 v[74:75], v6 offset:18688
    ds_read_b128 v[80:83], v7 offset:64
    v_mfma_f32_32x32x16_bf16 v[128:143], v[76:79], v[68:71], v[128:143]
    v_mfma_f32_32x32x16_bf16 v[144:159], v[84:87], v[68:71], v[144:159]
    s_waitcnt lgkmcnt(0)
    ds_read_b128 v[68:71], v5 offset:16384
    ds_read_b64_tr_b16 v[76:77], v6 offset:19456
    ds_read_b64_tr_b16 v[78:79], v6 offset:19712
    ds_read_b128 v[84:87], v7 offset:96
    v_mfma_f32_32x32x16_bf16 v[128:143], v[72:75], v[64:67], v[128:143]
    v_mfma_f32_32x32x16_bf16 v[144:159], v[80:83], v[64:67], v[144:159]
    s_waitcnt lgkmcnt(0)
    s_waitcnt vmcnt(4)
    s_barrier
    s_add_u32 s31, s61, 10
    s_and_b32 s31, s31, 15
    s_lshl_b32 s31, s31, 7
    v_add_u32 v7, s31, v15
    ds_read_b128 v[64:67], v2 offset:32768
    ds_read_b64_tr_b16 v[72:73], v6 offset:32768
    ds_read_b64_tr_b16 v[74:75], v6 offset:33024
    ds_read_b128 v[80:83], v7 offset:0
    v_mfma_f32_32x32x16_bf16 v[128:143], v[76:79], v[68:71], v[128:143]
    v_mfma_f32_32x32x16_bf16 v[144:159], v[84:87], v[68:71], v[144:159]
    s_add_u32 m0, s36, 0
    s_add_u32 s30, s34, 1536
    buffer_load_dwordx4 v8, s[8:11], s30 offen offset:0 lds
    buffer_load_dwordx4 v9, s[8:11], s30 offen offset:1024 lds
    s_add_u32 m0, s37, 0
    s_add_u32 s30, s35, 49152
    buffer_load_dwordx4 v14, s[12:15], s30 offen lds
    s_add_u32 m0, s37, 4096
    s_nop 0
    buffer_load_dwordx4 v14, s[16:19], s30 offen lds
    s_waitcnt lgkmcnt(0)
    ds_read_b128 v[68:71], v3 offset:32768
    ds_read_b64_tr_b16 v[76:77], v6 offset:33792
    ds_read_b64_tr_b16 v[78:79], v6 offset:34048
    ds_read_b128 v[84:87], v7 offset:32
    v_mfma_f32_32x32x16_bf16 v[128:143], v[72:75], v[64:67], v[128:143]
    v_mfma_f32_32x32x16_bf16 v[144:159], v[80:83], v[64:67], v[144:159]
    s_waitcnt lgkmcnt(0)
    ds_read_b128 v[64:67], v4 offset:32768
    ds_read_b64_tr_b16 v[72:73], v6 offset:34816
    ds_read_b64_tr_b16 v[74:75], v6 offset:35072
    ds_read_b128 v[80:83], v7 offset:64
    v_mfma_f32_32x32x16_bf16 v[128:143], v[76:79], v[68:71], v[128:143]
    v_mfma_f32_32x32x16_bf16 v[144:159], v[84:87], v[68:71], v[144:159]
    s_waitcnt lgkmcnt(0)
    ds_read_b128 v[68:71], v5 offset:32768
    ds_read_b64_tr_b16 v[76:77], v6 offset:35840
    ds_read_b64_tr_b16 v[78:79], v6 offset:36096
    ds_read_b128 v[84:87], v7 offset:96
    v_mfma_f32_32x32x16_bf16 v[128:143], v[72:75], v[64:67], v[128:143]
    v_mfma_f32_32x32x16_bf16 v[144:159], v[80:83], v[64:67], v[144:159]
    s_waitcnt lgkmcnt(0)
    s_waitcnt vmcnt(4)
    s_barrier
    s_add_u32 s31, s61, 11
    s_and_b32 s31, s31, 15
    s_lshl_b32 s31, s31, 7
    v_add_u32 v7, s31, v15
    ds_read_b128 v[64:67], v2 offset:49152
    ds_read_b64_tr_b16 v[72:73], v6 offset:49152
    ds_read_b64_tr_b16 v[74:75], v6 offset:49408
    ds_read_b128 v[80:83], v7 offset:0
    v_mfma_f32_32x32x16_bf16 v[128:143], v[76:79], v[68:71], v[128:143]
    v_mfma_f32_32x32x16_bf16 v[144:159], v[84:87], v[68:71], v[144:159]
    s_add_u32 m0, s36, 16384
    s_add_u32 s30, s34, 1664
    buffer_load_dwordx4 v8, s[8:11], s30 offen offset:0 lds
    buffer_load_dwordx4 v9, s[8:11], s30 offen offset:1024 lds
    s_add_u32 m0, s37, 16384
    s_add_u32 s30, s35, 53248
    buffer_load_dwordx4 v14, s[12:15], s30 offen lds
    s_add_u32 m0, s37, 20480
    s_nop 0
    buffer_load_dwordx4 v14, s[16:19], s30 offen lds
    s_waitcnt lgkmcnt(0)
    ds_read_b128 v[68:71], v3 offset:49152
    ds_read_b64_tr_b16 v[76:77], v6 offset:50176
    ds_read_b64_tr_b16 v[78:79], v6 offset:50432
    ds_read_b128 v[84:87], v7 offset:32
    v_mfma_f32_32x32x16_bf16 v[128:143], v[72:75], v[64:67], v[128:143]
    v_mfma_f32_32x32x16_bf16 v[144:159], v[80:83], v[64:67], v[144:159]
    s_waitcnt lgkmcnt(0)
    ds_read_b128 v[64:67], v4 offset:49152
    ds_read_b64_tr_b16 v[72:73], v6 offset:51200
    ds_read_b64_tr_b16 v[74:75], v6 offset:51456
    ds_read_b128 v[80:83], v7 offset:64
    v_mfma_f32_32x32x16_bf16 v[128:143], v[76:79], v[68:71], v[128:143]
    v_mfma_f32_32x32x16_bf16 v[144:159], v[84:87], v[68:71], v[144:159]
    s_waitcnt lgkmcnt(0)
    ds_read_b128 v[68:71], v5 offset:49152
    ds_read_b64_tr_b16 v[76:77], v6 offset:52224
    ds_read_b64_tr_b16 v[78:79], v6 offset:52480
    ds_read_b128 v[84:87], v7 offset:96
    v_mfma_f32_32x32x16_bf16 v[128:143], v[72:75], v[64:67], v[128:143]
    v_mfma_f32_32x32x16_bf16 v[144:159], v[80:83], v[64:67], v[144:159]
    s_waitcnt lgkmcnt(0)
    s_waitcnt vmcnt(4)
    s_barrier
    s_add_u32 s31, s61, 12
    s_and_b32 s31, s31, 15
    s_lshl_b32 s31, s31, 7
    v_add_u32 v7, s31, v15
    ds_read_b128 v[64:67], v2 offset:0
    ds_read_b64_tr_b16 v[72:73], v6 offset:0
    ds_read_b64_tr_b16 v[74:75], v6 offset:256
    ds_read_b128 v[80:83], v7 offset:0
    v_mfma_f32_32x32x16_bf16 v[128:143], v[76:79], v[68:71], v[128:143]
    v_mfma_f32_32x32x16_bf16 v[144:159], v[84:87], v[68:71], v[144:159]
    s_add_u32 m0, s36, 32768
    s_add_u32 s30, s34, 1792
    buffer_load_dwordx4 v8, s[8:11], s30 offen offset:0 lds
    buffer_load_dwordx4 v9, s[8:11], s30 offen offset:1024 lds
    s_add_u32 m0, s37, 32768
    s_add_u32 s30, s35, 57344
    buffer_load_dwordx4 v14, s[12:15], s30 offen lds
    s_add_u32 m0, s37, 36864
    s_nop 0
    buffer_load_dwordx4 v14, s[16:19], s30 offen lds
    s_waitcnt lgkmcnt(0)
    ds_read_b128 v[68:71], v3 offset:0
    ds_read_b64_tr_b16 v[76:77], v6 offset:1024
    ds_read_b64_tr_b16 v[78:79], v6 offset:1280
    ds_read_b128 v[84:87], v7 offset:32
    v_mfma_f32_32x32x16_bf16 v[128:143], v[72:75], v[64:67], v[128:143]
    v_mfma_f32_32x32x16_bf16 v[144:159], v[80:83], v[64:67], v[144:159]
    s_waitcnt lgkmcnt(0)
    ds_read_b128 v[64:67], v4 offset:0
    ds_read_b64_tr_b16 v[72:73], v6 offset:2048
    ds_read_b64_tr_b16 v[74:75], v6 offset:2304
    ds_read_b128 v[80:83], v7 offset:64
    v_mfma_f32_32x32x16_bf16 v[128:143], v[76:79], v[68:71], v[128:143]
    v_mfma_f32_32x32x16_bf16 v[144:159], v[84:87], v[68:71], v[144:159]
    s_waitcnt lgkmcnt(0)
    ds_read_b128 v[68:71], v5 offset:0
    ds_read_b64_tr_b16 v[76:77], v6 offset:3072
    ds_read_b64_tr_b16 v[78:79], v6 offset:3328
    ds_read_b128 v[84:87], v7 offset:96
    v_mfma_f32_32x32x16_bf16 v[128:143], v[72:75], v[64:67], v[128:143]
    v_mfma_f32_32x32x16_bf16 v[144:159], v[80:83], v[64:67], v[144:159]
    s_waitcnt lgkmcnt(0)
    s_waitcnt vmcnt(4)
    s_barrier
    s_add_u32 s31, s61, 13
    s_and_b32 s31, s31, 15
    s_lshl_b32 s31, s31, 7
    v_add_u32 v7, s31, v15
    ds_read_b128 v[64:67], v2 offset:16384
    ds_read_b64_tr_b16 v[72:73], v6 offset:16384
    ds_read_b64_tr_b16 v[74:75], v6 offset:16640
    ds_read_b128 v[80:83], v7 offset:0
    v_mfma_f32_32x32x16_bf16 v[128:143], v[76:79], v[68:71], v[128:143]
    v_mfma_f32_32x32x16_bf16 v[144:159], v[84:87], v[68:71], v[144:159]
    s_add_u32 m0, s36, 49152
    s_add_u32 s30, s34, 1920
    buffer_load_dwordx4 v8, s[8:11], s30 offen offset:0 lds
    buffer_load_dwordx4 v9, s[8:11], s30 offen offset:1024 lds
    s_add_u32 m0, s37, 49152
    s_add_u32 s30, s35, 61440
    buffer_load_dwordx4 v14, s[12:15], s30 offen lds
    s_add_u32 m0, s37, 53248
    s_nop 0
    buffer_load_dwordx4 v14, s[16:19], s30 offen lds
    s_waitcnt lgkmcnt(0)
    ds_read_b128 v[68:71], v3 offset:16384
    ds_read_b64_tr_b16 v[76:77], v6 offset:17408
    ds_read_b64_tr_b16 v[78:79], v6 offset:17664
    ds_read_b128 v[84:87], v7 offset:32
    v_mfma_f32_32x32x16_bf16 v[128:143], v[72:75], v[64:67], v[128:143]
    v_mfma_f32_32x32x16_bf16 v[144:159], v[80:83], v[64:67], v[144:159]
    s_waitcnt lgkmcnt(0)
    ds_read_b128 v[64:67], v4 offset:16384
    ds_read_b64_tr_b16 v[72:73], v6 offset:18432
    ds_read_b64_tr_b16 v[74:75], v6 offset:18688
    ds_read_b128 v[80:83], v7 offset:64
    v_mfma_f32_32x32x16_bf16 v[128:143], v[76:79], v[68:71], v[128:143]
    v_mfma_f32_32x32x16_bf16 v[144:159], v[84:87], v[68:71], v[144:159]
    s_waitcnt lgkmcnt(0)
    ds_read_b128 v[68:71], v5 offset:16384
    ds_read_b64_tr_b16 v[76:77], v6 offset:19456
    ds_read_b64_tr_b16 v[78:79], v6 offset:19712
    ds_read_b128 v[84:87], v7 offset:96
    v_mfma_f32_32x32x16_bf16 v[128:143], v[72:75], v[64:67], v[128:143]
    v_mfma_f32_32x32x16_bf16 v[144:159], v[80:83], v[64:67], v[144:159]
    s_waitcnt lgkmcnt(0)
    s_waitcnt vmcnt(4)
    s_barrier
    s_add_u32 s31, s61, 14
    s_and_b32 s31, s31, 15
    s_lshl_b32 s31, s31, 7
    v_add_u32 v7, s31, v15
    ds_read_b128 v[64:67], v2 offset:32768
    ds_read_b64_tr_b16 v[72:73], v6 offset:32768
    ds_read_b64_tr_b16 v[74:75], v6 offset:33024
    ds_read_b128 v[80:83], v7 offset:0
    v_mfma_f32_32x32x16_bf16 v[128:143], v[76:79], v[68:71], v[128:143]
    v_mfma_f32_32x32x16_bf16 v[144:159], v[84:87], v[68:71], v[144:159]
    s_waitcnt lgkmcnt(0)
    ds_read_b128 v[68:71], v3 offset:32768
    ds_read_b64_tr_b16 v[76:77], v6 offset:33792
    ds_read_b64_tr_b16 v[78:79], v6 offset:34048
    ds_read_b128 v[84:87], v7 offset:32
    v_mfma_f32_32x32x16_bf16 v[128:143], v[72:75], v[64:67], v[128:143]
    v_mfma_f32_32x32x16_bf16 v[144:159], v[80:83], v[64:67], v[144:159]
    s_waitcnt lgkmcnt(0)
    ds_read_b128 v[64:67], v4 offset:32768
    ds_read_b64_tr_b16 v[72:73], v6 offset:34816
    ds_read_b64_tr_b16 v[74:75], v6 offset:35072
    ds_read_b128 v[80:83], v7 offset:64
    v_mfma_f32_32x32x16_bf16 v[128:143], v[76:79], v[68:71], v[128:143]
    v_mfma_f32_32x32x16_bf16 v[144:159], v[84:87], v[68:71], v[144:159]
    s_waitcnt lgkmcnt(0)
    ds_read_b128 v[68:71], v5 offset:32768
    ds_read_b64_tr_b16 v[76:77], v6 offset:35840
    ds_read_b64_tr_b16 v[78:79], v6 offset:36096
    ds_read_b128 v[84:87], v7 offset:96
    v_mfma_f32_32x32x16_bf16 v[128:143], v[72:75], v[64:67], v[128:143]
    v_mfma_f32_32x32x16_bf16 v[144:159], v[80:83], v[64:67], v[144:159]
    s_waitcnt lgkmcnt(0)
    s_waitcnt vmcnt(0)
    s_barrier
    s_add_u32 s31, s61, 15
    s_and_b32 s31, s31, 15
    s_lshl_b32 s31, s31, 7
    v_add_u32 v7, s31, v15
    ds_read_b128 v[64:67], v2 offset:49152
    ds_read_b64_tr_b16 v[72:73], v6 offset:49152
    ds_read_b64_tr_b16 v[74:75], v6 offset:49408
    ds_read_b128 v[80:83], v7 offset:0
    v_mfma_f32_32x32x16_bf16 v[128:143], v[76:79], v[68:71], v[128:143]
    v_mfma_f32_32x32x16_bf16 v[144:159], v[84:87], v[68:71], v[144:159]
    s_waitcnt lgkmcnt(0)
    ds_read_b128 v[68:71], v3 offset:49152
    ds_read_b64_tr_b16 v[76:77], v6 offset:50176
    ds_read_b64_tr_b16 v[78:79], v6 offset:50432
    ds_read_b128 v[84:87], v7 offset:32
    v_mfma_f32_32x32x16_bf16 v[128:143], v[72:75], v[64:67], v[128:143]
    v_mfma_f32_32x32x16_bf16 v[144:159], v[80:83], v[64:67], v[144:159]
    s_waitcnt lgkmcnt(0)
    ds_read_b128 v[64:67], v4 offset:49152
    ds_read_b64_tr_b16 v[72:73], v6 offset:51200
    ds_read_b64_tr_b16 v[74:75], v6 offset:51456
    ds_read_b128 v[80:83], v7 offset:64
    v_mfma_f32_32x32x16_bf16 v[128:143], v[76:79], v[68:71], v[128:143]
    v_mfma_f32_32x32x16_bf16 v[144:159], v[84:87], v[68:71], v[144:159]
    s_waitcnt lgkmcnt(0)
    ds_read_b128 v[68:71], v5 offset:49152
    ds_read_b64_tr_b16 v[76:77], v6 offset:52224
    ds_read_b64_tr_b16 v[78:79], v6 offset:52480
    ds_read_b128 v[84:87], v7 offset:96
    v_mfma_f32_32x32x16_bf16 v[128:143], v[72:75], v[64:67], v[128:143]
    v_mfma_f32_32x32x16_bf16 v[144:159], v[80:83], v[64:67], v[144:159]
    s_waitcnt lgkmcnt(0)
    v_mfma_f32_32x32x16_bf16 v[128:143], v[76:79], v[68:71], v[128:143]
    v_mfma_f32_32x32x16_bf16 v[144:159], v[84:87], v[68:71], v[144:159]
    s_branch L_kv_out
L_kv_v:
    s_waitcnt vmcnt(8)
    s_barrier
    ds_read_b128 v[64:67], v2 offset:0
    ds_read_b64_tr_b16 v[72:73], v6 offset:0
    ds_read_b64_tr_b16 v[74:75], v6 offset:256
    s_waitcnt lgkmcnt(0)
    ds_read_b128 v[68:71], v3 offset:0
    ds_read_b64_tr_b16 v[76:77], v6 offset:1024
    ds_read_b64_tr_b16 v[78:79], v6 offset:1280
    v_mfma_f32_32x32x16_bf16 v[128:143], v[64:67], v[72:75], v[128:143]
    s_waitcnt lgkmcnt(0)
    ds_read_b128 v[64:67], v4 offset:0
    ds_read_b64_tr_b16 v[72:73], v6 offset:2048
    ds_read_b64_tr_b16 v[74:75], v6 offset:2304
    v_mfma_f32_32x32x16_bf16 v[128:143], v[68:71], v[76:79], v[128:143]
    s_waitcnt lgkmcnt(0)
    ds_read_b128 v[68:71], v5 offset:0
    ds_read_b64_tr_b16 v[76:77], v6 offset:3072
    ds_read_b64_tr_b16 v[78:79], v6 offset:3328
    v_mfma_f32_32x32x16_bf16 v[128:143], v[64:67], v[72:75], v[128:143]
    s_waitcnt lgkmcnt(0)
    s_waitcnt vmcnt(4)
    s_barrier
    ds_read_b128 v[64:67], v2 offset:16384
    ds_read_b64_tr_b16 v[72:73], v6 offset:16384
    ds_read_b64_tr_b16 v[74:75], v6 offset:16640
    v_mfma_f32_32x32x16_bf16 v[128:143], v[68:71], v[76:79], v[128:143]
    s_add_u32 m0, s36, 49152
    s_add_u32 s30, s34, 384
    buffer_load_dwordx4 v8, s[8:11], s30 offen offset:0 lds
    buffer_load_dwordx4 v9, s[8:11], s30 offen offset:1024 lds
    s_add_u32 m0, s37, 49152
    s_add_u32 s30, s35, 12288
    buffer_load_dwordx4 v14, s[12:15], s30 offen lds
    s_add_u32 m0, s37, 53248
    s_nop 0
    buffer_load_dwordx4 v14, s[16:19], s30 offen lds
    s_waitcnt lgkmcnt(0)
    ds_read_b128 v[68:71], v3 offset:16384
    ds_read_b64_tr_b16 v[76:77], v6 offset:17408
    ds_read_b64_tr_b16 v[78:79], v6 offset:17664
    v_mfma_f32_32x32x16_bf16 v[128:143], v[64:67], v[72:75], v[128:143]
    s_waitcnt lgkmcnt(0)
    ds_read_b128 v[64:67], v4 offset:16384
    ds_read_b64_tr_b16 v[72:73], v6 offset:18432
    ds_read_b64_tr_b16 v[74:75], v6 offset:18688
    v_mfma_f32_32x32x16_bf16 v[128:143], v[68:71], v[76:79], v[128:143]
    s_waitcnt lgkmcnt(0)
    ds_read_b128 v[68:71], v5 offset:16384
    ds_read_b64_tr_b16 v[76:77], v6 offset:19456
    ds_read_b64_tr_b16 v[78:79], v6 offset:19712
    v_mfma_f32_32x32x16_bf16 v[128:143], v[64:67], v[72:75], v[128:143]
    s_waitcnt lgkmcnt(0)
    s_waitcnt vmcnt(4)
    s_barrier
    ds_read_b128 v[64:67], v2 offset:32768
    ds_read_b64_tr_b16 v[72:73], v6 offset:32768
    ds_read_b64_tr_b16 v[74:75], v6 offset:33024
    v_mfma_f32_32x32x16_bf16 v[128:143], v[68:71], v[76:79], v[128:143]
    s_add_u32 m0, s36, 0
    s_add_u32 s30, s34, 512
    buffer_load_dwordx4 v8, s[8:11], s30 offen offset:0 lds
    buffer_load_dwordx4 v9, s[8:11], s30 offen offset:1024 lds
    s_add_u32 m0, s37, 0
    s_add_u32 s30, s35, 16384
    buffer_load_dwordx4 v14, s[12:15], s30 offen lds
    s_add_u32 m0, s37, 4096
    s_nop 0
    buffer_load_dwordx4 v14, s[16:19], s30 offen lds
    s_waitcnt lgkmcnt(0)
    ds_read_b128 v[68:71], v3 offset:32768
    ds_read_b64_tr_b16 v[76:77], v6 offset:33792
    ds_read_b64_tr_b16 v[78:79], v6 offset:34048
    v_mfma_f32_32x32x16_bf16 v[128:143], v[64:67], v[72:75], v[128:143]
    s_waitcnt lgkmcnt(0)
    ds_read_b128 v[64:67], v4 offset:32768
    ds_read_b64_tr_b16 v[72:73], v6 offset:34816
    ds_read_b64_tr_b16 v[74:75], v6 offset:35072
    v_mfma_f32_32x32x16_bf16 v[128:143], v[68:71], v[76:79], v[128:143]
    s_waitcnt lgkmcnt(0)
    ds_read_b128 v[68:71], v5 offset:32768
    ds_read_b64_tr_b16 v[76:77], v6 offset:35840
    ds_read_b64_tr_b16 v[78:79], v6 offset:36096
    v_mfma_f32_32x32x16_bf16 v[128:143], v[64:67], v[72:75], v[128:143]
    s_waitcnt lgkmcnt(0)
    s_waitcnt vmcnt(4)
    s_barrier
    ds_read_b128 v[64:67], v2 offset:49152
    ds_read_b64_tr_b16 v[72:73], v6 offset:49152
    ds_read_b64_tr_b16 v[74:75], v6 offset:49408
    v_mfma_f32_32x32x16_bf16 v[128:143], v[68:71], v[76:79], v[128:143]
    s_add_u32 m0, s36, 16384
    s_add_u32 s30, s34, 640
    buffer_load_dwordx4 v8, s[8:11], s30 offen offset:0 lds
    buffer_load_dwordx4 v9, s[8:11], s30 offen offset:1024 lds
    s_add_u32 m0, s37, 16384
    s_add_u32 s30, s35, 20480
    buffer_load_dwordx4 v14, s[12:15], s30 offen lds
    s_add_u32 m0, s37, 20480
    s_nop 0
    buffer_load_dwordx4 v14, s[16:19], s30 offen lds
    s_waitcnt lgkmcnt(0)
    ds_read_b128 v[68:71], v3 offset:49152
    ds_read_b64_tr_b16 v[76:77], v6 offset:50176
    ds_read_b64_tr_b16 v[78:79], v6 offset:50432
    v_mfma_f32_32x32x16_bf16 v[128:143], v[64:67], v[72:75], v[128:143]
    s_waitcnt lgkmcnt(0)
    ds_read_b128 v[64:67], v4 offset:49152
    ds_read_b64_tr_b16 v[72:73], v6 offset:51200
    ds_read_b64_tr_b16 v[74:75], v6 offset:51456
    v_mfma_f32_32x32x16_bf16 v[128:143], v[68:71], v[76:79], v[128:143]
    s_waitcnt lgkmcnt(0)
    ds_read_b128 v[68:71], v5 offset:49152
    ds_read_b64_tr_b16 v[76:77], v6 offset:52224
    ds_read_b64_tr_b16 v[78:79], v6 offset:52480
    v_mfma_f32_32x32x16_bf16 v[128:143], v[64:67], v[72:75], v[128:143]
    s_waitcnt lgkmcnt(0)
    s_waitcnt vmcnt(4)
    s_barrier
    ds_read_b128 v[64:67], v2 offset:0
    ds_read_b64_tr_b16 v[72:73], v6 offset:0
    ds_read_b64_tr_b16 v[74:75], v6 offset:256
    v_mfma_f32_32x32x16_bf16 v[128:143], v[68:71], v[76:79], v[128:143]
    s_add_u32 m0, s36, 32768
    s_add_u32 s30, s34, 768
    buffer_load_dwordx4 v8, s[8:11], s30 offen offset:0 lds
    buffer_load_dwordx4 v9, s[8:11], s30 offen offset:1024 lds
    s_add_u32 m0, s37, 32768
    s_add_u32 s30, s35, 24576
    buffer_load_dwordx4 v14, s[12:15], s30 offen lds
    s_add_u32 m0, s37, 36864
    s_nop 0
    buffer_load_dwordx4 v14, s[16:19], s30 offen lds
    s_waitcnt lgkmcnt(0)
    ds_read_b128 v[68:71], v3 offset:0
    ds_read_b64_tr_b16 v[76:77], v6 offset:1024
    ds_read_b64_tr_b16 v[78:79], v6 offset:1280
    v_mfma_f32_32x32x16_bf16 v[128:143], v[64:67], v[72:75], v[128:143]
    s_waitcnt lgkmcnt(0)
    ds_read_b128 v[64:67], v4 offset:0
    ds_read_b64_tr_b16 v[72:73], v6 offset:2048
    ds_read_b64_tr_b16 v[74:75], v6 offset:2304
    v_mfma_f32_32x32x16_bf16 v[128:143], v[68:71], v[76:79], v[128:143]
    s_waitcnt lgkmcnt(0)
    ds_read_b128 v[68:71], v5 offset:0
    ds_read_b64_tr_b16 v[76:77], v6 offset:3072
    ds_read_b64_tr_b16 v[78:79], v6 offset:3328
    v_mfma_f32_32x32x16_bf16 v[128:143], v[64:67], v[72:75], v[128:143]
    s_waitcnt lgkmcnt(0)
    s_waitcnt vmcnt(4)
    s_barrier
    ds_read_b128 v[64:67], v2 offset:16384
    ds_read_b64_tr_b16 v[72:73], v6 offset:16384
    ds_read_b64_tr_b16 v[74:75], v6 offset:16640
    v_mfma_f32_32x32x16_bf16 v[128:143], v[68:71], v[76:79], v[128:143]
    s_add_u32 m0, s36, 49152
    s_add_u32 s30, s34, 896
    buffer_load_dwordx4 v8, s[8:11], s30 offen offset:0 lds
    buffer_load_dwordx4 v9, s[8:11], s30 offen offset:1024 lds
    s_add_u32 m0, s37, 49152
    s_add_u32 s30, s35, 28672
    buffer_load_dwordx4 v14, s[12:15], s30 offen lds
    s_add_u32 m0, s37, 53248
    s_nop 0
    buffer_load_dwordx4 v14, s[16:19], s30 offen lds
    s_waitcnt lgkmcnt(0)
    ds_read_b128 v[68:71], v3 offset:16384
    ds_read_b64_tr_b16 v[76:77], v6 offset:17408
    ds_read_b64_tr_b16 v[78:79], v6 offset:17664
    v_mfma_f32_32x32x16_bf16 v[128:143], v[64:67], v[72:75], v[128:143]
    s_waitcnt lgkmcnt(0)
    ds_read_b128 v[64:67], v4 offset:16384
    ds_read_b64_tr_b16 v[72:73], v6 offset:18432
    ds_read_b64_tr_b16 v[74:75], v6 offset:18688
    v_mfma_f32_32x32x16_bf16 v[128:143], v[68:71], v[76:79], v[128:143]
    s_waitcnt lgkmcnt(0)
    ds_read_b128 v[68:71], v5 offset:16384
    ds_read_b64_tr_b16 v[76:77], v6 offset:19456
    ds_read_b64_tr_b16 v[78:79], v6 offset:19712
    v_mfma_f32_32x32x16_bf16 v[128:143], v[64:67], v[72:75], v[128:143]
    s_waitcnt lgkmcnt(0)
    s_waitcnt vmcnt(4)
    s_barrier
    ds_read_b128 v[64:67], v2 offset:32768
    ds_read_b64_tr_b16 v[72:73], v6 offset:32768
    ds_read_b64_tr_b16 v[74:75], v6 offset:33024
    v_mfma_f32_32x32x16_bf16 v[128:143], v[68:71], v[76:79], v[128:143]
    s_add_u32 m0, s36, 0
    s_add_u32 s30, s34, 1024
    buffer_load_dwordx4 v8, s[8:11], s30 offen offset:0 lds
    buffer_load_dwordx4 v9, s[8:11], s30 offen offset:1024 lds
    s_add_u32 m0, s37, 0
    s_add_u32 s30, s35, 32768
    buffer_load_dwordx4 v14, s[12:15], s30 offen lds
    s_add_u32 m0, s37, 4096
    s_nop 0
    buffer_load_dwordx4 v14, s[16:19], s30 offen lds
    s_waitcnt lgkmcnt(0)
    ds_read_b128 v[68:71], v3 offset:32768
    ds_read_b64_tr_b16 v[76:77], v6 offset:33792
    ds_read_b64_tr_b16 v[78:79], v6 offset:34048
    v_mfma_f32_32x32x16_bf16 v[128:143], v[64:67], v[72:75], v[128:143]
    s_waitcnt lgkmcnt(0)
    ds_read_b128 v[64:67], v4 offset:32768
    ds_read_b64_tr_b16 v[72:73], v6 offset:34816
    ds_read_b64_tr_b16 v[74:75], v6 offset:35072
    v_mfma_f32_32x32x16_bf16 v[128:143], v[68:71], v[76:79], v[128:143]
    s_waitcnt lgkmcnt(0)
    ds_read_b128 v[68:71], v5 offset:32768
    ds_read_b64_tr_b16 v[76:77], v6 offset:35840
    ds_read_b64_tr_b16 v[78:79], v6 offset:36096
    v_mfma_f32_32x32x16_bf16 v[128:143], v[64:67], v[72:75], v[128:143]
    s_waitcnt lgkmcnt(0)
    s_waitcnt vmcnt(4)
    s_barrier
    ds_read_b128 v[64:67], v2 offset:49152
    ds_read_b64_tr_b16 v[72:73], v6 offset:49152
    ds_read_b64_tr_b16 v[74:75], v6 offset:49408
    v_mfma_f32_32x32x16_bf16 v[128:143], v[68:71], v[76:79], v[128:143]
    s_add_u32 m0, s36, 16384
    s_add_u32 s30, s34, 1152
    buffer_load_dwordx4 v8, s[8:11], s30 offen offset:0 lds
    buffer_load_dwordx4 v9, s[8:11], s30 offen offset:1024 lds
    s_add_u32 m0, s37, 16384
    s_add_u32 s30, s35, 36864
    buffer_load_dwordx4 v14, s[12:15], s30 offen lds
    s_add_u32 m0, s37, 20480
    s_nop 0
    buffer_load_dwordx4 v14, s[16:19], s30 offen lds
    s_waitcnt lgkmcnt(0)
    ds_read_b128 v[68:71], v3 offset:49152
    ds_read_b64_tr_b16 v[76:77], v6 offset:50176
    ds_read_b64_tr_b16 v[78:79], v6 offset:50432
    v_mfma_f32_32x32x16_bf16 v[128:143], v[64:67], v[72:75], v[128:143]
    s_waitcnt lgkmcnt(0)
    ds_read_b128 v[64:67], v4 offset:49152
    ds_read_b64_tr_b16 v[72:73], v6 offset:51200
    ds_read_b64_tr_b16 v[74:75], v6 offset:51456
    v_mfma_f32_32x32x16_bf16 v[128:143], v[68:71], v[76:79], v[128:143]
    s_waitcnt lgkmcnt(0)
    ds_read_b128 v[68:71], v5 offset:49152
    ds_read_b64_tr_b16 v[76:77], v6 offset:52224
    ds_read_b64_tr_b16 v[78:79], v6 offset:52480
    v_mfma_f32_32x32x16_bf16 v[128:143], v[64:67], v[72:75], v[128:143]
    s_waitcnt lgkmcnt(0)
    s_waitcnt vmcnt(4)
    s_barrier
    ds_read_b128 v[64:67], v2 offset:0
    ds_read_b64_tr_b16 v[72:73], v6 offset:0
    ds_read_b64_tr_b16 v[74:75], v6 offset:256
    v_mfma_f32_32x32x16_bf16 v[128:143], v[68:71], v[76:79], v[128:143]
    s_add_u32 m0, s36, 32768
    s_add_u32 s30, s34, 1280
    buffer_load_dwordx4 v8, s[8:11], s30 offen offset:0 lds
    buffer_load_dwordx4 v9, s[8:11], s30 offen offset:1024 lds
    s_add_u32 m0, s37, 32768
    s_add_u32 s30, s35, 40960
    buffer_load_dwordx4 v14, s[12:15], s30 offen lds
    s_add_u32 m0, s37, 36864
    s_nop 0
    buffer_load_dwordx4 v14, s[16:19], s30 offen lds
    s_waitcnt lgkmcnt(0)
    ds_read_b128 v[68:71], v3 offset:0
    ds_read_b64_tr_b16 v[76:77], v6 offset:1024
    ds_read_b64_tr_b16 v[78:79], v6 offset:1280
    v_mfma_f32_32x32x16_bf16 v[128:143], v[64:67], v[72:75], v[128:143]
    s_waitcnt lgkmcnt(0)
    ds_read_b128 v[64:67], v4 offset:0
    ds_read_b64_tr_b16 v[72:73], v6 offset:2048
    ds_read_b64_tr_b16 v[74:75], v6 offset:2304
    v_mfma_f32_32x32x16_bf16 v[128:143], v[68:71], v[76:79], v[128:143]
    s_waitcnt lgkmcnt(0)
    ds_read_b128 v[68:71], v5 offset:0
    ds_read_b64_tr_b16 v[76:77], v6 offset:3072
    ds_read_b64_tr_b16 v[78:79], v6 offset:3328
    v_mfma_f32_32x32x16_bf16 v[128:143], v[64:67], v[72:75], v[128:143]
    s_waitcnt lgkmcnt(0)
    s_waitcnt vmcnt(4)
    s_barrier
    ds_read_b128 v[64:67], v2 offset:16384
    ds_read_b64_tr_b16 v[72:73], v6 offset:16384
    ds_read_b64_tr_b16 v[74:75], v6 offset:16640
    v_mfma_f32_32x32x16_bf16 v[128:143], v[68:71], v[76:79], v[128:143]
    s_add_u32 m0, s36, 49152
    s_add_u32 s30, s34, 1408
    buffer_load_dwordx4 v8, s[8:11], s30 offen offset:0 lds
    buffer_load_dwordx4 v9, s[8:11], s30 offen offset:1024 lds
    s_add_u32 m0, s37, 49152
    s_add_u32 s30, s35, 45056
    buffer_load_dwordx4 v14, s[12:15], s30 offen lds
    s_add_u32 m0, s37, 53248
    s_nop 0
    buffer_load_dwordx4 v14, s[16:19], s30 offen lds
    s_waitcnt lgkmcnt(0)
    ds_read_b128 v[68:71], v3 offset:16384
    ds_read_b64_tr_b16 v[76:77], v6 offset:17408
    ds_read_b64_tr_b16 v[78:79], v6 offset:17664
    v_mfma_f32_32x32x16_bf16 v[128:143], v[64:67], v[72:75], v[128:143]
    s_waitcnt lgkmcnt(0)
    ds_read_b128 v[64:67], v4 offset:16384
    ds_read_b64_tr_b16 v[72:73], v6 offset:18432
    ds_read_b64_tr_b16 v[74:75], v6 offset:18688
    v_mfma_f32_32x32x16_bf16 v[128:143], v[68:71], v[76:79], v[128:143]
    s_waitcnt lgkmcnt(0)
    ds_read_b128 v[68:71], v5 offset:16384
    ds_read_b64_tr_b16 v[76:77], v6 offset:19456
    ds_read_b64_tr_b16 v[78:79], v6 offset:19712
    v_mfma_f32_32x32x16_bf16 v[128:143], v[64:67], v[72:75], v[128:143]
    s_waitcnt lgkmcnt(0)
    s_waitcnt vmcnt(4)
    s_barrier
    ds_read_b128 v[64:67], v2 offset:32768
    ds_read_b64_tr_b16 v[72:73], v6 offset:32768
    ds_read_b64_tr_b16 v[74:75], v6 offset:33024
    v_mfma_f32_32x32x16_bf16 v[128:143], v[68:71], v[76:79], v[128:143]
    s_add_u32 m0, s36, 0
    s_add_u32 s30, s34, 1536
    buffer_load_dwordx4 v8, s[8:11], s30 offen offset:0 lds
    buffer_load_dwordx4 v9, s[8:11], s30 offen offset:1024 lds
    s_add_u32 m0, s37, 0
    s_add_u32 s30, s35, 49152
    buffer_load_dwordx4 v14, s[12:15], s30 offen lds
    s_add_u32 m0, s37, 4096
    s_nop 0
    buffer_load_dwordx4 v14, s[16:19], s30 offen lds
    s_waitcnt lgkmcnt(0)
    ds_read_b128 v[68:71], v3 offset:32768
    ds_read_b64_tr_b16 v[76:77], v6 offset:33792
    ds_read_b64_tr_b16 v[78:79], v6 offset:34048
    v_mfma_f32_32x32x16_bf16 v[128:143], v[64:67], v[72:75], v[128:143]
    s_waitcnt lgkmcnt(0)
    ds_read_b128 v[64:67], v4 offset:32768
    ds_read_b64_tr_b16 v[72:73], v6 offset:34816
    ds_read_b64_tr_b16 v[74:75], v6 offset:35072
    v_mfma_f32_32x32x16_bf16 v[128:143], v[68:71], v[76:79], v[128:143]
    s_waitcnt lgkmcnt(0)
    ds_read_b128 v[68:71], v5 offset:32768
    ds_read_b64_tr_b16 v[76:77], v6 offset:35840
    ds_read_b64_tr_b16 v[78:79], v6 offset:36096
    v_mfma_f32_32x32x16_bf16 v[128:143], v[64:67], v[72:75], v[128:143]
    s_waitcnt lgkmcnt(0)
    s_waitcnt vmcnt(4)
    s_barrier
    ds_read_b128 v[64:67], v2 offset:49152
    ds_read_b64_tr_b16 v[72:73], v6 offset:49152
    ds_read_b64_tr_b16 v[74:75], v6 offset:49408
    v_mfma_f32_32x32x16_bf16 v[128:143], v[68:71], v[76:79], v[128:143]
    s_add_u32 m0, s36, 16384
    s_add_u32 s30, s34, 1664
    buffer_load_dwordx4 v8, s[8:11], s30 offen offset:0 lds
    buffer_load_dwordx4 v9, s[8:11], s30 offen offset:1024 lds
    s_add_u32 m0, s37, 16384
    s_add_u32 s30, s35, 53248
    buffer_load_dwordx4 v14, s[12:15], s30 offen lds
    s_add_u32 m0, s37, 20480
    s_nop 0
    buffer_load_dwordx4 v14, s[16:19], s30 offen lds
    s_waitcnt lgkmcnt(0)
    ds_read_b128 v[68:71], v3 offset:49152
    ds_read_b64_tr_b16 v[76:77], v6 offset:50176
    ds_read_b64_tr_b16 v[78:79], v6 offset:50432
    v_mfma_f32_32x32x16_bf16 v[128:143], v[64:67], v[72:75], v[128:143]
    s_waitcnt lgkmcnt(0)
    ds_read_b128 v[64:67], v4 offset:49152
    ds_read_b64_tr_b16 v[72:73], v6 offset:51200
    ds_read_b64_tr_b16 v[74:75], v6 offset:51456
    v_mfma_f32_32x32x16_bf16 v[128:143], v[68:71], v[76:79], v[128:143]
    s_waitcnt lgkmcnt(0)
    ds_read_b128 v[68:71], v5 offset:49152
    ds_read_b64_tr_b16 v[76:77], v6 offset:52224
    ds_read_b64_tr_b16 v[78:79], v6 offset:52480
    v_mfma_f32_32x32x16_bf16 v[128:143], v[64:67], v[72:75], v[128:143]
    s_waitcnt lgkmcnt(0)
    s_waitcnt vmcnt(4)
    s_barrier
    ds_read_b128 v[64:67], v2 offset:0
    ds_read_b64_tr_b16 v[72:73], v6 offset:0
    ds_read_b64_tr_b16 v[74:75], v6 offset:256
    v_mfma_f32_32x32x16_bf16 v[128:143], v[68:71], v[76:79], v[128:143]
    s_add_u32 m0, s36, 32768
    s_add_u32 s30, s34, 1792
    buffer_load_dwordx4 v8, s[8:11], s30 offen offset:0 lds
    buffer_load_dwordx4 v9, s[8:11], s30 offen offset:1024 lds
    s_add_u32 m0, s37, 32768
    s_add_u32 s30, s35, 57344
    buffer_load_dwordx4 v14, s[12:15], s30 offen lds
    s_add_u32 m0, s37, 36864
    s_nop 0
    buffer_load_dwordx4 v14, s[16:19], s30 offen lds
    s_waitcnt lgkmcnt(0)
    ds_read_b128 v[68:71], v3 offset:0
    ds_read_b64_tr_b16 v[76:77], v6 offset:1024
    ds_read_b64_tr_b16 v[78:79], v6 offset:1280
    v_mfma_f32_32x32x16_bf16 v[128:143], v[64:67], v[72:75], v[128:143]
    s_waitcnt lgkmcnt(0)
    ds_read_b128 v[64:67], v4 offset:0
    ds_read_b64_tr_b16 v[72:73], v6 offset:2048
    ds_read_b64_tr_b16 v[74:75], v6 offset:2304
    v_mfma_f32_32x32x16_bf16 v[128:143], v[68:71], v[76:79], v[128:143]
    s_waitcnt lgkmcnt(0)
    ds_read_b128 v[68:71], v5 offset:0
    ds_read_b64_tr_b16 v[76:77], v6 offset:3072
    ds_read_b64_tr_b16 v[78:79], v6 offset:3328
    v_mfma_f32_32x32x16_bf16 v[128:143], v[64:67], v[72:75], v[128:143]
    s_waitcnt lgkmcnt(0)
    s_waitcnt vmcnt(4)
    s_barrier
    ds_read_b128 v[64:67], v2 offset:16384
    ds_read_b64_tr_b16 v[72:73], v6 offset:16384
    ds_read_b64_tr_b16 v[74:75], v6 offset:16640
    v_mfma_f32_32x32x16_bf16 v[128:143], v[68:71], v[76:79], v[128:143]
    s_add_u32 m0, s36, 49152
    s_add_u32 s30, s34, 1920
    buffer_load_dwordx4 v8, s[8:11], s30 offen offset:0 lds
    buffer_load_dwordx4 v9, s[8:11], s30 offen offset:1024 lds
    s_add_u32 m0, s37, 49152
    s_add_u32 s30, s35, 61440
    buffer_load_dwordx4 v14, s[12:15], s30 offen lds
    s_add_u32 m0, s37, 53248
    s_nop 0
    buffer_load_dwordx4 v14, s[16:19], s30 offen lds
    s_waitcnt lgkmcnt(0)
    ds_read_b128 v[68:71], v3 offset:16384
    ds_read_b64_tr_b16 v[76:77], v6 offset:17408
    ds_read_b64_tr_b16 v[78:79], v6 offset:17664
    v_mfma_f32_32x32x16_bf16 v[128:143], v[64:67], v[72:75], v[128:143]
    s_waitcnt lgkmcnt(0)
    ds_read_b128 v[64:67], v4 offset:16384
    ds_read_b64_tr_b16 v[72:73], v6 offset:18432
    ds_read_b64_tr_b16 v[74:75], v6 offset:18688
    v_mfma_f32_32x32x16_bf16 v[128:143], v[68:71], v[76:79], v[128:143]
    s_waitcnt lgkmcnt(0)
    ds_read_b128 v[68:71], v5 offset:16384
    ds_read_b64_tr_b16 v[76:77], v6 offset:19456
    ds_read_b64_tr_b16 v[78:79], v6 offset:19712
    v_mfma_f32_32x32x16_bf16 v[128:143], v[64:67], v[72:75], v[128:143]
    s_waitcnt lgkmcnt(0)
    s_waitcnt vmcnt(4)
    s_barrier
    ds_read_b128 v[64:67], v2 offset:32768
    ds_read_b64_tr_b16 v[72:73], v6 offset:32768
    ds_read_b64_tr_b16 v[74:75], v6 offset:33024
    v_mfma_f32_32x32x16_bf16 v[128:143], v[68:71], v[76:79], v[128:143]
    s_waitcnt lgkmcnt(0)
    ds_read_b128 v[68:71], v3 offset:32768
    ds_read_b64_tr_b16 v[76:77], v6 offset:33792
    ds_read_b64_tr_b16 v[78:79], v6 offset:34048
    v_mfma_f32_32x32x16_bf16 v[128:143], v[64:67], v[72:75], v[128:143]
    s_waitcnt lgkmcnt(0)
    ds_read_b128 v[64:67], v4 offset:32768
    ds_read_b64_tr_b16 v[72:73], v6 offset:34816
    ds_read_b64_tr_b16 v[74:75], v6 offset:35072
    v_mfma_f32_32x32x16_bf16 v[128:143], v[68:71], v[76:79], v[128:143]
    s_waitcnt lgkmcnt(0)
    ds_read_b128 v[68:71], v5 offset:32768
    ds_read_b64_tr_b16 v[76:77], v6 offset:35840
    ds_read_b64_tr_b16 v[78:79], v6 offset:36096
    v_mfma_f32_32x32x16_bf16 v[128:143], v[64:67], v[72:75], v[128:143]
    s_waitcnt lgkmcnt(0)
    s_waitcnt vmcnt(0)
    s_barrier
    ds_read_b128 v[64:67], v2 offset:49152
    ds_read_b64_tr_b16 v[72:73], v6 offset:49152
    ds_read_b64_tr_b16 v[74:75], v6 offset:49408
    v_mfma_f32_32x32x16_bf16 v[128:143], v[68:71], v[76:79], v[128:143]
    s_waitcnt lgkmcnt(0)
    ds_read_b128 v[68:71], v3 offset:49152
    ds_read_b64_tr_b16 v[76:77], v6 offset:50176
    ds_read_b64_tr_b16 v[78:79], v6 offset:50432
    v_mfma_f32_32x32x16_bf16 v[128:143], v[64:67], v[72:75], v[128:143]
    s_waitcnt lgkmcnt(0)
    ds_read_b128 v[64:67], v4 offset:49152
    ds_read_b64_tr_b16 v[72:73], v6 offset:51200
    ds_read_b64_tr_b16 v[74:75], v6 offset:51456
    v_mfma_f32_32x32x16_bf16 v[128:143], v[68:71], v[76:79], v[128:143]
    s_waitcnt lgkmcnt(0)
    ds_read_b128 v[68:71], v5 offset:49152
    ds_read_b64_tr_b16 v[76:77], v6 offset:52224
    ds_read_b64_tr_b16 v[78:79], v6 offset:52480
    v_mfma_f32_32x32x16_bf16 v[128:143], v[64:67], v[72:75], v[128:143]
    s_waitcnt lgkmcnt(0)
    v_mfma_f32_32x32x16_bf16 v[128:143], v[68:71], v[76:79], v[128:143]
L_kv_out:
    s_waitcnt vmcnt(0) lgkmcnt(0)
    v_mov_b32 v119, 0
    buffer_load_dword v118, v119, s[20:23], 0 offen sc1
    s_nop 15
    s_lshl_b32 s28, s27, 1
    s_and_b32 s29, s3, 1
    s_add_u32 s28, s28, s29
    s_lshl_b32 s30, s28, 12
    s_lshr_b32 s29, s3, 1
    s_lshl_b32 s29, s29, 11
    s_add_u32 s30, s30, s29
    s_add_u32 s30, s30, 65536
    v_cvt_pk_bf16_f32 v16, v128, v129
    v_cvt_pk_bf16_f32 v17, v130, v131
    v_cvt_pk_bf16_f32 v18, v132, v133
    v_cvt_pk_bf16_f32 v19, v134, v135
    v_cvt_pk_bf16_f32 v20, v136, v137
    v_cvt_pk_bf16_f32 v21, v138, v139
    v_cvt_pk_bf16_f32 v22, v140, v141
    v_cvt_pk_bf16_f32 v23, v142, v143
    buffer_store_dwordx4 v[16:19], v14, s[4:7], s30 offen offset:0 sc1
    buffer_store_dwordx4 v[20:23], v14, s[4:7], s30 offen offset:1024 sc1
    s_cmp_ge_u32 s3, 2
    s_cbranch_scc1 L_nog_8
    s_mov_b32 s40, 0xbfb8aa3b
    v_mul_f32 v24, s40, v144
    v_exp_f32 v24, v24
    s_nop 0
    v_add_f32 v24, 1.0, v24
    v_rcp_f32 v24, v24
    s_lshl_b32 s28, s28, 7
    s_add_u32 s28, s28, 8192
    v_lshlrev_b32 v25, 2, v0
    s_bfm_b64 exec, 32, 0
    buffer_store_dword v24, v25, s[4:7], s28 offen sc1
    s_mov_b64 exec, -1
L_nog_8:
    s_lshl_b32 s28, s27, 2
    s_waitcnt vmcnt(0) lgkmcnt(0)
    s_cmp_lg_u32 s3, 0
    s_cbranch_scc1 L_sig0_10
    v_readfirstlane_b32 s31, v118
    s_nop 2
    s_cmp_lg_u32 s31, 0
    s_cbranch_scc1 L_rdyok_11
    v_mov_b32 v17, 0
    s_bfm_b64 exec, 1, 0
    s_mov_b32 s39, 200000
L_poll_12:
    buffer_load_dword v118, v17, s[20:23], 0 offen sc1
    s_waitcnt vmcnt(0)
    v_cmp_ne_u32 vcc, 0, v118
    s_nop 3
    s_cmp_eq_u64 vcc, exec
    s_cbranch_scc1 L_polld_13
    s_sleep 4
    s_sub_u32 s39, s39, 1
    s_cmp_lg_u32 s39, 0
    s_cbranch_scc1 L_poll_12
L_polld_13:
    s_mov_b64 exec, -1
L_rdyok_11:
L_sig0_10:
    s_barrier
    s_cmp_lg_u32 s3, 0
    s_cbranch_scc1 L_sig_9
    v_mov_b32 v16, 1
    v_mov_b32 v17, 0
    s_mov_b64 exec, 1
    buffer_store_dword v16, v17, s[4:7], s28 offen sc1
    s_mov_b64 exec, -1
L_sig_9:
    s_mov_b32 s48, s80
    s_mov_b32 s49, s81
    s_mov_b32 s50, 0x200000
    s_mov_b32 s51, 0x20000
    s_sub_u32 s28, s68, 896
    s_mul_i32 s32, s28, 16384
    buffer_load_dword v112, v1, s[48:51], s32 offen
    s_add_u32 s32, s32, 8192
    buffer_load_dword v113, v1, s[48:51], s32 offen
    s_waitcnt vmcnt(0)
    s_setprio 0
L_final:
    s_setprio 0
    s_lshr_b32 s28, s24, 2
    s_lshl_b32 s28, s28, 3
    s_lshr_b32 s29, s25, 2
    s_add_u32 s27, s28, s29
    s_mov_b32 s12, s88
    s_mov_b32 s13, s89
    s_mov_b32 s14, 0x700000
    s_mov_b32 s15, 0x20000
    s_mov_b32 s16, s80
    s_mov_b32 s17, s81
    s_mov_b32 s18, 0x200000
    s_mov_b32 s19, 0x20000
    s_mov_b32 s8, s92
    s_mov_b32 s9, s93
    s_mov_b32 s10, 0x400000
    s_mov_b32 s11, 0x20000
    v_lshrrev_b32 v25, 3, v0
    v_lshlrev_b32 v25, 11, v25
    v_lshrrev_b32 v26, 4, v0
    v_lshlrev_b32 v26, 1, v26
    v_and_b32 v27, 7, v0
    v_xor_b32 v26, v26, v27
    v_lshlrev_b32 v26, 4, v26
    v_add_u32 v12, v25, v26
    v_add_u32 v13, 15360, v12
    v_add_u32 v14, 30720, v12
    v_add_u32 v15, 46080, v12
    s_lshl_b32 s37, s3, 14
    s_lshl_b32 s28, s27, 7
    s_mul_i32 s35, s3, 1835008
    s_add_u32 s35, s35, s28
    s_lshl_b32 s57, s3, 19
    s_add_u32 s57, s57, s28
    s_add_u32 m0, s37, 0
    s_nop 0
    buffer_load_dwordx4 v12, s[12:15], s35 offen offset:0 lds
    buffer_load_dwordx4 v13, s[12:15], s35 offen offset:1024 lds
    buffer_load_dwordx4 v14, s[12:15], s35 offen offset:2048 lds
    buffer_load_dwordx4 v15, s[12:15], s35 offen offset:3072 lds
    s_add_u32 s35, s35, 65536
    s_add_u32 m0, s37, 4096
    s_nop 0
    buffer_load_dwordx4 v12, s[12:15], s35 offen offset:0 lds
    buffer_load_dwordx4 v13, s[12:15], s35 offen offset:1024 lds
    buffer_load_dwordx4 v14, s[12:15], s35 offen offset:2048 lds
    buffer_load_dwordx4 v15, s[12:15], s35 offen offset:3072 lds
    s_add_u32 s35, s35, 65536
    s_add_u32 m0, s37, 8192
    s_nop 0
    buffer_load_dwordx4 v12, s[12:15], s35 offen offset:0 lds
    buffer_load_dwordx4 v13, s[12:15], s35 offen offset:1024 lds
    buffer_load_dwordx4 v14, s[12:15], s35 offen offset:2048 lds
    buffer_load_dwordx4 v15, s[12:15], s35 offen offset:3072 lds
    s_add_u32 s35, s35, 65536
    s_add_u32 m0, s37, 12288
    s_nop 0
    buffer_load_dwordx4 v12, s[12:15], s35 offen offset:0 lds
    buffer_load_dwordx4 v13, s[12:15], s35 offen offset:1024 lds
    buffer_load_dwordx4 v14, s[12:15], s35 offen offset:2048 lds
    buffer_load_dwordx4 v15, s[12:15], s35 offen offset:3072 lds
    s_add_u32 s35, s35, 65536
    s_mul_i32 s28, s26, 917504
    s_add_u32 s28, s28, 8388608
    s_add_u32 s44, s4, s28
    s_addc_u32 s45, s5, 0
    s_mov_b32 s46, 917504
    s_mov_b32 s47, 0x20000
    s_lshl_b32 s28, s26, 18
    s_add_u32 s28, s28, 1048576
    s_add_u32 s48, s4, s28
    s_addc_u32 s49, s5, 0
    s_mov_b32 s50, 262144
    s_mov_b32 s51, 0x20000
    s_mul_i32 s56, s3, 229376
    s_lshl_b32 s58, s3, 16
    v_lshrrev_b32 v25, 4, v0
    v_bfe_u32 v26, v0, 2, 2
    v_lshlrev_b32 v27, 2, v25
    v_add_u32 v27, v27, v26
    v_lshrrev_b32 v25, 1, v27
    v_and_b32 v25, 3, v25
    v_lshlrev_b32 v27, 7, v27
    v_add_u32 v27, s37, v27
    v_and_b32 v26, 3, v0
    v_lshlrev_b32 v26, 3, v26
    v_add_u32 v27, v27, v26
    v_xor_b32 v26, 0, v25
    v_lshlrev_b32 v26, 5, v26
    v_add_u32 v4, v27, v26
    v_xor_b32 v26, 1, v25
    v_lshlrev_b32 v26, 5, v26
    v_add_u32 v5, v27, v26
    v_xor_b32 v26, 2, v25
    v_lshlrev_b32 v26, 5, v26
    v_add_u32 v6, v27, v26
    v_xor_b32 v26, 3, v25
    v_lshlrev_b32 v26, 5, v26
    v_add_u32 v7, v27, v26
    s_xor_b32 s28, s3, 0
    s_lshl_b32 s28, s28, 11
    v_lshlrev_b32 v8, 4, v0
    v_add_u32 v8, s28, v8
    s_xor_b32 s28, s3, 1
    s_lshl_b32 s28, s28, 11
    v_lshlrev_b32 v9, 4, v0
    v_add_u32 v9, s28, v9
    s_xor_b32 s28, s3, 2
    s_lshl_b32 s28, s28, 11
    v_lshlrev_b32 v10, 4, v0
    v_add_u32 v10, s28, v10
    s_xor_b32 s28, s3, 3
    s_lshl_b32 s28, s28, 11
    v_lshlrev_b32 v11, 4, v0
    v_add_u32 v11, s28, v11
    v_lshlrev_b32 v24, 2, v0
    s_lshl_b32 s28, s26, 7
    s_add_u32 s29, s28, 128
    v_add_u32 v26, s29, v24
    v_subrev_u32 v27, 56, v24
    v_cmp_gt_u32 vcc, 14, v0
    s_nop 1
    v_cndmask_b32 v26, v27, v26, vcc
    s_bfm_b64 exec, 46, 0
    s_mov_b32 s39, 200000
L_poll_14:
    buffer_load_dword v25, v26, s[4:7], 0 offen sc1
    s_waitcnt vmcnt(0)
    v_cmp_ne_u32 vcc, 0, v25
    s_nop 3
    s_cmp_eq_u64 vcc, exec
    s_cbranch_scc1 L_polld_15
    s_sleep 4
    s_sub_u32 s39, s39, 1
    s_cmp_lg_u32 s39, 0
    s_cbranch_scc1 L_poll_14
L_polld_15:
    s_mov_b64 exec, -1
    buffer_load_dwordx4 v[64:67], v8, s[44:47], s56 offen offset:0 sc1
    buffer_load_dwordx4 v[68:71], v8, s[44:47], s56 offen offset:1024 sc1
    buffer_load_dwordx4 v[72:75], v9, s[44:47], s56 offen offset:0 sc1
    buffer_load_dwordx4 v[76:79], v9, s[44:47], s56 offen offset:1024 sc1
    buffer_load_dwordx4 v[80:83], v10, s[44:47], s56 offen offset:0 sc1
    buffer_load_dwordx4 v[84:87], v10, s[44:47], s56 offen offset:1024 sc1
    buffer_load_dwordx4 v[88:91], v11, s[44:47], s56 offen offset:0 sc1
    buffer_load_dwordx4 v[92:95], v11, s[44:47], s56 offen offset:1024 sc1
    s_add_u32 s56, s56, 8192
    buffer_load_dwordx4 v[96:99], v8, s[44:47], s56 offen offset:0 sc1
    buffer_load_dwordx4 v[100:103], v8, s[44:47], s56 offen offset:1024 sc1
    buffer_load_dwordx4 v[104:107], v9, s[44:47], s56 offen offset:0 sc1
    buffer_load_dwordx4 v[108:111], v9, s[44:47], s56 offen offset:1024 sc1
    buffer_load_dwordx4 v[112:115], v10, s[44:47], s56 offen offset:0 sc1
    buffer_load_dwordx4 v[116:119], v10, s[44:47], s56 offen offset:1024 sc1
    buffer_load_dwordx4 v[120:123], v11, s[44:47], s56 offen offset:0 sc1
    buffer_load_dwordx4 v[124:127], v11, s[44:47], s56 offen offset:1024 sc1
    s_add_u32 s56, s56, 8192
    v_and_b32 v25, 15, v0
    v_lshlrev_b32 v25, 2, v25
    s_xor_b32 s28, s3, 0
    s_lshl_b32 s28, s28, 7
    s_lshl_b32 s29, s26, 9
    s_add_u32 s28, s28, s29
    s_add_u32 s28, s28, 8192
    buffer_load_dword v16, v25, s[4:7], s28 offen offset:0 sc1
    buffer_load_dword v17, v25, s[4:7], s28 offen offset:64 sc1
    s_xor_b32 s28, s3, 1
    s_lshl_b32 s28, s28, 7
    s_lshl_b32 s29, s26, 9
    s_add_u32 s28, s28, s29
    s_add_u32 s28, s28, 8192
    buffer_load_dword v18, v25, s[4:7], s28 offen offset:0 sc1
    buffer_load_dword v19, v25, s[4:7], s28 offen offset:64 sc1
    s_xor_b32 s28, s3, 2
    s_lshl_b32 s28, s28, 7
    s_lshl_b32 s29, s26, 9
    s_add_u32 s28, s28, s29
    s_add_u32 s28, s28, 8192
    buffer_load_dword v20, v25, s[4:7], s28 offen offset:0 sc1
    buffer_load_dword v21, v25, s[4:7], s28 offen offset:64 sc1
    s_xor_b32 s28, s3, 3
    s_lshl_b32 s28, s28, 7
    s_lshl_b32 s29, s26, 9
    s_add_u32 s28, s28, s29
    s_add_u32 s28, s28, 8192
    buffer_load_dword v22, v25, s[4:7], s28 offen offset:0 sc1
    buffer_load_dword v23, v25, s[4:7], s28 offen offset:64 sc1
    ds_read_b64_tr_b16 v[32:33], v4 offset:0
    ds_read_b64_tr_b16 v[34:35], v4 offset:2048
    ds_read_b64_tr_b16 v[36:37], v5 offset:0
    ds_read_b64_tr_b16 v[38:39], v5 offset:2048
    ds_read_b64_tr_b16 v[40:41], v6 offset:0
    ds_read_b64_tr_b16 v[42:43], v6 offset:2048
    ds_read_b64_tr_b16 v[44:45], v7 offset:0
    ds_read_b64_tr_b16 v[46:47], v7 offset:2048
    s_waitcnt lgkmcnt(0)
    s_waitcnt vmcnt(23)
    s_waitcnt vmcnt(22)
    v_mfma_f32_16x16x32_bf16 v[128:131], v[32:35], v[64:67], 0
    v_mfma_f32_16x16x32_bf16 v[132:135], v[36:39], v[64:67], 0
    ds_read_b64_tr_b16 v[48:49], v4 offset:4096
    v_mfma_f32_16x16x32_bf16 v[136:139], v[40:43], v[64:67], 0
    ds_read_b64_tr_b16 v[50:51], v4 offset:6144
    v_mfma_f32_16x16x32_bf16 v[140:143], v[44:47], v[64:67], 0
    ds_read_b64_tr_b16 v[52:53], v5 offset:4096
    v_mfma_f32_16x16x32_bf16 v[156:159], v[44:47], v[68:71], 0
    buffer_load_dwordx4 v[64:67], v8, s[44:47], s56 offen offset:0 sc1
    v_mfma_f32_16x16x32_bf16 v[152:155], v[40:43], v[68:71], 0
    ds_read_b64_tr_b16 v[54:55], v5 offset:6144
    v_mfma_f32_16x16x32_bf16 v[148:151], v[36:39], v[68:71], 0
    ds_read_b64_tr_b16 v[56:57], v6 offset:4096
    v_mfma_f32_16x16x32_bf16 v[144:147], v[32:35], v[68:71], 0
    ds_read_b64_tr_b16 v[58:59], v6 offset:6144
    s_waitcnt vmcnt(21)
    v_mfma_f32_16x16x32_bf16 v[160:163], v[32:35], v[72:75], 0
    buffer_load_dwordx4 v[68:71], v8, s[44:47], s56 offen offset:1024 sc1
    v_mfma_f32_16x16x32_bf16 v[164:167], v[36:39], v[72:75], 0
    ds_read_b64_tr_b16 v[60:61], v7 offset:4096
    v_mfma_f32_16x16x32_bf16 v[168:171], v[40:43], v[72:75], 0
    ds_read_b64_tr_b16 v[62:63], v7 offset:6144
    v_mfma_f32_16x16x32_bf16 v[172:175], v[44:47], v[72:75], 0
    v_mfma_f32_16x16x32_bf16 v[188:191], v[44:47], v[76:79], 0
    buffer_load_dwordx4 v[72:75], v9, s[44:47], s56 offen offset:0 sc1
    v_mfma_f32_16x16x32_bf16 v[184:187], v[40:43], v[76:79], 0
    s_add_u32 m0, s37, 0
    v_mfma_f32_16x16x32_bf16 v[180:183], v[36:39], v[76:79], 0
    buffer_load_dwordx4 v12, s[12:15], s35 offen offset:0 lds
    v_mfma_f32_16x16x32_bf16 v[176:179], v[32:35], v[76:79], 0
    buffer_load_dwordx4 v13, s[12:15], s35 offen offset:1024 lds
    s_waitcnt vmcnt(23)
    v_mfma_f32_16x16x32_bf16 v[192:195], v[32:35], v[80:83], 0
    buffer_load_dwordx4 v[76:79], v9, s[44:47], s56 offen offset:1024 sc1
    v_mfma_f32_16x16x32_bf16 v[196:199], v[36:39], v[80:83], 0
    buffer_load_dwordx4 v14, s[12:15], s35 offen offset:2048 lds
    v_mfma_f32_16x16x32_bf16 v[200:203], v[40:43], v[80:83], 0
    buffer_load_dwordx4 v15, s[12:15], s35 offen offset:3072 lds
    v_mfma_f32_16x16x32_bf16 v[204:207], v[44:47], v[80:83], 0
    s_add_u32 s35, s35, 65536
    v_mfma_f32_16x16x32_bf16 v[220:223], v[44:47], v[84:87], 0
    buffer_load_dwordx4 v[80:83], v10, s[44:47], s56 offen offset:0 sc1
    v_mfma_f32_16x16x32_bf16 v[216:219], v[40:43], v[84:87], 0
    v_mfma_f32_16x16x32_bf16 v[212:215], v[36:39], v[84:87], 0
    v_mfma_f32_16x16x32_bf16 v[208:211], v[32:35], v[84:87], 0
    s_waitcnt vmcnt(25)
    v_mfma_f32_16x16x32_bf16 v[224:227], v[32:35], v[88:91], 0
    buffer_load_dwordx4 v[84:87], v10, s[44:47], s56 offen offset:1024 sc1
    v_mfma_f32_16x16x32_bf16 v[228:231], v[36:39], v[88:91], 0
    v_mfma_f32_16x16x32_bf16 v[232:235], v[40:43], v[88:91], 0
    v_mfma_f32_16x16x32_bf16 v[236:239], v[44:47], v[88:91], 0
    v_mfma_f32_16x16x32_bf16 v[252:255], v[44:47], v[92:95], 0
    buffer_load_dwordx4 v[88:91], v11, s[44:47], s56 offen offset:0 sc1
    v_mfma_f32_16x16x32_bf16 v[248:251], v[40:43], v[92:95], 0
    v_mfma_f32_16x16x32_bf16 v[244:247], v[36:39], v[92:95], 0
    v_mfma_f32_16x16x32_bf16 v[240:243], v[32:35], v[92:95], 0
    buffer_load_dwordx4 v[92:95], v11, s[44:47], s56 offen offset:1024 sc1
    s_add_u32 s56, s56, 8192
    s_waitcnt lgkmcnt(0)
    s_waitcnt vmcnt(27)
    s_waitcnt vmcnt(26)
    v_mfma_f32_16x16x32_bf16 v[128:131], v[48:51], v[96:99], v[128:131]
    v_mfma_f32_16x16x32_bf16 v[132:135], v[52:55], v[96:99], v[132:135]
    ds_read_b64_tr_b16 v[32:33], v4 offset:8192
    v_mfma_f32_16x16x32_bf16 v[136:139], v[56:59], v[96:99], v[136:139]
    ds_read_b64_tr_b16 v[34:35], v4 offset:10240
    v_mfma_f32_16x16x32_bf16 v[140:143], v[60:63], v[96:99], v[140:143]
    ds_read_b64_tr_b16 v[36:37], v5 offset:8192
    v_mfma_f32_16x16x32_bf16 v[156:159], v[60:63], v[100:103], v[156:159]
    buffer_load_dwordx4 v[96:99], v8, s[44:47], s56 offen offset:0 sc1
    v_mfma_f32_16x16x32_bf16 v[152:155], v[56:59], v[100:103], v[152:155]
    ds_read_b64_tr_b16 v[38:39], v5 offset:10240
    v_mfma_f32_16x16x32_bf16 v[148:151], v[52:55], v[100:103], v[148:151]
    ds_read_b64_tr_b16 v[40:41], v6 offset:8192
    v_mfma_f32_16x16x32_bf16 v[144:147], v[48:51], v[100:103], v[144:147]
    ds_read_b64_tr_b16 v[42:43], v6 offset:10240
    s_waitcnt vmcnt(25)
    v_mfma_f32_16x16x32_bf16 v[160:163], v[48:51], v[104:107], v[160:163]
    buffer_load_dwordx4 v[100:103], v8, s[44:47], s56 offen offset:1024 sc1
    v_mfma_f32_16x16x32_bf16 v[164:167], v[52:55], v[104:107], v[164:167]
    ds_read_b64_tr_b16 v[44:45], v7 offset:8192
    v_mfma_f32_16x16x32_bf16 v[168:171], v[56:59], v[104:107], v[168:171]
    ds_read_b64_tr_b16 v[46:47], v7 offset:10240
    v_mfma_f32_16x16x32_bf16 v[172:175], v[60:63], v[104:107], v[172:175]
    v_mfma_f32_16x16x32_bf16 v[188:191], v[60:63], v[108:111], v[188:191]
    buffer_load_dwordx4 v[104:107], v9, s[44:47], s56 offen offset:0 sc1
    v_mfma_f32_16x16x32_bf16 v[184:187], v[56:59], v[108:111], v[184:187]
    s_add_u32 m0, s37, 4096
    v_mfma_f32_16x16x32_bf16 v[180:183], v[52:55], v[108:111], v[180:183]
    buffer_load_dwordx4 v12, s[12:15], s35 offen offset:0 lds
    v_mfma_f32_16x16x32_bf16 v[176:179], v[48:51], v[108:111], v[176:179]
    buffer_load_dwordx4 v13, s[12:15], s35 offen offset:1024 lds
    s_waitcnt vmcnt(27)
    v_mfma_f32_16x16x32_bf16 v[192:195], v[48:51], v[112:115], v[192:195]
    buffer_load_dwordx4 v[108:111], v9, s[44:47], s56 offen offset:1024 sc1
    v_mfma_f32_16x16x32_bf16 v[196:199], v[52:55], v[112:115], v[196:199]
    buffer_load_dwordx4 v14, s[12:15], s35 offen offset:2048 lds
    v_mfma_f32_16x16x32_bf16 v[200:203], v[56:59], v[112:115], v[200:203]
    buffer_load_dwordx4 v15, s[12:15], s35 offen offset:3072 lds
    v_mfma_f32_16x16x32_bf16 v[204:207], v[60:63], v[112:115], v[204:207]
    s_add_u32 s35, s35, 65536
    v_mfma_f32_16x16x32_bf16 v[220:223], v[60:63], v[116:119], v[220:223]
    buffer_load_dwordx4 v[112:115], v10, s[44:47], s56 offen offset:0 sc1
    v_mfma_f32_16x16x32_bf16 v[216:219], v[56:59], v[116:119], v[216:219]
    v_mfma_f32_16x16x32_bf16 v[212:215], v[52:55], v[116:119], v[212:215]
    v_mfma_f32_16x16x32_bf16 v[208:211], v[48:51], v[116:119], v[208:211]
    s_waitcnt vmcnt(29)
    v_mfma_f32_16x16x32_bf16 v[224:227], v[48:51], v[120:123], v[224:227]
    buffer_load_dwordx4 v[116:119], v10, s[44:47], s56 offen offset:1024 sc1
    v_mfma_f32_16x16x32_bf16 v[228:231], v[52:55], v[120:123], v[228:231]
    v_mfma_f32_16x16x32_bf16 v[232:235], v[56:59], v[120:123], v[232:235]
    v_mfma_f32_16x16x32_bf16 v[236:239], v[60:63], v[120:123], v[236:239]
    v_mfma_f32_16x16x32_bf16 v[252:255], v[60:63], v[124:127], v[252:255]
    buffer_load_dwordx4 v[120:123], v11, s[44:47], s56 offen offset:0 sc1
    v_mfma_f32_16x16x32_bf16 v[248:251], v[56:59], v[124:127], v[248:251]
    v_mfma_f32_16x16x32_bf16 v[244:247], v[52:55], v[124:127], v[244:247]
    v_mfma_f32_16x16x32_bf16 v[240:243], v[48:51], v[124:127], v[240:243]
    buffer_load_dwordx4 v[124:127], v11, s[44:47], s56 offen offset:1024 sc1
    s_add_u32 s56, s56, 8192
    s_waitcnt lgkmcnt(0)
    s_waitcnt vmcnt(23)
    s_waitcnt vmcnt(22)
    v_mfma_f32_16x16x32_bf16 v[128:131], v[32:35], v[64:67], v[128:131]
    v_mfma_f32_16x16x32_bf16 v[132:135], v[36:39], v[64:67], v[132:135]
    ds_read_b64_tr_b16 v[48:49], v4 offset:12288
    v_mfma_f32_16x16x32_bf16 v[136:139], v[40:43], v[64:67], v[136:139]
    ds_read_b64_tr_b16 v[50:51], v4 offset:14336
    v_mfma_f32_16x16x32_bf16 v[140:143], v[44:47], v[64:67], v[140:143]
    ds_read_b64_tr_b16 v[52:53], v5 offset:12288
    v_mfma_f32_16x16x32_bf16 v[156:159], v[44:47], v[68:71], v[156:159]
    buffer_load_dwordx4 v[64:67], v8, s[44:47], s56 offen offset:0 sc1
    v_mfma_f32_16x16x32_bf16 v[152:155], v[40:43], v[68:71], v[152:155]
    ds_read_b64_tr_b16 v[54:55], v5 offset:14336
    v_mfma_f32_16x16x32_bf16 v[148:151], v[36:39], v[68:71], v[148:151]
    ds_read_b64_tr_b16 v[56:57], v6 offset:12288
    v_mfma_f32_16x16x32_bf16 v[144:147], v[32:35], v[68:71], v[144:147]
    ds_read_b64_tr_b16 v[58:59], v6 offset:14336
    s_waitcnt vmcnt(19)
    v_mfma_f32_16x16x32_bf16 v[160:163], v[32:35], v[72:75], v[160:163]
    buffer_load_dwordx4 v[68:71], v8, s[44:47], s56 offen offset:1024 sc1
    v_mfma_f32_16x16x32_bf16 v[164:167], v[36:39], v[72:75], v[164:167]
    ds_read_b64_tr_b16 v[60:61], v7 offset:12288
    v_mfma_f32_16x16x32_bf16 v[168:171], v[40:43], v[72:75], v[168:171]
    ds_read_b64_tr_b16 v[62:63], v7 offset:14336
    v_mfma_f32_16x16x32_bf16 v[172:175], v[44:47], v[72:75], v[172:175]
    v_mfma_f32_16x16x32_bf16 v[188:191], v[44:47], v[76:79], v[188:191]
    buffer_load_dwordx4 v[72:75], v9, s[44:47], s56 offen offset:0 sc1
    v_mfma_f32_16x16x32_bf16 v[184:187], v[40:43], v[76:79], v[184:187]
    s_add_u32 m0, s37, 8192
    v_mfma_f32_16x16x32_bf16 v[180:183], v[36:39], v[76:79], v[180:183]
    buffer_load_dwordx4 v12, s[12:15], s35 offen offset:0 lds
    v_mfma_f32_16x16x32_bf16 v[176:179], v[32:35], v[76:79], v[176:179]
    buffer_load_dwordx4 v13, s[12:15], s35 offen offset:1024 lds
    s_waitcnt vmcnt(19)
    v_mfma_f32_16x16x32_bf16 v[192:195], v[32:35], v[80:83], v[192:195]
    buffer_load_dwordx4 v[76:79], v9, s[44:47], s56 offen offset:1024 sc1
    v_mfma_f32_16x16x32_bf16 v[196:199], v[36:39], v[80:83], v[196:199]
    buffer_load_dwordx4 v14, s[12:15], s35 offen offset:2048 lds
    v_mfma_f32_16x16x32_bf16 v[200:203], v[40:43], v[80:83], v[200:203]
    buffer_load_dwordx4 v15, s[12:15], s35 offen offset:3072 lds
    v_mfma_f32_16x16x32_bf16 v[204:207], v[44:47], v[80:83], v[204:207]
    s_add_u32 s35, s35, 65536
    v_mfma_f32_16x16x32_bf16 v[220:223], v[44:47], v[84:87], v[220:223]
    buffer_load_dwordx4 v[80:83], v10, s[44:47], s56 offen offset:0 sc1
    v_mfma_f32_16x16x32_bf16 v[216:219], v[40:43], v[84:87], v[216:219]
    v_mfma_f32_16x16x32_bf16 v[212:215], v[36:39], v[84:87], v[212:215]
    v_mfma_f32_16x16x32_bf16 v[208:211], v[32:35], v[84:87], v[208:211]
    s_waitcnt vmcnt(21)
    v_mfma_f32_16x16x32_bf16 v[224:227], v[32:35], v[88:91], v[224:227]
    buffer_load_dwordx4 v[84:87], v10, s[44:47], s56 offen offset:1024 sc1
    v_mfma_f32_16x16x32_bf16 v[228:231], v[36:39], v[88:91], v[228:231]
    v_mfma_f32_16x16x32_bf16 v[232:235], v[40:43], v[88:91], v[232:235]
    v_mfma_f32_16x16x32_bf16 v[236:239], v[44:47], v[88:91], v[236:239]
    v_mfma_f32_16x16x32_bf16 v[252:255], v[44:47], v[92:95], v[252:255]
    buffer_load_dwordx4 v[88:91], v11, s[44:47], s56 offen offset:0 sc1
    v_mfma_f32_16x16x32_bf16 v[248:251], v[40:43], v[92:95], v[248:251]
    v_mfma_f32_16x16x32_bf16 v[244:247], v[36:39], v[92:95], v[244:247]
    v_mfma_f32_16x16x32_bf16 v[240:243], v[32:35], v[92:95], v[240:243]
    buffer_load_dwordx4 v[92:95], v11, s[44:47], s56 offen offset:1024 sc1
    s_add_u32 s56, s56, 8192
    s_waitcnt lgkmcnt(0)
    s_waitcnt vmcnt(23)
    s_waitcnt vmcnt(22)
    v_mfma_f32_16x16x32_bf16 v[128:131], v[48:51], v[96:99], v[128:131]
    v_mfma_f32_16x16x32_bf16 v[132:135], v[52:55], v[96:99], v[132:135]
    ds_read_b64_tr_b16 v[32:33], v4 offset:0
    v_mfma_f32_16x16x32_bf16 v[136:139], v[56:59], v[96:99], v[136:139]
    ds_read_b64_tr_b16 v[34:35], v4 offset:2048
    v_mfma_f32_16x16x32_bf16 v[140:143], v[60:63], v[96:99], v[140:143]
    ds_read_b64_tr_b16 v[36:37], v5 offset:0
    v_mfma_f32_16x16x32_bf16 v[156:159], v[60:63], v[100:103], v[156:159]
    buffer_load_dwordx4 v[96:99], v8, s[44:47], s56 offen offset:0 sc1
    v_mfma_f32_16x16x32_bf16 v[152:155], v[56:59], v[100:103], v[152:155]
    ds_read_b64_tr_b16 v[38:39], v5 offset:2048
    v_mfma_f32_16x16x32_bf16 v[148:151], v[52:55], v[100:103], v[148:151]
    ds_read_b64_tr_b16 v[40:41], v6 offset:0
    v_mfma_f32_16x16x32_bf16 v[144:147], v[48:51], v[100:103], v[144:147]
    ds_read_b64_tr_b16 v[42:43], v6 offset:2048
    s_waitcnt vmcnt(19)
    v_mfma_f32_16x16x32_bf16 v[160:163], v[48:51], v[104:107], v[160:163]
    buffer_load_dwordx4 v[100:103], v8, s[44:47], s56 offen offset:1024 sc1
    v_mfma_f32_16x16x32_bf16 v[164:167], v[52:55], v[104:107], v[164:167]
    ds_read_b64_tr_b16 v[44:45], v7 offset:0
    v_mfma_f32_16x16x32_bf16 v[168:171], v[56:59], v[104:107], v[168:171]
    ds_read_b64_tr_b16 v[46:47], v7 offset:2048
    v_mfma_f32_16x16x32_bf16 v[172:175], v[60:63], v[104:107], v[172:175]
    v_mfma_f32_16x16x32_bf16 v[188:191], v[60:63], v[108:111], v[188:191]
    buffer_load_dwordx4 v[104:107], v9, s[44:47], s56 offen offset:0 sc1
    v_mfma_f32_16x16x32_bf16 v[184:187], v[56:59], v[108:111], v[184:187]
    s_add_u32 m0, s37, 12288
    v_mfma_f32_16x16x32_bf16 v[180:183], v[52:55], v[108:111], v[180:183]
    buffer_load_dwordx4 v12, s[12:15], s35 offen offset:0 lds
    v_mfma_f32_16x16x32_bf16 v[176:179], v[48:51], v[108:111], v[176:179]
    buffer_load_dwordx4 v13, s[12:15], s35 offen offset:1024 lds
    s_waitcnt vmcnt(19)
    v_mfma_f32_16x16x32_bf16 v[192:195], v[48:51], v[112:115], v[192:195]
    buffer_load_dwordx4 v[108:111], v9, s[44:47], s56 offen offset:1024 sc1
    v_mfma_f32_16x16x32_bf16 v[196:199], v[52:55], v[112:115], v[196:199]
    buffer_load_dwordx4 v14, s[12:15], s35 offen offset:2048 lds
    v_mfma_f32_16x16x32_bf16 v[200:203], v[56:59], v[112:115], v[200:203]
    buffer_load_dwordx4 v15, s[12:15], s35 offen offset:3072 lds
    v_mfma_f32_16x16x32_bf16 v[204:207], v[60:63], v[112:115], v[204:207]
    s_add_u32 s35, s35, 65536
    v_mfma_f32_16x16x32_bf16 v[220:223], v[60:63], v[116:119], v[220:223]
    buffer_load_dwordx4 v[112:115], v10, s[44:47], s56 offen offset:0 sc1
    v_mfma_f32_16x16x32_bf16 v[216:219], v[56:59], v[116:119], v[216:219]
    v_mfma_f32_16x16x32_bf16 v[212:215], v[52:55], v[116:119], v[212:215]
    v_mfma_f32_16x16x32_bf16 v[208:211], v[48:51], v[116:119], v[208:211]
    s_waitcnt vmcnt(21)
    v_mfma_f32_16x16x32_bf16 v[224:227], v[48:51], v[120:123], v[224:227]
    buffer_load_dwordx4 v[116:119], v10, s[44:47], s56 offen offset:1024 sc1
    v_mfma_f32_16x16x32_bf16 v[228:231], v[52:55], v[120:123], v[228:231]
    v_mfma_f32_16x16x32_bf16 v[232:235], v[56:59], v[120:123], v[232:235]
    v_mfma_f32_16x16x32_bf16 v[236:239], v[60:63], v[120:123], v[236:239]
    v_mfma_f32_16x16x32_bf16 v[252:255], v[60:63], v[124:127], v[252:255]
    buffer_load_dwordx4 v[120:123], v11, s[44:47], s56 offen offset:0 sc1
    v_mfma_f32_16x16x32_bf16 v[248:251], v[56:59], v[124:127], v[248:251]
    v_mfma_f32_16x16x32_bf16 v[244:247], v[52:55], v[124:127], v[244:247]
    v_mfma_f32_16x16x32_bf16 v[240:243], v[48:51], v[124:127], v[240:243]
    buffer_load_dwordx4 v[124:127], v11, s[44:47], s56 offen offset:1024 sc1
    s_add_u32 s56, s56, 8192
    s_waitcnt lgkmcnt(0)
    s_mov_b32 s38, 5
.p2align 6
L_ffn2_16:
    s_waitcnt vmcnt(23)
    s_waitcnt vmcnt(22)
    v_mfma_f32_16x16x32_bf16 v[128:131], v[32:35], v[64:67], v[128:131]
    v_mfma_f32_16x16x32_bf16 v[132:135], v[36:39], v[64:67], v[132:135]
    ds_read_b64_tr_b16 v[48:49], v4 offset:4096
    v_mfma_f32_16x16x32_bf16 v[136:139], v[40:43], v[64:67], v[136:139]
    ds_read_b64_tr_b16 v[50:51], v4 offset:6144
    v_mfma_f32_16x16x32_bf16 v[140:143], v[44:47], v[64:67], v[140:143]
    ds_read_b64_tr_b16 v[52:53], v5 offset:4096
    v_mfma_f32_16x16x32_bf16 v[156:159], v[44:47], v[68:71], v[156:159]
    buffer_load_dwordx4 v[64:67], v8, s[44:47], s56 offen offset:0 sc1
    v_mfma_f32_16x16x32_bf16 v[152:155], v[40:43], v[68:71], v[152:155]
    ds_read_b64_tr_b16 v[54:55], v5 offset:6144
    v_mfma_f32_16x16x32_bf16 v[148:151], v[36:39], v[68:71], v[148:151]
    ds_read_b64_tr_b16 v[56:57], v6 offset:4096
    v_mfma_f32_16x16x32_bf16 v[144:147], v[32:35], v[68:71], v[144:147]
    ds_read_b64_tr_b16 v[58:59], v6 offset:6144
    s_waitcnt vmcnt(19)
    v_mfma_f32_16x16x32_bf16 v[160:163], v[32:35], v[72:75], v[160:163]
    buffer_load_dwordx4 v[68:71], v8, s[44:47], s56 offen offset:1024 sc1
    v_mfma_f32_16x16x32_bf16 v[164:167], v[36:39], v[72:75], v[164:167]
    ds_read_b64_tr_b16 v[60:61], v7 offset:4096
    v_mfma_f32_16x16x32_bf16 v[168:171], v[40:43], v[72:75], v[168:171]
    ds_read_b64_tr_b16 v[62:63], v7 offset:6144
    v_mfma_f32_16x16x32_bf16 v[172:175], v[44:47], v[72:75], v[172:175]
    v_mfma_f32_16x16x32_bf16 v[188:191], v[44:47], v[76:79], v[188:191]
    buffer_load_dwordx4 v[72:75], v9, s[44:47], s56 offen offset:0 sc1
    v_mfma_f32_16x16x32_bf16 v[184:187], v[40:43], v[76:79], v[184:187]
    s_add_u32 m0, s37, 0
    v_mfma_f32_16x16x32_bf16 v[180:183], v[36:39], v[76:79], v[180:183]
    buffer_load_dwordx4 v12, s[12:15], s35 offen offset:0 lds
    v_mfma_f32_16x16x32_bf16 v[176:179], v[32:35], v[76:79], v[176:179]
    buffer_load_dwordx4 v13, s[12:15], s35 offen offset:1024 lds
    s_waitcnt vmcnt(19)
    v_mfma_f32_16x16x32_bf16 v[192:195], v[32:35], v[80:83], v[192:195]
    buffer_load_dwordx4 v[76:79], v9, s[44:47], s56 offen offset:1024 sc1
    v_mfma_f32_16x16x32_bf16 v[196:199], v[36:39], v[80:83], v[196:199]
    buffer_load_dwordx4 v14, s[12:15], s35 offen offset:2048 lds
    v_mfma_f32_16x16x32_bf16 v[200:203], v[40:43], v[80:83], v[200:203]
    buffer_load_dwordx4 v15, s[12:15], s35 offen offset:3072 lds
    v_mfma_f32_16x16x32_bf16 v[204:207], v[44:47], v[80:83], v[204:207]
    s_add_u32 s35, s35, 65536
    v_mfma_f32_16x16x32_bf16 v[220:223], v[44:47], v[84:87], v[220:223]
    buffer_load_dwordx4 v[80:83], v10, s[44:47], s56 offen offset:0 sc1
    v_mfma_f32_16x16x32_bf16 v[216:219], v[40:43], v[84:87], v[216:219]
    v_mfma_f32_16x16x32_bf16 v[212:215], v[36:39], v[84:87], v[212:215]
    v_mfma_f32_16x16x32_bf16 v[208:211], v[32:35], v[84:87], v[208:211]
    s_waitcnt vmcnt(21)
    v_mfma_f32_16x16x32_bf16 v[224:227], v[32:35], v[88:91], v[224:227]
    buffer_load_dwordx4 v[84:87], v10, s[44:47], s56 offen offset:1024 sc1
    v_mfma_f32_16x16x32_bf16 v[228:231], v[36:39], v[88:91], v[228:231]
    v_mfma_f32_16x16x32_bf16 v[232:235], v[40:43], v[88:91], v[232:235]
    v_mfma_f32_16x16x32_bf16 v[236:239], v[44:47], v[88:91], v[236:239]
    v_mfma_f32_16x16x32_bf16 v[252:255], v[44:47], v[92:95], v[252:255]
    buffer_load_dwordx4 v[88:91], v11, s[44:47], s56 offen offset:0 sc1
    v_mfma_f32_16x16x32_bf16 v[248:251], v[40:43], v[92:95], v[248:251]
    v_mfma_f32_16x16x32_bf16 v[244:247], v[36:39], v[92:95], v[244:247]
    v_mfma_f32_16x16x32_bf16 v[240:243], v[32:35], v[92:95], v[240:243]
    buffer_load_dwordx4 v[92:95], v11, s[44:47], s56 offen offset:1024 sc1
    s_add_u32 s56, s56, 8192
    s_waitcnt lgkmcnt(0)
    s_waitcnt vmcnt(23)
    s_waitcnt vmcnt(22)
    v_mfma_f32_16x16x32_bf16 v[128:131], v[48:51], v[96:99], v[128:131]
    v_mfma_f32_16x16x32_bf16 v[132:135], v[52:55], v[96:99], v[132:135]
    ds_read_b64_tr_b16 v[32:33], v4 offset:8192
    v_mfma_f32_16x16x32_bf16 v[136:139], v[56:59], v[96:99], v[136:139]
    ds_read_b64_tr_b16 v[34:35], v4 offset:10240
    v_mfma_f32_16x16x32_bf16 v[140:143], v[60:63], v[96:99], v[140:143]
    ds_read_b64_tr_b16 v[36:37], v5 offset:8192
    v_mfma_f32_16x16x32_bf16 v[156:159], v[60:63], v[100:103], v[156:159]
    buffer_load_dwordx4 v[96:99], v8, s[44:47], s56 offen offset:0 sc1
    v_mfma_f32_16x16x32_bf16 v[152:155], v[56:59], v[100:103], v[152:155]
    ds_read_b64_tr_b16 v[38:39], v5 offset:10240
    v_mfma_f32_16x16x32_bf16 v[148:151], v[52:55], v[100:103], v[148:151]
    ds_read_b64_tr_b16 v[40:41], v6 offset:8192
    v_mfma_f32_16x16x32_bf16 v[144:147], v[48:51], v[100:103], v[144:147]
    ds_read_b64_tr_b16 v[42:43], v6 offset:10240
    s_waitcnt vmcnt(19)
    v_mfma_f32_16x16x32_bf16 v[160:163], v[48:51], v[104:107], v[160:163]
    buffer_load_dwordx4 v[100:103], v8, s[44:47], s56 offen offset:1024 sc1
    v_mfma_f32_16x16x32_bf16 v[164:167], v[52:55], v[104:107], v[164:167]
    ds_read_b64_tr_b16 v[44:45], v7 offset:8192
    v_mfma_f32_16x16x32_bf16 v[168:171], v[56:59], v[104:107], v[168:171]
    ds_read_b64_tr_b16 v[46:47], v7 offset:10240
    v_mfma_f32_16x16x32_bf16 v[172:175], v[60:63], v[104:107], v[172:175]
    v_mfma_f32_16x16x32_bf16 v[188:191], v[60:63], v[108:111], v[188:191]
    buffer_load_dwordx4 v[104:107], v9, s[44:47], s56 offen offset:0 sc1
    v_mfma_f32_16x16x32_bf16 v[184:187], v[56:59], v[108:111], v[184:187]
    s_add_u32 m0, s37, 4096
    v_mfma_f32_16x16x32_bf16 v[180:183], v[52:55], v[108:111], v[180:183]
    buffer_load_dwordx4 v12, s[12:15], s35 offen offset:0 lds
    v_mfma_f32_16x16x32_bf16 v[176:179], v[48:51], v[108:111], v[176:179]
    buffer_load_dwordx4 v13, s[12:15], s35 offen offset:1024 lds
    s_waitcnt vmcnt(19)
    v_mfma_f32_16x16x32_bf16 v[192:195], v[48:51], v[112:115], v[192:195]
    buffer_load_dwordx4 v[108:111], v9, s[44:47], s56 offen offset:1024 sc1
    v_mfma_f32_16x16x32_bf16 v[196:199], v[52:55], v[112:115], v[196:199]
    buffer_load_dwordx4 v14, s[12:15], s35 offen offset:2048 lds
    v_mfma_f32_16x16x32_bf16 v[200:203], v[56:59], v[112:115], v[200:203]
    buffer_load_dwordx4 v15, s[12:15], s35 offen offset:3072 lds
    v_mfma_f32_16x16x32_bf16 v[204:207], v[60:63], v[112:115], v[204:207]
    s_add_u32 s35, s35, 65536
    v_mfma_f32_16x16x32_bf16 v[220:223], v[60:63], v[116:119], v[220:223]
    buffer_load_dwordx4 v[112:115], v10, s[44:47], s56 offen offset:0 sc1
    v_mfma_f32_16x16x32_bf16 v[216:219], v[56:59], v[116:119], v[216:219]
    v_mfma_f32_16x16x32_bf16 v[212:215], v[52:55], v[116:119], v[212:215]
    v_mfma_f32_16x16x32_bf16 v[208:211], v[48:51], v[116:119], v[208:211]
    s_waitcnt vmcnt(21)
    v_mfma_f32_16x16x32_bf16 v[224:227], v[48:51], v[120:123], v[224:227]
    buffer_load_dwordx4 v[116:119], v10, s[44:47], s56 offen offset:1024 sc1
    v_mfma_f32_16x16x32_bf16 v[228:231], v[52:55], v[120:123], v[228:231]
    v_mfma_f32_16x16x32_bf16 v[232:235], v[56:59], v[120:123], v[232:235]
    v_mfma_f32_16x16x32_bf16 v[236:239], v[60:63], v[120:123], v[236:239]
    v_mfma_f32_16x16x32_bf16 v[252:255], v[60:63], v[124:127], v[252:255]
    buffer_load_dwordx4 v[120:123], v11, s[44:47], s56 offen offset:0 sc1
    v_mfma_f32_16x16x32_bf16 v[248:251], v[56:59], v[124:127], v[248:251]
    v_mfma_f32_16x16x32_bf16 v[244:247], v[52:55], v[124:127], v[244:247]
    v_mfma_f32_16x16x32_bf16 v[240:243], v[48:51], v[124:127], v[240:243]
    buffer_load_dwordx4 v[124:127], v11, s[44:47], s56 offen offset:1024 sc1
    s_add_u32 s56, s56, 8192
    s_waitcnt lgkmcnt(0)
    s_waitcnt vmcnt(23)
    s_waitcnt vmcnt(22)
    v_mfma_f32_16x16x32_bf16 v[128:131], v[32:35], v[64:67], v[128:131]
    v_mfma_f32_16x16x32_bf16 v[132:135], v[36:39], v[64:67], v[132:135]
    ds_read_b64_tr_b16 v[48:49], v4 offset:12288
    v_mfma_f32_16x16x32_bf16 v[136:139], v[40:43], v[64:67], v[136:139]
    ds_read_b64_tr_b16 v[50:51], v4 offset:14336
    v_mfma_f32_16x16x32_bf16 v[140:143], v[44:47], v[64:67], v[140:143]
    ds_read_b64_tr_b16 v[52:53], v5 offset:12288
    v_mfma_f32_16x16x32_bf16 v[156:159], v[44:47], v[68:71], v[156:159]
    buffer_load_dwordx4 v[64:67], v8, s[44:47], s56 offen offset:0 sc1
    v_mfma_f32_16x16x32_bf16 v[152:155], v[40:43], v[68:71], v[152:155]
    ds_read_b64_tr_b16 v[54:55], v5 offset:14336
    v_mfma_f32_16x16x32_bf16 v[148:151], v[36:39], v[68:71], v[148:151]
    ds_read_b64_tr_b16 v[56:57], v6 offset:12288
    v_mfma_f32_16x16x32_bf16 v[144:147], v[32:35], v[68:71], v[144:147]
    ds_read_b64_tr_b16 v[58:59], v6 offset:14336
    s_waitcnt vmcnt(19)
    v_mfma_f32_16x16x32_bf16 v[160:163], v[32:35], v[72:75], v[160:163]
    buffer_load_dwordx4 v[68:71], v8, s[44:47], s56 offen offset:1024 sc1
    v_mfma_f32_16x16x32_bf16 v[164:167], v[36:39], v[72:75], v[164:167]
    ds_read_b64_tr_b16 v[60:61], v7 offset:12288
    v_mfma_f32_16x16x32_bf16 v[168:171], v[40:43], v[72:75], v[168:171]
    ds_read_b64_tr_b16 v[62:63], v7 offset:14336
    v_mfma_f32_16x16x32_bf16 v[172:175], v[44:47], v[72:75], v[172:175]
    v_mfma_f32_16x16x32_bf16 v[188:191], v[44:47], v[76:79], v[188:191]
    buffer_load_dwordx4 v[72:75], v9, s[44:47], s56 offen offset:0 sc1
    v_mfma_f32_16x16x32_bf16 v[184:187], v[40:43], v[76:79], v[184:187]
    s_add_u32 m0, s37, 8192
    v_mfma_f32_16x16x32_bf16 v[180:183], v[36:39], v[76:79], v[180:183]
    buffer_load_dwordx4 v12, s[12:15], s35 offen offset:0 lds
    v_mfma_f32_16x16x32_bf16 v[176:179], v[32:35], v[76:79], v[176:179]
    buffer_load_dwordx4 v13, s[12:15], s35 offen offset:1024 lds
    s_waitcnt vmcnt(19)
    v_mfma_f32_16x16x32_bf16 v[192:195], v[32:35], v[80:83], v[192:195]
    buffer_load_dwordx4 v[76:79], v9, s[44:47], s56 offen offset:1024 sc1
    v_mfma_f32_16x16x32_bf16 v[196:199], v[36:39], v[80:83], v[196:199]
    buffer_load_dwordx4 v14, s[12:15], s35 offen offset:2048 lds
    v_mfma_f32_16x16x32_bf16 v[200:203], v[40:43], v[80:83], v[200:203]
    buffer_load_dwordx4 v15, s[12:15], s35 offen offset:3072 lds
    v_mfma_f32_16x16x32_bf16 v[204:207], v[44:47], v[80:83], v[204:207]
    s_add_u32 s35, s35, 65536
    v_mfma_f32_16x16x32_bf16 v[220:223], v[44:47], v[84:87], v[220:223]
    buffer_load_dwordx4 v[80:83], v10, s[44:47], s56 offen offset:0 sc1
    v_mfma_f32_16x16x32_bf16 v[216:219], v[40:43], v[84:87], v[216:219]
    v_mfma_f32_16x16x32_bf16 v[212:215], v[36:39], v[84:87], v[212:215]
    v_mfma_f32_16x16x32_bf16 v[208:211], v[32:35], v[84:87], v[208:211]
    s_waitcnt vmcnt(21)
    v_mfma_f32_16x16x32_bf16 v[224:227], v[32:35], v[88:91], v[224:227]
    buffer_load_dwordx4 v[84:87], v10, s[44:47], s56 offen offset:1024 sc1
    v_mfma_f32_16x16x32_bf16 v[228:231], v[36:39], v[88:91], v[228:231]
    v_mfma_f32_16x16x32_bf16 v[232:235], v[40:43], v[88:91], v[232:235]
    v_mfma_f32_16x16x32_bf16 v[236:239], v[44:47], v[88:91], v[236:239]
    v_mfma_f32_16x16x32_bf16 v[252:255], v[44:47], v[92:95], v[252:255]
    buffer_load_dwordx4 v[88:91], v11, s[44:47], s56 offen offset:0 sc1
    v_mfma_f32_16x16x32_bf16 v[248:251], v[40:43], v[92:95], v[248:251]
    v_mfma_f32_16x16x32_bf16 v[244:247], v[36:39], v[92:95], v[244:247]
    v_mfma_f32_16x16x32_bf16 v[240:243], v[32:35], v[92:95], v[240:243]
    buffer_load_dwordx4 v[92:95], v11, s[44:47], s56 offen offset:1024 sc1
    s_add_u32 s56, s56, 8192
    s_waitcnt lgkmcnt(0)
    s_waitcnt vmcnt(23)
    s_waitcnt vmcnt(22)
    v_mfma_f32_16x16x32_bf16 v[128:131], v[48:51], v[96:99], v[128:131]
    v_mfma_f32_16x16x32_bf16 v[132:135], v[52:55], v[96:99], v[132:135]
    ds_read_b64_tr_b16 v[32:33], v4 offset:0
    v_mfma_f32_16x16x32_bf16 v[136:139], v[56:59], v[96:99], v[136:139]
    ds_read_b64_tr_b16 v[34:35], v4 offset:2048
    v_mfma_f32_16x16x32_bf16 v[140:143], v[60:63], v[96:99], v[140:143]
    ds_read_b64_tr_b16 v[36:37], v5 offset:0
    v_mfma_f32_16x16x32_bf16 v[156:159], v[60:63], v[100:103], v[156:159]
    buffer_load_dwordx4 v[96:99], v8, s[44:47], s56 offen offset:0 sc1
    v_mfma_f32_16x16x32_bf16 v[152:155], v[56:59], v[100:103], v[152:155]
    ds_read_b64_tr_b16 v[38:39], v5 offset:2048
    v_mfma_f32_16x16x32_bf16 v[148:151], v[52:55], v[100:103], v[148:151]
    ds_read_b64_tr_b16 v[40:41], v6 offset:0
    v_mfma_f32_16x16x32_bf16 v[144:147], v[48:51], v[100:103], v[144:147]
    ds_read_b64_tr_b16 v[42:43], v6 offset:2048
    s_waitcnt vmcnt(19)
    v_mfma_f32_16x16x32_bf16 v[160:163], v[48:51], v[104:107], v[160:163]
    buffer_load_dwordx4 v[100:103], v8, s[44:47], s56 offen offset:1024 sc1
    v_mfma_f32_16x16x32_bf16 v[164:167], v[52:55], v[104:107], v[164:167]
    ds_read_b64_tr_b16 v[44:45], v7 offset:0
    v_mfma_f32_16x16x32_bf16 v[168:171], v[56:59], v[104:107], v[168:171]
    ds_read_b64_tr_b16 v[46:47], v7 offset:2048
    v_mfma_f32_16x16x32_bf16 v[172:175], v[60:63], v[104:107], v[172:175]
    v_mfma_f32_16x16x32_bf16 v[188:191], v[60:63], v[108:111], v[188:191]
    buffer_load_dwordx4 v[104:107], v9, s[44:47], s56 offen offset:0 sc1
    v_mfma_f32_16x16x32_bf16 v[184:187], v[56:59], v[108:111], v[184:187]
    s_add_u32 m0, s37, 12288
    v_mfma_f32_16x16x32_bf16 v[180:183], v[52:55], v[108:111], v[180:183]
    buffer_load_dwordx4 v12, s[12:15], s35 offen offset:0 lds
    v_mfma_f32_16x16x32_bf16 v[176:179], v[48:51], v[108:111], v[176:179]
    buffer_load_dwordx4 v13, s[12:15], s35 offen offset:1024 lds
    s_waitcnt vmcnt(19)
    v_mfma_f32_16x16x32_bf16 v[192:195], v[48:51], v[112:115], v[192:195]
    buffer_load_dwordx4 v[108:111], v9, s[44:47], s56 offen offset:1024 sc1
    v_mfma_f32_16x16x32_bf16 v[196:199], v[52:55], v[112:115], v[196:199]
    buffer_load_dwordx4 v14, s[12:15], s35 offen offset:2048 lds
    v_mfma_f32_16x16x32_bf16 v[200:203], v[56:59], v[112:115], v[200:203]
    buffer_load_dwordx4 v15, s[12:15], s35 offen offset:3072 lds
    v_mfma_f32_16x16x32_bf16 v[204:207], v[60:63], v[112:115], v[204:207]
    s_add_u32 s35, s35, 65536
    v_mfma_f32_16x16x32_bf16 v[220:223], v[60:63], v[116:119], v[220:223]
    buffer_load_dwordx4 v[112:115], v10, s[44:47], s56 offen offset:0 sc1
    v_mfma_f32_16x16x32_bf16 v[216:219], v[56:59], v[116:119], v[216:219]
    v_mfma_f32_16x16x32_bf16 v[212:215], v[52:55], v[116:119], v[212:215]
    v_mfma_f32_16x16x32_bf16 v[208:211], v[48:51], v[116:119], v[208:211]
    s_waitcnt vmcnt(21)
    v_mfma_f32_16x16x32_bf16 v[224:227], v[48:51], v[120:123], v[224:227]
    buffer_load_dwordx4 v[116:119], v10, s[44:47], s56 offen offset:1024 sc1
    v_mfma_f32_16x16x32_bf16 v[228:231], v[52:55], v[120:123], v[228:231]
    v_mfma_f32_16x16x32_bf16 v[232:235], v[56:59], v[120:123], v[232:235]
    v_mfma_f32_16x16x32_bf16 v[236:239], v[60:63], v[120:123], v[236:239]
    v_mfma_f32_16x16x32_bf16 v[252:255], v[60:63], v[124:127], v[252:255]
    buffer_load_dwordx4 v[120:123], v11, s[44:47], s56 offen offset:0 sc1
    v_mfma_f32_16x16x32_bf16 v[248:251], v[56:59], v[124:127], v[248:251]
    v_mfma_f32_16x16x32_bf16 v[244:247], v[52:55], v[124:127], v[244:247]
    v_mfma_f32_16x16x32_bf16 v[240:243], v[48:51], v[124:127], v[240:243]
    buffer_load_dwordx4 v[124:127], v11, s[44:47], s56 offen offset:1024 sc1
    s_add_u32 s56, s56, 8192
    s_waitcnt lgkmcnt(0)
    s_sub_u32 s38, s38, 1
    s_cmp_lg_u32 s38, 0
    s_cbranch_scc1 L_ffn2_16
    s_waitcnt vmcnt(23)
    s_waitcnt vmcnt(22)
    v_mfma_f32_16x16x32_bf16 v[128:131], v[32:35], v[64:67], v[128:131]
    v_mfma_f32_16x16x32_bf16 v[132:135], v[36:39], v[64:67], v[132:135]
    ds_read_b64_tr_b16 v[48:49], v4 offset:4096
    v_mfma_f32_16x16x32_bf16 v[136:139], v[40:43], v[64:67], v[136:139]
    ds_read_b64_tr_b16 v[50:51], v4 offset:6144
    v_mfma_f32_16x16x32_bf16 v[140:143], v[44:47], v[64:67], v[140:143]
    ds_read_b64_tr_b16 v[52:53], v5 offset:4096
    v_mfma_f32_16x16x32_bf16 v[156:159], v[44:47], v[68:71], v[156:159]
    buffer_load_dwordx4 v[64:67], v8, s[44:47], s56 offen offset:0 sc1
    v_mfma_f32_16x16x32_bf16 v[152:155], v[40:43], v[68:71], v[152:155]
    ds_read_b64_tr_b16 v[54:55], v5 offset:6144
    v_mfma_f32_16x16x32_bf16 v[148:151], v[36:39], v[68:71], v[148:151]
    ds_read_b64_tr_b16 v[56:57], v6 offset:4096
    v_mfma_f32_16x16x32_bf16 v[144:147], v[32:35], v[68:71], v[144:147]
    ds_read_b64_tr_b16 v[58:59], v6 offset:6144
    s_waitcnt vmcnt(19)
    v_mfma_f32_16x16x32_bf16 v[160:163], v[32:35], v[72:75], v[160:163]
    buffer_load_dwordx4 v[68:71], v8, s[44:47], s56 offen offset:1024 sc1
    v_mfma_f32_16x16x32_bf16 v[164:167], v[36:39], v[72:75], v[164:167]
    ds_read_b64_tr_b16 v[60:61], v7 offset:4096
    v_mfma_f32_16x16x32_bf16 v[168:171], v[40:43], v[72:75], v[168:171]
    ds_read_b64_tr_b16 v[62:63], v7 offset:6144
    v_mfma_f32_16x16x32_bf16 v[172:175], v[44:47], v[72:75], v[172:175]
    v_mfma_f32_16x16x32_bf16 v[188:191], v[44:47], v[76:79], v[188:191]
    buffer_load_dwordx4 v[72:75], v9, s[44:47], s56 offen offset:0 sc1
    v_mfma_f32_16x16x32_bf16 v[184:187], v[40:43], v[76:79], v[184:187]
    s_add_u32 m0, s37, 0
    v_mfma_f32_16x16x32_bf16 v[180:183], v[36:39], v[76:79], v[180:183]
    buffer_load_dwordx4 v12, s[16:19], s57 offen offset:0 lds
    v_mfma_f32_16x16x32_bf16 v[176:179], v[32:35], v[76:79], v[176:179]
    buffer_load_dwordx4 v13, s[16:19], s57 offen offset:1024 lds
    s_waitcnt vmcnt(19)
    v_mfma_f32_16x16x32_bf16 v[192:195], v[32:35], v[80:83], v[192:195]
    buffer_load_dwordx4 v[76:79], v9, s[44:47], s56 offen offset:1024 sc1
    v_mfma_f32_16x16x32_bf16 v[196:199], v[36:39], v[80:83], v[196:199]
    buffer_load_dwordx4 v14, s[16:19], s57 offen offset:2048 lds
    v_mfma_f32_16x16x32_bf16 v[200:203], v[40:43], v[80:83], v[200:203]
    buffer_load_dwordx4 v15, s[16:19], s57 offen offset:3072 lds
    v_mfma_f32_16x16x32_bf16 v[204:207], v[44:47], v[80:83], v[204:207]
    s_add_u32 s57, s57, 65536
    v_mfma_f32_16x16x32_bf16 v[220:223], v[44:47], v[84:87], v[220:223]
    buffer_load_dwordx4 v[80:83], v10, s[44:47], s56 offen offset:0 sc1
    v_mfma_f32_16x16x32_bf16 v[216:219], v[40:43], v[84:87], v[216:219]
    v_mfma_f32_16x16x32_bf16 v[212:215], v[36:39], v[84:87], v[212:215]
    v_mfma_f32_16x16x32_bf16 v[208:211], v[32:35], v[84:87], v[208:211]
    s_waitcnt vmcnt(21)
    v_mfma_f32_16x16x32_bf16 v[224:227], v[32:35], v[88:91], v[224:227]
    buffer_load_dwordx4 v[84:87], v10, s[44:47], s56 offen offset:1024 sc1
    v_mfma_f32_16x16x32_bf16 v[228:231], v[36:39], v[88:91], v[228:231]
    v_mfma_f32_16x16x32_bf16 v[232:235], v[40:43], v[88:91], v[232:235]
    v_mfma_f32_16x16x32_bf16 v[236:239], v[44:47], v[88:91], v[236:239]
    v_mfma_f32_16x16x32_bf16 v[252:255], v[44:47], v[92:95], v[252:255]
    buffer_load_dwordx4 v[88:91], v11, s[44:47], s56 offen offset:0 sc1
    v_mfma_f32_16x16x32_bf16 v[248:251], v[40:43], v[92:95], v[248:251]
    v_mfma_f32_16x16x32_bf16 v[244:247], v[36:39], v[92:95], v[244:247]
    v_mfma_f32_16x16x32_bf16 v[240:243], v[32:35], v[92:95], v[240:243]
    buffer_load_dwordx4 v[92:95], v11, s[44:47], s56 offen offset:1024 sc1
    s_add_u32 s56, s56, 8192
    s_waitcnt lgkmcnt(0)
    s_waitcnt vmcnt(23)
    s_waitcnt vmcnt(22)
    v_mfma_f32_16x16x32_bf16 v[128:131], v[48:51], v[96:99], v[128:131]
    v_mfma_f32_16x16x32_bf16 v[132:135], v[52:55], v[96:99], v[132:135]
    ds_read_b64_tr_b16 v[32:33], v4 offset:8192
    v_mfma_f32_16x16x32_bf16 v[136:139], v[56:59], v[96:99], v[136:139]
    ds_read_b64_tr_b16 v[34:35], v4 offset:10240
    v_mfma_f32_16x16x32_bf16 v[140:143], v[60:63], v[96:99], v[140:143]
    ds_read_b64_tr_b16 v[36:37], v5 offset:8192
    v_mfma_f32_16x16x32_bf16 v[156:159], v[60:63], v[100:103], v[156:159]
    buffer_load_dwordx4 v[96:99], v8, s[44:47], s56 offen offset:0 sc1
    v_mfma_f32_16x16x32_bf16 v[152:155], v[56:59], v[100:103], v[152:155]
    ds_read_b64_tr_b16 v[38:39], v5 offset:10240
    v_mfma_f32_16x16x32_bf16 v[148:151], v[52:55], v[100:103], v[148:151]
    ds_read_b64_tr_b16 v[40:41], v6 offset:8192
    v_mfma_f32_16x16x32_bf16 v[144:147], v[48:51], v[100:103], v[144:147]
    ds_read_b64_tr_b16 v[42:43], v6 offset:10240
    s_waitcnt vmcnt(19)
    v_mfma_f32_16x16x32_bf16 v[160:163], v[48:51], v[104:107], v[160:163]
    buffer_load_dwordx4 v[100:103], v8, s[44:47], s56 offen offset:1024 sc1
    v_mfma_f32_16x16x32_bf16 v[164:167], v[52:55], v[104:107], v[164:167]
    ds_read_b64_tr_b16 v[44:45], v7 offset:8192
    v_mfma_f32_16x16x32_bf16 v[168:171], v[56:59], v[104:107], v[168:171]
    ds_read_b64_tr_b16 v[46:47], v7 offset:10240
    v_mfma_f32_16x16x32_bf16 v[172:175], v[60:63], v[104:107], v[172:175]
    v_mfma_f32_16x16x32_bf16 v[188:191], v[60:63], v[108:111], v[188:191]
    buffer_load_dwordx4 v[104:107], v9, s[44:47], s56 offen offset:0 sc1
    v_mfma_f32_16x16x32_bf16 v[184:187], v[56:59], v[108:111], v[184:187]
    s_add_u32 m0, s37, 4096
    v_mfma_f32_16x16x32_bf16 v[180:183], v[52:55], v[108:111], v[180:183]
    buffer_load_dwordx4 v12, s[16:19], s57 offen offset:0 lds
    v_mfma_f32_16x16x32_bf16 v[176:179], v[48:51], v[108:111], v[176:179]
    buffer_load_dwordx4 v13, s[16:19], s57 offen offset:1024 lds
    s_waitcnt vmcnt(19)
    v_mfma_f32_16x16x32_bf16 v[192:195], v[48:51], v[112:115], v[192:195]
    buffer_load_dwordx4 v[108:111], v9, s[44:47], s56 offen offset:1024 sc1
    v_mfma_f32_16x16x32_bf16 v[196:199], v[52:55], v[112:115], v[196:199]
    buffer_load_dwordx4 v14, s[16:19], s57 offen offset:2048 lds
    v_mfma_f32_16x16x32_bf16 v[200:203], v[56:59], v[112:115], v[200:203]
    buffer_load_dwordx4 v15, s[16:19], s57 offen offset:3072 lds
    v_mfma_f32_16x16x32_bf16 v[204:207], v[60:63], v[112:115], v[204:207]
    s_add_u32 s57, s57, 65536
    v_mfma_f32_16x16x32_bf16 v[220:223], v[60:63], v[116:119], v[220:223]
    buffer_load_dwordx4 v[112:115], v10, s[44:47], s56 offen offset:0 sc1
    v_mfma_f32_16x16x32_bf16 v[216:219], v[56:59], v[116:119], v[216:219]
    v_mfma_f32_16x16x32_bf16 v[212:215], v[52:55], v[116:119], v[212:215]
    v_mfma_f32_16x16x32_bf16 v[208:211], v[48:51], v[116:119], v[208:211]
    s_waitcnt vmcnt(21)
    v_mfma_f32_16x16x32_bf16 v[224:227], v[48:51], v[120:123], v[224:227]
    buffer_load_dwordx4 v[116:119], v10, s[44:47], s56 offen offset:1024 sc1
    v_mfma_f32_16x16x32_bf16 v[228:231], v[52:55], v[120:123], v[228:231]
    v_mfma_f32_16x16x32_bf16 v[232:235], v[56:59], v[120:123], v[232:235]
    v_mfma_f32_16x16x32_bf16 v[236:239], v[60:63], v[120:123], v[236:239]
    v_mfma_f32_16x16x32_bf16 v[252:255], v[60:63], v[124:127], v[252:255]
    buffer_load_dwordx4 v[120:123], v11, s[44:47], s56 offen offset:0 sc1
    v_mfma_f32_16x16x32_bf16 v[248:251], v[56:59], v[124:127], v[248:251]
    v_mfma_f32_16x16x32_bf16 v[244:247], v[52:55], v[124:127], v[244:247]
    v_mfma_f32_16x16x32_bf16 v[240:243], v[48:51], v[124:127], v[240:243]
    buffer_load_dwordx4 v[124:127], v11, s[44:47], s56 offen offset:1024 sc1
    s_add_u32 s56, s56, 8192
    s_waitcnt lgkmcnt(0)
    s_waitcnt vmcnt(23)
    s_waitcnt vmcnt(22)
    v_mfma_f32_16x16x32_bf16 v[128:131], v[32:35], v[64:67], v[128:131]
    v_mfma_f32_16x16x32_bf16 v[132:135], v[36:39], v[64:67], v[132:135]
    ds_read_b64_tr_b16 v[48:49], v4 offset:12288
    v_mfma_f32_16x16x32_bf16 v[136:139], v[40:43], v[64:67], v[136:139]
    ds_read_b64_tr_b16 v[50:51], v4 offset:14336
    v_mfma_f32_16x16x32_bf16 v[140:143], v[44:47], v[64:67], v[140:143]
    ds_read_b64_tr_b16 v[52:53], v5 offset:12288
    v_mfma_f32_16x16x32_bf16 v[156:159], v[44:47], v[68:71], v[156:159]
    v_mfma_f32_16x16x32_bf16 v[152:155], v[40:43], v[68:71], v[152:155]
    ds_read_b64_tr_b16 v[54:55], v5 offset:14336
    v_mfma_f32_16x16x32_bf16 v[148:151], v[36:39], v[68:71], v[148:151]
    ds_read_b64_tr_b16 v[56:57], v6 offset:12288
    v_mfma_f32_16x16x32_bf16 v[144:147], v[32:35], v[68:71], v[144:147]
    ds_read_b64_tr_b16 v[58:59], v6 offset:14336
    s_waitcnt vmcnt(18)
    v_mfma_f32_16x16x32_bf16 v[160:163], v[32:35], v[72:75], v[160:163]
    v_mfma_f32_16x16x32_bf16 v[164:167], v[36:39], v[72:75], v[164:167]
    ds_read_b64_tr_b16 v[60:61], v7 offset:12288
    v_mfma_f32_16x16x32_bf16 v[168:171], v[40:43], v[72:75], v[168:171]
    ds_read_b64_tr_b16 v[62:63], v7 offset:14336
    v_mfma_f32_16x16x32_bf16 v[172:175], v[44:47], v[72:75], v[172:175]
    v_mfma_f32_16x16x32_bf16 v[188:191], v[44:47], v[76:79], v[188:191]
    v_mfma_f32_16x16x32_bf16 v[184:187], v[40:43], v[76:79], v[184:187]
    s_add_u32 m0, s37, 8192
    v_mfma_f32_16x16x32_bf16 v[180:183], v[36:39], v[76:79], v[180:183]
    buffer_load_dwordx4 v12, s[16:19], s57 offen offset:0 lds
    v_mfma_f32_16x16x32_bf16 v[176:179], v[32:35], v[76:79], v[176:179]
    buffer_load_dwordx4 v13, s[16:19], s57 offen offset:1024 lds
    s_waitcnt vmcnt(16)
    v_mfma_f32_16x16x32_bf16 v[192:195], v[32:35], v[80:83], v[192:195]
    v_mfma_f32_16x16x32_bf16 v[196:199], v[36:39], v[80:83], v[196:199]
    buffer_load_dwordx4 v14, s[16:19], s57 offen offset:2048 lds
    v_mfma_f32_16x16x32_bf16 v[200:203], v[40:43], v[80:83], v[200:203]
    buffer_load_dwordx4 v15, s[16:19], s57 offen offset:3072 lds
    v_mfma_f32_16x16x32_bf16 v[204:207], v[44:47], v[80:83], v[204:207]
    s_add_u32 s57, s57, 65536
    v_mfma_f32_16x16x32_bf16 v[220:223], v[44:47], v[84:87], v[220:223]
    v_mfma_f32_16x16x32_bf16 v[216:219], v[40:43], v[84:87], v[216:219]
    v_mfma_f32_16x16x32_bf16 v[212:215], v[36:39], v[84:87], v[212:215]
    v_mfma_f32_16x16x32_bf16 v[208:211], v[32:35], v[84:87], v[208:211]
    s_waitcnt vmcnt(16)
    v_mfma_f32_16x16x32_bf16 v[224:227], v[32:35], v[88:91], v[224:227]
    v_mfma_f32_16x16x32_bf16 v[228:231], v[36:39], v[88:91], v[228:231]
    v_mfma_f32_16x16x32_bf16 v[232:235], v[40:43], v[88:91], v[232:235]
    v_mfma_f32_16x16x32_bf16 v[236:239], v[44:47], v[88:91], v[236:239]
    v_mfma_f32_16x16x32_bf16 v[252:255], v[44:47], v[92:95], v[252:255]
    v_mfma_f32_16x16x32_bf16 v[248:251], v[40:43], v[92:95], v[248:251]
    v_mfma_f32_16x16x32_bf16 v[244:247], v[36:39], v[92:95], v[244:247]
    v_mfma_f32_16x16x32_bf16 v[240:243], v[32:35], v[92:95], v[240:243]
    s_waitcnt lgkmcnt(0)
    s_waitcnt vmcnt(15)
    s_waitcnt vmcnt(14)
    v_mfma_f32_16x16x32_bf16 v[128:131], v[48:51], v[96:99], v[128:131]
    v_mfma_f32_16x16x32_bf16 v[132:135], v[52:55], v[96:99], v[132:135]
    ds_read_b64_tr_b16 v[32:33], v4 offset:0
    v_mfma_f32_16x16x32_bf16 v[136:139], v[56:59], v[96:99], v[136:139]
    ds_read_b64_tr_b16 v[34:35], v4 offset:2048
    v_mfma_f32_16x16x32_bf16 v[140:143], v[60:63], v[96:99], v[140:143]
    ds_read_b64_tr_b16 v[36:37], v5 offset:0
    v_mfma_f32_16x16x32_bf16 v[156:159], v[60:63], v[100:103], v[156:159]
    v_mfma_f32_16x16x32_bf16 v[152:155], v[56:59], v[100:103], v[152:155]
    ds_read_b64_tr_b16 v[38:39], v5 offset:2048
    v_mfma_f32_16x16x32_bf16 v[148:151], v[52:55], v[100:103], v[148:151]
    ds_read_b64_tr_b16 v[40:41], v6 offset:0
    v_mfma_f32_16x16x32_bf16 v[144:147], v[48:51], v[100:103], v[144:147]
    ds_read_b64_tr_b16 v[42:43], v6 offset:2048
    s_waitcnt vmcnt(10)
    v_mfma_f32_16x16x32_bf16 v[160:163], v[48:51], v[104:107], v[160:163]
    v_mfma_f32_16x16x32_bf16 v[164:167], v[52:55], v[104:107], v[164:167]
    ds_read_b64_tr_b16 v[44:45], v7 offset:0
    v_mfma_f32_16x16x32_bf16 v[168:171], v[56:59], v[104:107], v[168:171]
    ds_read_b64_tr_b16 v[46:47], v7 offset:2048
    v_mfma_f32_16x16x32_bf16 v[172:175], v[60:63], v[104:107], v[172:175]
    v_mfma_f32_16x16x32_bf16 v[188:191], v[60:63], v[108:111], v[188:191]
    v_mfma_f32_16x16x32_bf16 v[184:187], v[56:59], v[108:111], v[184:187]
    s_add_u32 m0, s37, 12288
    v_mfma_f32_16x16x32_bf16 v[180:183], v[52:55], v[108:111], v[180:183]
    buffer_load_dwordx4 v12, s[16:19], s57 offen offset:0 lds
    v_mfma_f32_16x16x32_bf16 v[176:179], v[48:51], v[108:111], v[176:179]
    buffer_load_dwordx4 v13, s[16:19], s57 offen offset:1024 lds
    s_waitcnt vmcnt(8)
    v_mfma_f32_16x16x32_bf16 v[192:195], v[48:51], v[112:115], v[192:195]
    v_mfma_f32_16x16x32_bf16 v[196:199], v[52:55], v[112:115], v[196:199]
    buffer_load_dwordx4 v14, s[16:19], s57 offen offset:2048 lds
    v_mfma_f32_16x16x32_bf16 v[200:203], v[56:59], v[112:115], v[200:203]
    buffer_load_dwordx4 v15, s[16:19], s57 offen offset:3072 lds
    v_mfma_f32_16x16x32_bf16 v[204:207], v[60:63], v[112:115], v[204:207]
    s_add_u32 s57, s57, 65536
    v_mfma_f32_16x16x32_bf16 v[220:223], v[60:63], v[116:119], v[220:223]
    v_mfma_f32_16x16x32_bf16 v[216:219], v[56:59], v[116:119], v[216:219]
    v_mfma_f32_16x16x32_bf16 v[212:215], v[52:55], v[116:119], v[212:215]
    v_mfma_f32_16x16x32_bf16 v[208:211], v[48:51], v[116:119], v[208:211]
    s_waitcnt vmcnt(8)
    v_mfma_f32_16x16x32_bf16 v[224:227], v[48:51], v[120:123], v[224:227]
    v_mfma_f32_16x16x32_bf16 v[228:231], v[52:55], v[120:123], v[228:231]
    v_mfma_f32_16x16x32_bf16 v[232:235], v[56:59], v[120:123], v[232:235]
    v_mfma_f32_16x16x32_bf16 v[236:239], v[60:63], v[120:123], v[236:239]
    v_mfma_f32_16x16x32_bf16 v[252:255], v[60:63], v[124:127], v[252:255]
    v_mfma_f32_16x16x32_bf16 v[248:251], v[56:59], v[124:127], v[248:251]
    v_mfma_f32_16x16x32_bf16 v[244:247], v[52:55], v[124:127], v[244:247]
    v_mfma_f32_16x16x32_bf16 v[240:243], v[48:51], v[124:127], v[240:243]
    s_waitcnt lgkmcnt(0)
    v_sub_f32 v16, 1.0, v16
    v_sub_f32 v17, 1.0, v17
    v_sub_f32 v18, 1.0, v18
    v_sub_f32 v19, 1.0, v19
    v_sub_f32 v20, 1.0, v20
    v_sub_f32 v21, 1.0, v21
    v_sub_f32 v22, 1.0, v22
    v_sub_f32 v23, 1.0, v23
    v_mul_f32 v128, v16, v128
    v_mul_f32 v129, v16, v129
    v_mul_f32 v130, v16, v130
    v_mul_f32 v131, v16, v131
    v_mul_f32 v132, v16, v132
    v_mul_f32 v133, v16, v133
    v_mul_f32 v134, v16, v134
    v_mul_f32 v135, v16, v135
    v_mul_f32 v136, v16, v136
    v_mul_f32 v137, v16, v137
    v_mul_f32 v138, v16, v138
    v_mul_f32 v139, v16, v139
    v_mul_f32 v140, v16, v140
    v_mul_f32 v141, v16, v141
    v_mul_f32 v142, v16, v142
    v_mul_f32 v143, v16, v143
    v_mul_f32 v144, v17, v144
    v_mul_f32 v145, v17, v145
    v_mul_f32 v146, v17, v146
    v_mul_f32 v147, v17, v147
    v_mul_f32 v148, v17, v148
    v_mul_f32 v149, v17, v149
    v_mul_f32 v150, v17, v150
    v_mul_f32 v151, v17, v151
    v_mul_f32 v152, v17, v152
    v_mul_f32 v153, v17, v153
    v_mul_f32 v154, v17, v154
    v_mul_f32 v155, v17, v155
    v_mul_f32 v156, v17, v156
    v_mul_f32 v157, v17, v157
    v_mul_f32 v158, v17, v158
    v_mul_f32 v159, v17, v159
    v_mul_f32 v160, v18, v160
    v_mul_f32 v161, v18, v161
    v_mul_f32 v162, v18, v162
    v_mul_f32 v163, v18, v163
    v_mul_f32 v164, v18, v164
    v_mul_f32 v165, v18, v165
    v_mul_f32 v166, v18, v166
    v_mul_f32 v167, v18, v167
    v_mul_f32 v168, v18, v168
    v_mul_f32 v169, v18, v169
    v_mul_f32 v170, v18, v170
    v_mul_f32 v171, v18, v171
    v_mul_f32 v172, v18, v172
    v_mul_f32 v173, v18, v173
    v_mul_f32 v174, v18, v174
    v_mul_f32 v175, v18, v175
    v_mul_f32 v176, v19, v176
    v_mul_f32 v177, v19, v177
    v_mul_f32 v178, v19, v178
    v_mul_f32 v179, v19, v179
    v_mul_f32 v180, v19, v180
    v_mul_f32 v181, v19, v181
    v_mul_f32 v182, v19, v182
    v_mul_f32 v183, v19, v183
    v_mul_f32 v184, v19, v184
    v_mul_f32 v185, v19, v185
    v_mul_f32 v186, v19, v186
    v_mul_f32 v187, v19, v187
    v_mul_f32 v188, v19, v188
    v_mul_f32 v189, v19, v189
    v_mul_f32 v190, v19, v190
    v_mul_f32 v191, v19, v191
    v_mul_f32 v192, v20, v192
    v_mul_f32 v193, v20, v193
    v_mul_f32 v194, v20, v194
    v_mul_f32 v195, v20, v195
    v_mul_f32 v196, v20, v196
    v_mul_f32 v197, v20, v197
    v_mul_f32 v198, v20, v198
    v_mul_f32 v199, v20, v199
    v_mul_f32 v200, v20, v200
    v_mul_f32 v201, v20, v201
    v_mul_f32 v202, v20, v202
    v_mul_f32 v203, v20, v203
    v_mul_f32 v204, v20, v204
    v_mul_f32 v205, v20, v205
    v_mul_f32 v206, v20, v206
    v_mul_f32 v207, v20, v207
    v_mul_f32 v208, v21, v208
    v_mul_f32 v209, v21, v209
    v_mul_f32 v210, v21, v210
    v_mul_f32 v211, v21, v211
    v_mul_f32 v212, v21, v212
    v_mul_f32 v213, v21, v213
    v_mul_f32 v214, v21, v214
    v_mul_f32 v215, v21, v215
    v_mul_f32 v216, v21, v216
    v_mul_f32 v217, v21, v217
    v_mul_f32 v218, v21, v218
    v_mul_f32 v219, v21, v219
    v_mul_f32 v220, v21, v220
    v_mul_f32 v221, v21, v221
    v_mul_f32 v222, v21, v222
    v_mul_f32 v223, v21, v223
    v_mul_f32 v224, v22, v224
    v_mul_f32 v225, v22, v225
    v_mul_f32 v226, v22, v226
    v_mul_f32 v227, v22, v227
    v_mul_f32 v228, v22, v228
    v_mul_f32 v229, v22, v229
    v_mul_f32 v230, v22, v230
    v_mul_f32 v231, v22, v231
    v_mul_f32 v232, v22, v232
    v_mul_f32 v233, v22, v233
    v_mul_f32 v234, v22, v234
    v_mul_f32 v235, v22, v235
    v_mul_f32 v236, v22, v236
    v_mul_f32 v237, v22, v237
    v_mul_f32 v238, v22, v238
    v_mul_f32 v239, v22, v239
    v_mul_f32 v240, v23, v240
    v_mul_f32 v241, v23, v241
    v_mul_f32 v242, v23, v242
    v_mul_f32 v243, v23, v243
    v_mul_f32 v244, v23, v244
    v_mul_f32 v245, v23, v245
    v_mul_f32 v246, v23, v246
    v_mul_f32 v247, v23, v247
    v_mul_f32 v248, v23, v248
    v_mul_f32 v249, v23, v249
    v_mul_f32 v250, v23, v250
    v_mul_f32 v251, v23, v251
    v_mul_f32 v252, v23, v252
    v_mul_f32 v253, v23, v253
    v_mul_f32 v254, v23, v254
    v_mul_f32 v255, v23, v255
    s_lshl_b32 s28, s26, 7
    s_add_u32 s29, s28, 2176
    s_bfm_b64 exec, 16, 0
    s_mov_b32 s39, 200000
L_poll_17:
    buffer_load_dword v25, v24, s[4:7], s29 offen sc1
    s_waitcnt vmcnt(0)
    v_cmp_ne_u32 vcc, 0, v25
    s_nop 3
    s_cmp_eq_u64 vcc, exec
    s_cbranch_scc1 L_polld_18
    s_sleep 4
    s_sub_u32 s39, s39, 1
    s_cmp_lg_u32 s39, 0
    s_cbranch_scc1 L_poll_17
L_polld_18:
    s_mov_b64 exec, -1
    buffer_load_dwordx4 v[64:67], v8, s[48:51], s58 offen offset:0 sc1
    buffer_load_dwordx4 v[68:71], v8, s[48:51], s58 offen offset:1024 sc1
    buffer_load_dwordx4 v[72:75], v9, s[48:51], s58 offen offset:0 sc1
    buffer_load_dwordx4 v[76:79], v9, s[48:51], s58 offen offset:1024 sc1
    buffer_load_dwordx4 v[80:83], v10, s[48:51], s58 offen offset:0 sc1
    buffer_load_dwordx4 v[84:87], v10, s[48:51], s58 offen offset:1024 sc1
    buffer_load_dwordx4 v[88:91], v11, s[48:51], s58 offen offset:0 sc1
    buffer_load_dwordx4 v[92:95], v11, s[48:51], s58 offen offset:1024 sc1
    s_add_u32 s58, s58, 8192
    buffer_load_dwordx4 v[96:99], v8, s[48:51], s58 offen offset:0 sc1
    buffer_load_dwordx4 v[100:103], v8, s[48:51], s58 offen offset:1024 sc1
    buffer_load_dwordx4 v[104:107], v9, s[48:51], s58 offen offset:0 sc1
    buffer_load_dwordx4 v[108:111], v9, s[48:51], s58 offen offset:1024 sc1
    buffer_load_dwordx4 v[112:115], v10, s[48:51], s58 offen offset:0 sc1
    buffer_load_dwordx4 v[116:119], v10, s[48:51], s58 offen offset:1024 sc1
    buffer_load_dwordx4 v[120:123], v11, s[48:51], s58 offen offset:0 sc1
    buffer_load_dwordx4 v[124:127], v11, s[48:51], s58 offen offset:1024 sc1
    s_add_u32 s58, s58, 8192
    s_setprio 2
    s_waitcnt vmcnt(15)
    s_waitcnt vmcnt(14)
    v_mfma_f32_16x16x32_bf16 v[128:131], v[32:35], v[64:67], v[128:131]
    v_mfma_f32_16x16x32_bf16 v[132:135], v[36:39], v[64:67], v[132:135]
    ds_read_b64_tr_b16 v[48:49], v4 offset:4096
    v_mfma_f32_16x16x32_bf16 v[136:139], v[40:43], v[64:67], v[136:139]
    ds_read_b64_tr_b16 v[50:51], v4 offset:6144
    v_mfma_f32_16x16x32_bf16 v[140:143], v[44:47], v[64:67], v[140:143]
    ds_read_b64_tr_b16 v[52:53], v5 offset:4096
    v_mfma_f32_16x16x32_bf16 v[156:159], v[44:47], v[68:71], v[156:159]
    buffer_load_dwordx4 v[64:67], v8, s[48:51], s58 offen offset:0 sc1
    v_mfma_f32_16x16x32_bf16 v[152:155], v[40:43], v[68:71], v[152:155]
    ds_read_b64_tr_b16 v[54:55], v5 offset:6144
    v_mfma_f32_16x16x32_bf16 v[148:151], v[36:39], v[68:71], v[148:151]
    ds_read_b64_tr_b16 v[56:57], v6 offset:4096
    v_mfma_f32_16x16x32_bf16 v[144:147], v[32:35], v[68:71], v[144:147]
    ds_read_b64_tr_b16 v[58:59], v6 offset:6144
    s_waitcnt vmcnt(13)
    v_mfma_f32_16x16x32_bf16 v[160:163], v[32:35], v[72:75], v[160:163]
    buffer_load_dwordx4 v[68:71], v8, s[48:51], s58 offen offset:1024 sc1
    v_mfma_f32_16x16x32_bf16 v[164:167], v[36:39], v[72:75], v[164:167]
    ds_read_b64_tr_b16 v[60:61], v7 offset:4096
    v_mfma_f32_16x16x32_bf16 v[168:171], v[40:43], v[72:75], v[168:171]
    ds_read_b64_tr_b16 v[62:63], v7 offset:6144
    v_mfma_f32_16x16x32_bf16 v[172:175], v[44:47], v[72:75], v[172:175]
    v_mfma_f32_16x16x32_bf16 v[188:191], v[44:47], v[76:79], v[188:191]
    buffer_load_dwordx4 v[72:75], v9, s[48:51], s58 offen offset:0 sc1
    v_mfma_f32_16x16x32_bf16 v[184:187], v[40:43], v[76:79], v[184:187]
    s_add_u32 m0, s37, 0
    v_mfma_f32_16x16x32_bf16 v[180:183], v[36:39], v[76:79], v[180:183]
    buffer_load_dwordx4 v12, s[16:19], s57 offen offset:0 lds
    v_mfma_f32_16x16x32_bf16 v[176:179], v[32:35], v[76:79], v[176:179]
    buffer_load_dwordx4 v13, s[16:19], s57 offen offset:1024 lds
    s_waitcnt vmcnt(15)
    v_mfma_f32_16x16x32_bf16 v[192:195], v[32:35], v[80:83], v[192:195]
    buffer_load_dwordx4 v[76:79], v9, s[48:51], s58 offen offset:1024 sc1
    v_mfma_f32_16x16x32_bf16 v[196:199], v[36:39], v[80:83], v[196:199]
    buffer_load_dwordx4 v14, s[16:19], s57 offen offset:2048 lds
    v_mfma_f32_16x16x32_bf16 v[200:203], v[40:43], v[80:83], v[200:203]
    buffer_load_dwordx4 v15, s[16:19], s57 offen offset:3072 lds
    v_mfma_f32_16x16x32_bf16 v[204:207], v[44:47], v[80:83], v[204:207]
    s_add_u32 s57, s57, 65536
    v_mfma_f32_16x16x32_bf16 v[220:223], v[44:47], v[84:87], v[220:223]
    buffer_load_dwordx4 v[80:83], v10, s[48:51], s58 offen offset:0 sc1
    v_mfma_f32_16x16x32_bf16 v[216:219], v[40:43], v[84:87], v[216:219]
    v_mfma_f32_16x16x32_bf16 v[212:215], v[36:39], v[84:87], v[212:215]
    v_mfma_f32_16x16x32_bf16 v[208:211], v[32:35], v[84:87], v[208:211]
    s_waitcnt vmcnt(17)
    v_mfma_f32_16x16x32_bf16 v[224:227], v[32:35], v[88:91], v[224:227]
    buffer_load_dwordx4 v[84:87], v10, s[48:51], s58 offen offset:1024 sc1
    v_mfma_f32_16x16x32_bf16 v[228:231], v[36:39], v[88:91], v[228:231]
    v_mfma_f32_16x16x32_bf16 v[232:235], v[40:43], v[88:91], v[232:235]
    v_mfma_f32_16x16x32_bf16 v[236:239], v[44:47], v[88:91], v[236:239]
    v_mfma_f32_16x16x32_bf16 v[252:255], v[44:47], v[92:95], v[252:255]
    buffer_load_dwordx4 v[88:91], v11, s[48:51], s58 offen offset:0 sc1
    v_mfma_f32_16x16x32_bf16 v[248:251], v[40:43], v[92:95], v[248:251]
    v_mfma_f32_16x16x32_bf16 v[244:247], v[36:39], v[92:95], v[244:247]
    v_mfma_f32_16x16x32_bf16 v[240:243], v[32:35], v[92:95], v[240:243]
    buffer_load_dwordx4 v[92:95], v11, s[48:51], s58 offen offset:1024 sc1
    s_add_u32 s58, s58, 8192
    s_waitcnt lgkmcnt(0)
    s_waitcnt vmcnt(19)
    s_waitcnt vmcnt(18)
    v_mfma_f32_16x16x32_bf16 v[128:131], v[48:51], v[96:99], v[128:131]
    v_mfma_f32_16x16x32_bf16 v[132:135], v[52:55], v[96:99], v[132:135]
    ds_read_b64_tr_b16 v[32:33], v4 offset:8192
    v_mfma_f32_16x16x32_bf16 v[136:139], v[56:59], v[96:99], v[136:139]
    ds_read_b64_tr_b16 v[34:35], v4 offset:10240
    v_mfma_f32_16x16x32_bf16 v[140:143], v[60:63], v[96:99], v[140:143]
    ds_read_b64_tr_b16 v[36:37], v5 offset:8192
    v_mfma_f32_16x16x32_bf16 v[156:159], v[60:63], v[100:103], v[156:159]
    buffer_load_dwordx4 v[96:99], v8, s[48:51], s58 offen offset:0 sc1
    v_mfma_f32_16x16x32_bf16 v[152:155], v[56:59], v[100:103], v[152:155]
    ds_read_b64_tr_b16 v[38:39], v5 offset:10240
    v_mfma_f32_16x16x32_bf16 v[148:151], v[52:55], v[100:103], v[148:151]
    ds_read_b64_tr_b16 v[40:41], v6 offset:8192
    v_mfma_f32_16x16x32_bf16 v[144:147], v[48:51], v[100:103], v[144:147]
    ds_read_b64_tr_b16 v[42:43], v6 offset:10240
    s_waitcnt vmcnt(17)
    v_mfma_f32_16x16x32_bf16 v[160:163], v[48:51], v[104:107], v[160:163]
    buffer_load_dwordx4 v[100:103], v8, s[48:51], s58 offen offset:1024 sc1
    v_mfma_f32_16x16x32_bf16 v[164:167], v[52:55], v[104:107], v[164:167]
    ds_read_b64_tr_b16 v[44:45], v7 offset:8192
    v_mfma_f32_16x16x32_bf16 v[168:171], v[56:59], v[104:107], v[168:171]
    ds_read_b64_tr_b16 v[46:47], v7 offset:10240
    v_mfma_f32_16x16x32_bf16 v[172:175], v[60:63], v[104:107], v[172:175]
    v_mfma_f32_16x16x32_bf16 v[188:191], v[60:63], v[108:111], v[188:191]
    buffer_load_dwordx4 v[104:107], v9, s[48:51], s58 offen offset:0 sc1
    v_mfma_f32_16x16x32_bf16 v[184:187], v[56:59], v[108:111], v[184:187]
    s_add_u32 m0, s37, 4096
    v_mfma_f32_16x16x32_bf16 v[180:183], v[52:55], v[108:111], v[180:183]
    buffer_load_dwordx4 v12, s[16:19], s57 offen offset:0 lds
    v_mfma_f32_16x16x32_bf16 v[176:179], v[48:51], v[108:111], v[176:179]
    buffer_load_dwordx4 v13, s[16:19], s57 offen offset:1024 lds
    s_waitcnt vmcnt(19)
    v_mfma_f32_16x16x32_bf16 v[192:195], v[48:51], v[112:115], v[192:195]
    buffer_load_dwordx4 v[108:111], v9, s[48:51], s58 offen offset:1024 sc1
    v_mfma_f32_16x16x32_bf16 v[196:199], v[52:55], v[112:115], v[196:199]
    buffer_load_dwordx4 v14, s[16:19], s57 offen offset:2048 lds
    v_mfma_f32_16x16x32_bf16 v[200:203], v[56:59], v[112:115], v[200:203]
    buffer_load_dwordx4 v15, s[16:19], s57 offen offset:3072 lds
    v_mfma_f32_16x16x32_bf16 v[204:207], v[60:63], v[112:115], v[204:207]
    s_add_u32 s57, s57, 65536
    v_mfma_f32_16x16x32_bf16 v[220:223], v[60:63], v[116:119], v[220:223]
    buffer_load_dwordx4 v[112:115], v10, s[48:51], s58 offen offset:0 sc1
    v_mfma_f32_16x16x32_bf16 v[216:219], v[56:59], v[116:119], v[216:219]
    v_mfma_f32_16x16x32_bf16 v[212:215], v[52:55], v[116:119], v[212:215]
    v_mfma_f32_16x16x32_bf16 v[208:211], v[48:51], v[116:119], v[208:211]
    s_waitcnt vmcnt(21)
    v_mfma_f32_16x16x32_bf16 v[224:227], v[48:51], v[120:123], v[224:227]
    buffer_load_dwordx4 v[116:119], v10, s[48:51], s58 offen offset:1024 sc1
    v_mfma_f32_16x16x32_bf16 v[228:231], v[52:55], v[120:123], v[228:231]
    v_mfma_f32_16x16x32_bf16 v[232:235], v[56:59], v[120:123], v[232:235]
    v_mfma_f32_16x16x32_bf16 v[236:239], v[60:63], v[120:123], v[236:239]
    v_mfma_f32_16x16x32_bf16 v[252:255], v[60:63], v[124:127], v[252:255]
    buffer_load_dwordx4 v[120:123], v11, s[48:51], s58 offen offset:0 sc1
    v_mfma_f32_16x16x32_bf16 v[248:251], v[56:59], v[124:127], v[248:251]
    v_mfma_f32_16x16x32_bf16 v[244:247], v[52:55], v[124:127], v[244:247]
    v_mfma_f32_16x16x32_bf16 v[240:243], v[48:51], v[124:127], v[240:243]
    buffer_load_dwordx4 v[124:127], v11, s[48:51], s58 offen offset:1024 sc1
    s_add_u32 s58, s58, 8192
    s_waitcnt lgkmcnt(0)
    s_waitcnt vmcnt(23)
    s_waitcnt vmcnt(22)
    v_mfma_f32_16x16x32_bf16 v[128:131], v[32:35], v[64:67], v[128:131]
    v_mfma_f32_16x16x32_bf16 v[132:135], v[36:39], v[64:67], v[132:135]
    ds_read_b64_tr_b16 v[48:49], v4 offset:12288
    v_mfma_f32_16x16x32_bf16 v[136:139], v[40:43], v[64:67], v[136:139]
    ds_read_b64_tr_b16 v[50:51], v4 offset:14336
    v_mfma_f32_16x16x32_bf16 v[140:143], v[44:47], v[64:67], v[140:143]
    ds_read_b64_tr_b16 v[52:53], v5 offset:12288
    v_mfma_f32_16x16x32_bf16 v[156:159], v[44:47], v[68:71], v[156:159]
    buffer_load_dwordx4 v[64:67], v8, s[48:51], s58 offen offset:0 sc1
    v_mfma_f32_16x16x32_bf16 v[152:155], v[40:43], v[68:71], v[152:155]
    ds_read_b64_tr_b16 v[54:55], v5 offset:14336
    v_mfma_f32_16x16x32_bf16 v[148:151], v[36:39], v[68:71], v[148:151]
    ds_read_b64_tr_b16 v[56:57], v6 offset:12288
    v_mfma_f32_16x16x32_bf16 v[144:147], v[32:35], v[68:71], v[144:147]
    ds_read_b64_tr_b16 v[58:59], v6 offset:14336
    s_waitcnt vmcnt(19)
    v_mfma_f32_16x16x32_bf16 v[160:163], v[32:35], v[72:75], v[160:163]
    buffer_load_dwordx4 v[68:71], v8, s[48:51], s58 offen offset:1024 sc1
    v_mfma_f32_16x16x32_bf16 v[164:167], v[36:39], v[72:75], v[164:167]
    ds_read_b64_tr_b16 v[60:61], v7 offset:12288
    v_mfma_f32_16x16x32_bf16 v[168:171], v[40:43], v[72:75], v[168:171]
    ds_read_b64_tr_b16 v[62:63], v7 offset:14336
    v_mfma_f32_16x16x32_bf16 v[172:175], v[44:47], v[72:75], v[172:175]
    v_mfma_f32_16x16x32_bf16 v[188:191], v[44:47], v[76:79], v[188:191]
    buffer_load_dwordx4 v[72:75], v9, s[48:51], s58 offen offset:0 sc1
    v_mfma_f32_16x16x32_bf16 v[184:187], v[40:43], v[76:79], v[184:187]
    s_add_u32 m0, s37, 8192
    v_mfma_f32_16x16x32_bf16 v[180:183], v[36:39], v[76:79], v[180:183]
    buffer_load_dwordx4 v12, s[16:19], s57 offen offset:0 lds
    v_mfma_f32_16x16x32_bf16 v[176:179], v[32:35], v[76:79], v[176:179]
    buffer_load_dwordx4 v13, s[16:19], s57 offen offset:1024 lds
    s_waitcnt vmcnt(19)
    v_mfma_f32_16x16x32_bf16 v[192:195], v[32:35], v[80:83], v[192:195]
    buffer_load_dwordx4 v[76:79], v9, s[48:51], s58 offen offset:1024 sc1
    v_mfma_f32_16x16x32_bf16 v[196:199], v[36:39], v[80:83], v[196:199]
    buffer_load_dwordx4 v14, s[16:19], s57 offen offset:2048 lds
    v_mfma_f32_16x16x32_bf16 v[200:203], v[40:43], v[80:83], v[200:203]
    buffer_load_dwordx4 v15, s[16:19], s57 offen offset:3072 lds
    v_mfma_f32_16x16x32_bf16 v[204:207], v[44:47], v[80:83], v[204:207]
    s_add_u32 s57, s57, 65536
    v_mfma_f32_16x16x32_bf16 v[220:223], v[44:47], v[84:87], v[220:223]
    buffer_load_dwordx4 v[80:83], v10, s[48:51], s58 offen offset:0 sc1
    v_mfma_f32_16x16x32_bf16 v[216:219], v[40:43], v[84:87], v[216:219]
    v_mfma_f32_16x16x32_bf16 v[212:215], v[36:39], v[84:87], v[212:215]
    v_mfma_f32_16x16x32_bf16 v[208:211], v[32:35], v[84:87], v[208:211]
    s_waitcnt vmcnt(21)
    v_mfma_f32_16x16x32_bf16 v[224:227], v[32:35], v[88:91], v[224:227]
    buffer_load_dwordx4 v[84:87], v10, s[48:51], s58 offen offset:1024 sc1
    v_mfma_f32_16x16x32_bf16 v[228:231], v[36:39], v[88:91], v[228:231]
    v_mfma_f32_16x16x32_bf16 v[232:235], v[40:43], v[88:91], v[232:235]
    v_mfma_f32_16x16x32_bf16 v[236:239], v[44:47], v[88:91], v[236:239]
    v_mfma_f32_16x16x32_bf16 v[252:255], v[44:47], v[92:95], v[252:255]
    buffer_load_dwordx4 v[88:91], v11, s[48:51], s58 offen offset:0 sc1
    v_mfma_f32_16x16x32_bf16 v[248:251], v[40:43], v[92:95], v[248:251]
    v_mfma_f32_16x16x32_bf16 v[244:247], v[36:39], v[92:95], v[244:247]
    v_mfma_f32_16x16x32_bf16 v[240:243], v[32:35], v[92:95], v[240:243]
    buffer_load_dwordx4 v[92:95], v11, s[48:51], s58 offen offset:1024 sc1
    s_add_u32 s58, s58, 8192
    s_waitcnt lgkmcnt(0)
    s_waitcnt vmcnt(23)
    s_waitcnt vmcnt(22)
    v_mfma_f32_16x16x32_bf16 v[128:131], v[48:51], v[96:99], v[128:131]
    v_mfma_f32_16x16x32_bf16 v[132:135], v[52:55], v[96:99], v[132:135]
    ds_read_b64_tr_b16 v[32:33], v4 offset:0
    v_mfma_f32_16x16x32_bf16 v[136:139], v[56:59], v[96:99], v[136:139]
    ds_read_b64_tr_b16 v[34:35], v4 offset:2048
    v_mfma_f32_16x16x32_bf16 v[140:143], v[60:63], v[96:99], v[140:143]
    ds_read_b64_tr_b16 v[36:37], v5 offset:0
    v_mfma_f32_16x16x32_bf16 v[156:159], v[60:63], v[100:103], v[156:159]
    buffer_load_dwordx4 v[96:99], v8, s[48:51], s58 offen offset:0 sc1
    v_mfma_f32_16x16x32_bf16 v[152:155], v[56:59], v[100:103], v[152:155]
    ds_read_b64_tr_b16 v[38:39], v5 offset:2048
    v_mfma_f32_16x16x32_bf16 v[148:151], v[52:55], v[100:103], v[148:151]
    ds_read_b64_tr_b16 v[40:41], v6 offset:0
    v_mfma_f32_16x16x32_bf16 v[144:147], v[48:51], v[100:103], v[144:147]
    ds_read_b64_tr_b16 v[42:43], v6 offset:2048
    s_waitcnt vmcnt(19)
    v_mfma_f32_16x16x32_bf16 v[160:163], v[48:51], v[104:107], v[160:163]
    buffer_load_dwordx4 v[100:103], v8, s[48:51], s58 offen offset:1024 sc1
    v_mfma_f32_16x16x32_bf16 v[164:167], v[52:55], v[104:107], v[164:167]
    ds_read_b64_tr_b16 v[44:45], v7 offset:0
    v_mfma_f32_16x16x32_bf16 v[168:171], v[56:59], v[104:107], v[168:171]
    ds_read_b64_tr_b16 v[46:47], v7 offset:2048
    v_mfma_f32_16x16x32_bf16 v[172:175], v[60:63], v[104:107], v[172:175]
    v_mfma_f32_16x16x32_bf16 v[188:191], v[60:63], v[108:111], v[188:191]
    buffer_load_dwordx4 v[104:107], v9, s[48:51], s58 offen offset:0 sc1
    v_mfma_f32_16x16x32_bf16 v[184:187], v[56:59], v[108:111], v[184:187]
    s_add_u32 m0, s37, 12288
    v_mfma_f32_16x16x32_bf16 v[180:183], v[52:55], v[108:111], v[180:183]
    buffer_load_dwordx4 v12, s[16:19], s57 offen offset:0 lds
    v_mfma_f32_16x16x32_bf16 v[176:179], v[48:51], v[108:111], v[176:179]
    buffer_load_dwordx4 v13, s[16:19], s57 offen offset:1024 lds
    s_waitcnt vmcnt(19)
    v_mfma_f32_16x16x32_bf16 v[192:195], v[48:51], v[112:115], v[192:195]
    buffer_load_dwordx4 v[108:111], v9, s[48:51], s58 offen offset:1024 sc1
    v_mfma_f32_16x16x32_bf16 v[196:199], v[52:55], v[112:115], v[196:199]
    buffer_load_dwordx4 v14, s[16:19], s57 offen offset:2048 lds
    v_mfma_f32_16x16x32_bf16 v[200:203], v[56:59], v[112:115], v[200:203]
    buffer_load_dwordx4 v15, s[16:19], s57 offen offset:3072 lds
    v_mfma_f32_16x16x32_bf16 v[204:207], v[60:63], v[112:115], v[204:207]
    s_add_u32 s57, s57, 65536
    v_mfma_f32_16x16x32_bf16 v[220:223], v[60:63], v[116:119], v[220:223]
    buffer_load_dwordx4 v[112:115], v10, s[48:51], s58 offen offset:0 sc1
    v_mfma_f32_16x16x32_bf16 v[216:219], v[56:59], v[116:119], v[216:219]
    v_mfma_f32_16x16x32_bf16 v[212:215], v[52:55], v[116:119], v[212:215]
    v_mfma_f32_16x16x32_bf16 v[208:211], v[48:51], v[116:119], v[208:211]
    s_waitcnt vmcnt(21)
    v_mfma_f32_16x16x32_bf16 v[224:227], v[48:51], v[120:123], v[224:227]
    buffer_load_dwordx4 v[116:119], v10, s[48:51], s58 offen offset:1024 sc1
    v_mfma_f32_16x16x32_bf16 v[228:231], v[52:55], v[120:123], v[228:231]
    v_mfma_f32_16x16x32_bf16 v[232:235], v[56:59], v[120:123], v[232:235]
    v_mfma_f32_16x16x32_bf16 v[236:239], v[60:63], v[120:123], v[236:239]
    v_mfma_f32_16x16x32_bf16 v[252:255], v[60:63], v[124:127], v[252:255]
    buffer_load_dwordx4 v[120:123], v11, s[48:51], s58 offen offset:0 sc1
    v_mfma_f32_16x16x32_bf16 v[248:251], v[56:59], v[124:127], v[248:251]
    v_mfma_f32_16x16x32_bf16 v[244:247], v[52:55], v[124:127], v[244:247]
    v_mfma_f32_16x16x32_bf16 v[240:243], v[48:51], v[124:127], v[240:243]
    buffer_load_dwordx4 v[124:127], v11, s[48:51], s58 offen offset:1024 sc1
    s_add_u32 s58, s58, 8192
    s_waitcnt lgkmcnt(0)
    s_waitcnt vmcnt(23)
    s_waitcnt vmcnt(22)
    v_mfma_f32_16x16x32_bf16 v[128:131], v[32:35], v[64:67], v[128:131]
    v_mfma_f32_16x16x32_bf16 v[132:135], v[36:39], v[64:67], v[132:135]
    ds_read_b64_tr_b16 v[48:49], v4 offset:4096
    v_mfma_f32_16x16x32_bf16 v[136:139], v[40:43], v[64:67], v[136:139]
    ds_read_b64_tr_b16 v[50:51], v4 offset:6144
    v_mfma_f32_16x16x32_bf16 v[140:143], v[44:47], v[64:67], v[140:143]
    ds_read_b64_tr_b16 v[52:53], v5 offset:4096
    v_mfma_f32_16x16x32_bf16 v[156:159], v[44:47], v[68:71], v[156:159]
    buffer_load_dwordx4 v[64:67], v8, s[48:51], s58 offen offset:0 sc1
    v_mfma_f32_16x16x32_bf16 v[152:155], v[40:43], v[68:71], v[152:155]
    ds_read_b64_tr_b16 v[54:55], v5 offset:6144
    v_mfma_f32_16x16x32_bf16 v[148:151], v[36:39], v[68:71], v[148:151]
    ds_read_b64_tr_b16 v[56:57], v6 offset:4096
    v_mfma_f32_16x16x32_bf16 v[144:147], v[32:35], v[68:71], v[144:147]
    ds_read_b64_tr_b16 v[58:59], v6 offset:6144
    s_waitcnt vmcnt(19)
    v_mfma_f32_16x16x32_bf16 v[160:163], v[32:35], v[72:75], v[160:163]
    buffer_load_dwordx4 v[68:71], v8, s[48:51], s58 offen offset:1024 sc1
    v_mfma_f32_16x16x32_bf16 v[164:167], v[36:39], v[72:75], v[164:167]
    ds_read_b64_tr_b16 v[60:61], v7 offset:4096
    v_mfma_f32_16x16x32_bf16 v[168:171], v[40:43], v[72:75], v[168:171]
    ds_read_b64_tr_b16 v[62:63], v7 offset:6144
    v_mfma_f32_16x16x32_bf16 v[172:175], v[44:47], v[72:75], v[172:175]
    v_mfma_f32_16x16x32_bf16 v[188:191], v[44:47], v[76:79], v[188:191]
    buffer_load_dwordx4 v[72:75], v9, s[48:51], s58 offen offset:0 sc1
    v_mfma_f32_16x16x32_bf16 v[184:187], v[40:43], v[76:79], v[184:187]
    v_mfma_f32_16x16x32_bf16 v[180:183], v[36:39], v[76:79], v[180:183]
    v_mfma_f32_16x16x32_bf16 v[176:179], v[32:35], v[76:79], v[176:179]
    s_waitcnt vmcnt(17)
    v_mfma_f32_16x16x32_bf16 v[192:195], v[32:35], v[80:83], v[192:195]
    buffer_load_dwordx4 v[76:79], v9, s[48:51], s58 offen offset:1024 sc1
    v_mfma_f32_16x16x32_bf16 v[196:199], v[36:39], v[80:83], v[196:199]
    v_mfma_f32_16x16x32_bf16 v[200:203], v[40:43], v[80:83], v[200:203]
    v_mfma_f32_16x16x32_bf16 v[204:207], v[44:47], v[80:83], v[204:207]
    v_mfma_f32_16x16x32_bf16 v[220:223], v[44:47], v[84:87], v[220:223]
    buffer_load_dwordx4 v[80:83], v10, s[48:51], s58 offen offset:0 sc1
    v_mfma_f32_16x16x32_bf16 v[216:219], v[40:43], v[84:87], v[216:219]
    v_mfma_f32_16x16x32_bf16 v[212:215], v[36:39], v[84:87], v[212:215]
    v_mfma_f32_16x16x32_bf16 v[208:211], v[32:35], v[84:87], v[208:211]
    s_waitcnt vmcnt(17)
    v_mfma_f32_16x16x32_bf16 v[224:227], v[32:35], v[88:91], v[224:227]
    buffer_load_dwordx4 v[84:87], v10, s[48:51], s58 offen offset:1024 sc1
    v_mfma_f32_16x16x32_bf16 v[228:231], v[36:39], v[88:91], v[228:231]
    v_mfma_f32_16x16x32_bf16 v[232:235], v[40:43], v[88:91], v[232:235]
    v_mfma_f32_16x16x32_bf16 v[236:239], v[44:47], v[88:91], v[236:239]
    v_mfma_f32_16x16x32_bf16 v[252:255], v[44:47], v[92:95], v[252:255]
    buffer_load_dwordx4 v[88:91], v11, s[48:51], s58 offen offset:0 sc1
    v_mfma_f32_16x16x32_bf16 v[248:251], v[40:43], v[92:95], v[248:251]
    v_mfma_f32_16x16x32_bf16 v[244:247], v[36:39], v[92:95], v[244:247]
    v_mfma_f32_16x16x32_bf16 v[240:243], v[32:35], v[92:95], v[240:243]
    buffer_load_dwordx4 v[92:95], v11, s[48:51], s58 offen offset:1024 sc1
    s_add_u32 s58, s58, 8192
    s_waitcnt lgkmcnt(0)
    s_waitcnt vmcnt(19)
    s_waitcnt vmcnt(18)
    v_mfma_f32_16x16x32_bf16 v[128:131], v[48:51], v[96:99], v[128:131]
    v_mfma_f32_16x16x32_bf16 v[132:135], v[52:55], v[96:99], v[132:135]
    ds_read_b64_tr_b16 v[32:33], v4 offset:8192
    v_mfma_f32_16x16x32_bf16 v[136:139], v[56:59], v[96:99], v[136:139]
    ds_read_b64_tr_b16 v[34:35], v4 offset:10240
    v_mfma_f32_16x16x32_bf16 v[140:143], v[60:63], v[96:99], v[140:143]
    ds_read_b64_tr_b16 v[36:37], v5 offset:8192
    v_mfma_f32_16x16x32_bf16 v[156:159], v[60:63], v[100:103], v[156:159]
    buffer_load_dwordx4 v[96:99], v8, s[48:51], s58 offen offset:0 sc1
    v_mfma_f32_16x16x32_bf16 v[152:155], v[56:59], v[100:103], v[152:155]
    ds_read_b64_tr_b16 v[38:39], v5 offset:10240
    v_mfma_f32_16x16x32_bf16 v[148:151], v[52:55], v[100:103], v[148:151]
    ds_read_b64_tr_b16 v[40:41], v6 offset:8192
    v_mfma_f32_16x16x32_bf16 v[144:147], v[48:51], v[100:103], v[144:147]
    ds_read_b64_tr_b16 v[42:43], v6 offset:10240
    s_waitcnt vmcnt(15)
    v_mfma_f32_16x16x32_bf16 v[160:163], v[48:51], v[104:107], v[160:163]
    buffer_load_dwordx4 v[100:103], v8, s[48:51], s58 offen offset:1024 sc1
    v_mfma_f32_16x16x32_bf16 v[164:167], v[52:55], v[104:107], v[164:167]
    ds_read_b64_tr_b16 v[44:45], v7 offset:8192
    v_mfma_f32_16x16x32_bf16 v[168:171], v[56:59], v[104:107], v[168:171]
    ds_read_b64_tr_b16 v[46:47], v7 offset:10240
    v_mfma_f32_16x16x32_bf16 v[172:175], v[60:63], v[104:107], v[172:175]
    v_mfma_f32_16x16x32_bf16 v[188:191], v[60:63], v[108:111], v[188:191]
    buffer_load_dwordx4 v[104:107], v9, s[48:51], s58 offen offset:0 sc1
    v_mfma_f32_16x16x32_bf16 v[184:187], v[56:59], v[108:111], v[184:187]
    v_mfma_f32_16x16x32_bf16 v[180:183], v[52:55], v[108:111], v[180:183]
    v_mfma_f32_16x16x32_bf16 v[176:179], v[48:51], v[108:111], v[176:179]
    s_waitcnt vmcnt(13)
    v_mfma_f32_16x16x32_bf16 v[192:195], v[48:51], v[112:115], v[192:195]
    buffer_load_dwordx4 v[108:111], v9, s[48:51], s58 offen offset:1024 sc1
    v_mfma_f32_16x16x32_bf16 v[196:199], v[52:55], v[112:115], v[196:199]
    v_mfma_f32_16x16x32_bf16 v[200:203], v[56:59], v[112:115], v[200:203]
    v_mfma_f32_16x16x32_bf16 v[204:207], v[60:63], v[112:115], v[204:207]
    v_mfma_f32_16x16x32_bf16 v[220:223], v[60:63], v[116:119], v[220:223]
    buffer_load_dwordx4 v[112:115], v10, s[48:51], s58 offen offset:0 sc1
    v_mfma_f32_16x16x32_bf16 v[216:219], v[56:59], v[116:119], v[216:219]
    v_mfma_f32_16x16x32_bf16 v[212:215], v[52:55], v[116:119], v[212:215]
    v_mfma_f32_16x16x32_bf16 v[208:211], v[48:51], v[116:119], v[208:211]
    s_waitcnt vmcnt(13)
    v_mfma_f32_16x16x32_bf16 v[224:227], v[48:51], v[120:123], v[224:227]
    buffer_load_dwordx4 v[116:119], v10, s[48:51], s58 offen offset:1024 sc1
    v_mfma_f32_16x16x32_bf16 v[228:231], v[52:55], v[120:123], v[228:231]
    v_mfma_f32_16x16x32_bf16 v[232:235], v[56:59], v[120:123], v[232:235]
    v_mfma_f32_16x16x32_bf16 v[236:239], v[60:63], v[120:123], v[236:239]
    v_mfma_f32_16x16x32_bf16 v[252:255], v[60:63], v[124:127], v[252:255]
    buffer_load_dwordx4 v[120:123], v11, s[48:51], s58 offen offset:0 sc1
    v_mfma_f32_16x16x32_bf16 v[248:251], v[56:59], v[124:127], v[248:251]
    v_mfma_f32_16x16x32_bf16 v[244:247], v[52:55], v[124:127], v[244:247]
    v_mfma_f32_16x16x32_bf16 v[240:243], v[48:51], v[124:127], v[240:243]
    buffer_load_dwordx4 v[124:127], v11, s[48:51], s58 offen offset:1024 sc1
    s_add_u32 s58, s58, 8192
    s_waitcnt lgkmcnt(0)
    s_waitcnt vmcnt(15)
    s_waitcnt vmcnt(14)
    v_mfma_f32_16x16x32_bf16 v[128:131], v[32:35], v[64:67], v[128:131]
    v_mfma_f32_16x16x32_bf16 v[132:135], v[36:39], v[64:67], v[132:135]
    ds_read_b64_tr_b16 v[48:49], v4 offset:12288
    v_mfma_f32_16x16x32_bf16 v[136:139], v[40:43], v[64:67], v[136:139]
    ds_read_b64_tr_b16 v[50:51], v4 offset:14336
    v_mfma_f32_16x16x32_bf16 v[140:143], v[44:47], v[64:67], v[140:143]
    ds_read_b64_tr_b16 v[52:53], v5 offset:12288
    v_mfma_f32_16x16x32_bf16 v[156:159], v[44:47], v[68:71], v[156:159]
    v_mfma_f32_16x16x32_bf16 v[152:155], v[40:43], v[68:71], v[152:155]
    ds_read_b64_tr_b16 v[54:55], v5 offset:14336
    v_mfma_f32_16x16x32_bf16 v[148:151], v[36:39], v[68:71], v[148:151]
    ds_read_b64_tr_b16 v[56:57], v6 offset:12288
    v_mfma_f32_16x16x32_bf16 v[144:147], v[32:35], v[68:71], v[144:147]
    ds_read_b64_tr_b16 v[58:59], v6 offset:14336
    s_waitcnt vmcnt(12)
    v_mfma_f32_16x16x32_bf16 v[160:163], v[32:35], v[72:75], v[160:163]
    v_mfma_f32_16x16x32_bf16 v[164:167], v[36:39], v[72:75], v[164:167]
    ds_read_b64_tr_b16 v[60:61], v7 offset:12288
    v_mfma_f32_16x16x32_bf16 v[168:171], v[40:43], v[72:75], v[168:171]
    ds_read_b64_tr_b16 v[62:63], v7 offset:14336
    v_mfma_f32_16x16x32_bf16 v[172:175], v[44:47], v[72:75], v[172:175]
    v_mfma_f32_16x16x32_bf16 v[188:191], v[44:47], v[76:79], v[188:191]
    v_mfma_f32_16x16x32_bf16 v[184:187], v[40:43], v[76:79], v[184:187]
    v_mfma_f32_16x16x32_bf16 v[180:183], v[36:39], v[76:79], v[180:183]
    v_mfma_f32_16x16x32_bf16 v[176:179], v[32:35], v[76:79], v[176:179]
    s_waitcnt vmcnt(10)
    v_mfma_f32_16x16x32_bf16 v[192:195], v[32:35], v[80:83], v[192:195]
    v_mfma_f32_16x16x32_bf16 v[196:199], v[36:39], v[80:83], v[196:199]
    v_mfma_f32_16x16x32_bf16 v[200:203], v[40:43], v[80:83], v[200:203]
    v_mfma_f32_16x16x32_bf16 v[204:207], v[44:47], v[80:83], v[204:207]
    v_mfma_f32_16x16x32_bf16 v[220:223], v[44:47], v[84:87], v[220:223]
    v_mfma_f32_16x16x32_bf16 v[216:219], v[40:43], v[84:87], v[216:219]
    v_mfma_f32_16x16x32_bf16 v[212:215], v[36:39], v[84:87], v[212:215]
    v_mfma_f32_16x16x32_bf16 v[208:211], v[32:35], v[84:87], v[208:211]
    s_waitcnt vmcnt(8)
    v_mfma_f32_16x16x32_bf16 v[224:227], v[32:35], v[88:91], v[224:227]
    v_mfma_f32_16x16x32_bf16 v[228:231], v[36:39], v[88:91], v[228:231]
    v_mfma_f32_16x16x32_bf16 v[232:235], v[40:43], v[88:91], v[232:235]
    v_mfma_f32_16x16x32_bf16 v[236:239], v[44:47], v[88:91], v[236:239]
    v_mfma_f32_16x16x32_bf16 v[252:255], v[44:47], v[92:95], v[252:255]
    v_mfma_f32_16x16x32_bf16 v[248:251], v[40:43], v[92:95], v[248:251]
    v_mfma_f32_16x16x32_bf16 v[244:247], v[36:39], v[92:95], v[244:247]
    v_mfma_f32_16x16x32_bf16 v[240:243], v[32:35], v[92:95], v[240:243]
    s_waitcnt lgkmcnt(0)
    s_waitcnt vmcnt(7)
    s_waitcnt vmcnt(6)
    v_mfma_f32_16x16x32_bf16 v[128:131], v[48:51], v[96:99], v[128:131]
    v_mfma_f32_16x16x32_bf16 v[132:135], v[52:55], v[96:99], v[132:135]
    v_mfma_f32_16x16x32_bf16 v[136:139], v[56:59], v[96:99], v[136:139]
    v_mfma_f32_16x16x32_bf16 v[140:143], v[60:63], v[96:99], v[140:143]
    v_mfma_f32_16x16x32_bf16 v[156:159], v[60:63], v[100:103], v[156:159]
    v_mfma_f32_16x16x32_bf16 v[152:155], v[56:59], v[100:103], v[152:155]
    v_mfma_f32_16x16x32_bf16 v[148:151], v[52:55], v[100:103], v[148:151]
    v_mfma_f32_16x16x32_bf16 v[144:147], v[48:51], v[100:103], v[144:147]
    s_waitcnt vmcnt(4)
    v_mfma_f32_16x16x32_bf16 v[160:163], v[48:51], v[104:107], v[160:163]
    v_mfma_f32_16x16x32_bf16 v[164:167], v[52:55], v[104:107], v[164:167]
    v_mfma_f32_16x16x32_bf16 v[168:171], v[56:59], v[104:107], v[168:171]
    v_mfma_f32_16x16x32_bf16 v[172:175], v[60:63], v[104:107], v[172:175]
    v_mfma_f32_16x16x32_bf16 v[188:191], v[60:63], v[108:111], v[188:191]
    v_mfma_f32_16x16x32_bf16 v[184:187], v[56:59], v[108:111], v[184:187]
    v_mfma_f32_16x16x32_bf16 v[180:183], v[52:55], v[108:111], v[180:183]
    v_mfma_f32_16x16x32_bf16 v[176:179], v[48:51], v[108:111], v[176:179]
    s_waitcnt vmcnt(2)
    v_mfma_f32_16x16x32_bf16 v[192:195], v[48:51], v[112:115], v[192:195]
    v_mfma_f32_16x16x32_bf16 v[196:199], v[52:55], v[112:115], v[196:199]
    v_mfma_f32_16x16x32_bf16 v[200:203], v[56:59], v[112:115], v[200:203]
    v_mfma_f32_16x16x32_bf16 v[204:207], v[60:63], v[112:115], v[204:207]
    v_mfma_f32_16x16x32_bf16 v[220:223], v[60:63], v[116:119], v[220:223]
    v_mfma_f32_16x16x32_bf16 v[216:219], v[56:59], v[116:119], v[216:219]
    v_mfma_f32_16x16x32_bf16 v[212:215], v[52:55], v[116:119], v[212:215]
    v_mfma_f32_16x16x32_bf16 v[208:211], v[48:51], v[116:119], v[208:211]
    s_waitcnt vmcnt(0)
    v_mfma_f32_16x16x32_bf16 v[224:227], v[48:51], v[120:123], v[224:227]
    v_mfma_f32_16x16x32_bf16 v[228:231], v[52:55], v[120:123], v[228:231]
    v_mfma_f32_16x16x32_bf16 v[232:235], v[56:59], v[120:123], v[232:235]
    v_mfma_f32_16x16x32_bf16 v[236:239], v[60:63], v[120:123], v[236:239]
    v_mfma_f32_16x16x32_bf16 v[252:255], v[60:63], v[124:127], v[252:255]
    v_mfma_f32_16x16x32_bf16 v[248:251], v[56:59], v[124:127], v[248:251]
    v_mfma_f32_16x16x32_bf16 v[244:247], v[52:55], v[124:127], v[244:247]
    v_mfma_f32_16x16x32_bf16 v[240:243], v[48:51], v[124:127], v[240:243]
    s_waitcnt vmcnt(0) lgkmcnt(0)
    s_lshl_b32 s28, s3, 14
    v_lshlrev_b32 v2, 4, v0
    v_add_u32 v2, s28, v2
    s_xor_b32 s29, s28, 32768
    v_lshlrev_b32 v3, 4, v0
    v_add_u32 v3, s29, v3
    ds_write_b128 v2, v[224:227] offset:8192
    ds_write_b128 v2, v[228:231] offset:9216
    ds_write_b128 v2, v[232:235] offset:10240
    ds_write_b128 v2, v[236:239] offset:11264
    ds_write_b128 v2, v[240:243] offset:12288
    ds_write_b128 v2, v[244:247] offset:13312
    ds_write_b128 v2, v[248:251] offset:14336
    ds_write_b128 v2, v[252:255] offset:15360
    ds_write_b128 v2, v[192:195] offset:0
    ds_write_b128 v2, v[196:199] offset:1024
    ds_write_b128 v2, v[200:203] offset:2048
    ds_write_b128 v2, v[204:207] offset:3072
    ds_write_b128 v2, v[208:211] offset:4096
    ds_write_b128 v2, v[212:215] offset:5120
    ds_write_b128 v2, v[216:219] offset:6144
    ds_write_b128 v2, v[220:223] offset:7168
    s_waitcnt lgkmcnt(0)
    s_barrier
    ds_read_b128 v[96:99], v3 offset:8192
    ds_read_b128 v[100:103], v3 offset:9216
    ds_read_b128 v[104:107], v3 offset:10240
    ds_read_b128 v[108:111], v3 offset:11264
    ds_read_b128 v[112:115], v3 offset:12288
    ds_read_b128 v[116:119], v3 offset:13312
    ds_read_b128 v[120:123], v3 offset:14336
    ds_read_b128 v[124:127], v3 offset:15360
    ds_read_b128 v[64:67], v3 offset:0
    ds_read_b128 v[68:71], v3 offset:1024
    ds_read_b128 v[72:75], v3 offset:2048
    ds_read_b128 v[76:79], v3 offset:3072
    ds_read_b128 v[80:83], v3 offset:4096
    ds_read_b128 v[84:87], v3 offset:5120
    ds_read_b128 v[88:91], v3 offset:6144
    ds_read_b128 v[92:95], v3 offset:7168
    s_waitcnt lgkmcnt(15)
    v_add_f32 v160, v160, v96
    v_add_f32 v161, v161, v97
    v_add_f32 v162, v162, v98
    v_add_f32 v163, v163, v99
    s_waitcnt lgkmcnt(14)
    v_add_f32 v164, v164, v100
    v_add_f32 v165, v165, v101
    v_add_f32 v166, v166, v102
    v_add_f32 v167, v167, v103
    s_waitcnt lgkmcnt(13)
    v_add_f32 v168, v168, v104
    v_add_f32 v169, v169, v105
    v_add_f32 v170, v170, v106
    v_add_f32 v171, v171, v107
    s_waitcnt lgkmcnt(12)
    v_add_f32 v172, v172, v108
    v_add_f32 v173, v173, v109
    v_add_f32 v174, v174, v110
    v_add_f32 v175, v175, v111
    s_waitcnt lgkmcnt(11)
    v_add_f32 v176, v176, v112
    v_add_f32 v177, v177, v113
    v_add_f32 v178, v178, v114
    v_add_f32 v179, v179, v115
    s_waitcnt lgkmcnt(10)
    v_add_f32 v180, v180, v116
    v_add_f32 v181, v181, v117
    v_add_f32 v182, v182, v118
    v_add_f32 v183, v183, v119
    s_waitcnt lgkmcnt(9)
    v_add_f32 v184, v184, v120
    v_add_f32 v185, v185, v121
    v_add_f32 v186, v186, v122
    v_add_f32 v187, v187, v123
    s_waitcnt lgkmcnt(8)
    v_add_f32 v188, v188, v124
    v_add_f32 v189, v189, v125
    v_add_f32 v190, v190, v126
    v_add_f32 v191, v191, v127
    ds_write_b128 v3, v[160:163] offset:8192
    ds_write_b128 v3, v[164:167] offset:9216
    ds_write_b128 v3, v[168:171] offset:10240
    ds_write_b128 v3, v[172:175] offset:11264
    ds_write_b128 v3, v[176:179] offset:12288
    ds_write_b128 v3, v[180:183] offset:13312
    ds_write_b128 v3, v[184:187] offset:14336
    ds_write_b128 v3, v[188:191] offset:15360
    s_waitcnt lgkmcnt(8)
    v_add_f32 v128, v128, v64
    v_add_f32 v129, v129, v65
    v_add_f32 v130, v130, v66
    v_add_f32 v131, v131, v67
    v_add_f32 v132, v132, v68
    v_add_f32 v133, v133, v69
    v_add_f32 v134, v134, v70
    v_add_f32 v135, v135, v71
    v_add_f32 v136, v136, v72
    v_add_f32 v137, v137, v73
    v_add_f32 v138, v138, v74
    v_add_f32 v139, v139, v75
    v_add_f32 v140, v140, v76
    v_add_f32 v141, v141, v77
    v_add_f32 v142, v142, v78
    v_add_f32 v143, v143, v79
    v_add_f32 v144, v144, v80
    v_add_f32 v145, v145, v81
    v_add_f32 v146, v146, v82
    v_add_f32 v147, v147, v83
    v_add_f32 v148, v148, v84
    v_add_f32 v149, v149, v85
    v_add_f32 v150, v150, v86
    v_add_f32 v151, v151, v87
    v_add_f32 v152, v152, v88
    v_add_f32 v153, v153, v89
    v_add_f32 v154, v154, v90
    v_add_f32 v155, v155, v91
    v_add_f32 v156, v156, v92
    v_add_f32 v157, v157, v93
    v_add_f32 v158, v158, v94
    v_add_f32 v159, v159, v95
    s_xor_b32 s29, s28, 49152
    v_lshlrev_b32 v2, 4, v0
    v_add_u32 v2, s29, v2
    s_waitcnt lgkmcnt(0)
    s_barrier
    ds_read_b128 v[64:67], v2 offset:8192
    ds_read_b128 v[68:71], v2 offset:9216
    ds_read_b128 v[72:75], v2 offset:10240
    ds_read_b128 v[76:79], v2 offset:11264
    ds_read_b128 v[80:83], v2 offset:12288
    ds_read_b128 v[84:87], v2 offset:13312
    ds_read_b128 v[88:91], v2 offset:14336
    ds_read_b128 v[92:95], v2 offset:15360
    v_and_b32 v25, 15, v0
    v_lshlrev_b32 v25, 11, v25
    v_bfe_u32 v26, v0, 4, 1
    v_lshlrev_b32 v26, 5, v26
    v_add_u32 v25, v25, v26
    v_lshrrev_b32 v26, 5, v0
    v_lshlrev_b32 v26, 4, v26
    v_add_u32 v25, v25, v26
    s_lshl_b32 s28, s26, 2
    s_add_u32 s28, s28, s3
    s_lshl_b32 s28, s28, 16
    s_lshl_b32 s29, s27, 7
    s_add_u32 s28, s28, s29
    s_add_u32 s29, s28, 32768
    s_waitcnt lgkmcnt(6)
    v_add_f32 v128, v128, v64
    v_add_f32 v129, v129, v65
    v_add_f32 v130, v130, v66
    v_add_f32 v131, v131, v67
    v_add_f32 v132, v132, v68
    v_add_f32 v133, v133, v69
    v_add_f32 v134, v134, v70
    v_add_f32 v135, v135, v71
    v_cvt_pk_bf16_f32 v32, v128, v129
    v_cvt_pk_bf16_f32 v33, v130, v131
    v_cvt_pk_bf16_f32 v34, v132, v133
    v_cvt_pk_bf16_f32 v35, v134, v135
    s_nop 0
    v_permlane16_swap_b32 v32, v34
    v_permlane16_swap_b32 v33, v35
    buffer_store_dwordx4 v[32:35], v25, s[8:11], s28 offen offset:0 sc1
    s_waitcnt lgkmcnt(4)
    v_add_f32 v136, v136, v72
    v_add_f32 v137, v137, v73
    v_add_f32 v138, v138, v74
    v_add_f32 v139, v139, v75
    v_add_f32 v140, v140, v76
    v_add_f32 v141, v141, v77
    v_add_f32 v142, v142, v78
    v_add_f32 v143, v143, v79
    v_cvt_pk_bf16_f32 v36, v136, v137
    v_cvt_pk_bf16_f32 v37, v138, v139
    v_cvt_pk_bf16_f32 v38, v140, v141
    v_cvt_pk_bf16_f32 v39, v142, v143
    s_nop 0
    v_permlane16_swap_b32 v36, v38
    v_permlane16_swap_b32 v37, v39
    buffer_store_dwordx4 v[36:39], v25, s[8:11], s28 offen offset:64 sc1
    s_waitcnt lgkmcnt(2)
    v_add_f32 v144, v144, v80
    v_add_f32 v145, v145, v81
    v_add_f32 v146, v146, v82
    v_add_f32 v147, v147, v83
    v_add_f32 v148, v148, v84
    v_add_f32 v149, v149, v85
    v_add_f32 v150, v150, v86
    v_add_f32 v151, v151, v87
    v_cvt_pk_bf16_f32 v40, v144, v145
    v_cvt_pk_bf16_f32 v41, v146, v147
    v_cvt_pk_bf16_f32 v42, v148, v149
    v_cvt_pk_bf16_f32 v43, v150, v151
    s_nop 0
    v_permlane16_swap_b32 v40, v42
    v_permlane16_swap_b32 v41, v43
    buffer_store_dwordx4 v[40:43], v25, s[8:11], s29 offen offset:0 sc1
    s_waitcnt lgkmcnt(0)
    v_add_f32 v152, v152, v88
    v_add_f32 v153, v153, v89
    v_add_f32 v154, v154, v90
    v_add_f32 v155, v155, v91
    v_add_f32 v156, v156, v92
    v_add_f32 v157, v157, v93
    v_add_f32 v158, v158, v94
    v_add_f32 v159, v159, v95
    v_cvt_pk_bf16_f32 v44, v152, v153
    v_cvt_pk_bf16_f32 v45, v154, v155
    v_cvt_pk_bf16_f32 v46, v156, v157
    v_cvt_pk_bf16_f32 v47, v158, v159
    s_nop 0
    v_permlane16_swap_b32 v44, v46
    v_permlane16_swap_b32 v45, v47
    buffer_store_dwordx4 v[44:47], v25, s[8:11], s29 offen offset:64 sc1
    s_endpgm
L_roleA:
    s_setprio 3
    s_lshr_b32 s28, s24, 2
    s_lshl_b32 s28, s28, 3
    s_lshr_b32 s29, s25, 2
    s_add_u32 s27, s28, s29
    v_lshrrev_b32 v16, 3, v0
    v_lshlrev_b32 v16, 11, v16
    v_lshrrev_b32 v17, 4, v0
    v_and_b32 v18, 7, v0
    v_xor_b32 v17, v17, v18
    v_xor_b32 v18, 0, v17
    v_lshlrev_b32 v18, 4, v18
    v_add_u32 v18, v16, v18
    v_add_u32 v8, 0, v18
    v_xor_b32 v18, 4, v17
    v_lshlrev_b32 v18, 4, v18
    v_add_u32 v18, v16, v18
    v_add_u32 v9, 15360, v18
    v_xor_b32 v18, 0, v17
    v_lshlrev_b32 v18, 4, v18
    v_add_u32 v18, v16, v18
    v_add_u32 v10, 30720, v18
    v_xor_b32 v18, 4, v17
    v_lshlrev_b32 v18, 4, v18
    v_add_u32 v18, v16, v18
    v_add_u32 v11, 46080, v18
    v_lshrrev_b32 v16, 3, v0
    v_mul_u32_u24 v16, 2048, v16
    v_lshrrev_b32 v17, 4, v0
    v_and_b32 v17, 1, v17
    v_lshlrev_b32 v17, 2, v17
    v_and_b32 v18, 7, v0
    v_xor_b32 v17, v17, v18
    v_lshlrev_b32 v17, 4, v17
    v_add_u32 v12, v16, v17
    v_add_u32 v13, 15360, v12
    s_lshl_b32 s28, s26, 2
    s_add_u32 s28, s28, s3
    s_lshl_b32 s34, s28, 16
    s_lshl_b32 s36, s3, 12
    s_add_u32 s36, s36, 24576
    s_lshl_b32 s35, s3, 15
    s_lshl_b32 s28, s27, 7
    s_add_u32 s35, s35, s28
    s_lshl_b32 s37, s3, 11
    s_waitcnt lgkmcnt(0)
    s_and_b32 s28, s25, 3
    s_lshl_b32 s28, s28, 2
    s_lshr_b32 s29, s25, 2
    s_lshl_b32 s29, s29, 1
    s_add_u32 s61, s28, s29
    s_add_u32 s61, s61, 1
    s_cmp_lt_u32 s25, 28
    s_cbranch_scc1 L_kvf_19
    s_cmp_lg_u32 s3, 0
    s_cbranch_scc1 L_kvf_19_b
    v_mov_b32 v247, 0
    s_bfm_b64 exec, 1, 0
    s_mov_b32 s39, 200000
L_poll_20:
    buffer_load_dword v246, v247, s[20:23], 0 offen sc1
    s_waitcnt vmcnt(0)
    v_cmp_ne_u32 vcc, 0, v246
    s_nop 3
    s_cmp_eq_u64 vcc, exec
    s_cbranch_scc1 L_polld_21
    s_sleep 4
    s_sub_u32 s39, s39, 1
    s_cmp_lg_u32 s39, 0
    s_cbranch_scc1 L_poll_20
L_polld_21:
    s_mov_b64 exec, -1
    s_bfm_b64 exec, 32, 0
    s_mov_b32 s39, 200000
L_poll_22:
    buffer_load_dword v246, v15, s[4:7], 0 offen sc1
    s_waitcnt vmcnt(0)
    v_cmp_ne_u32 vcc, 0, v246
    s_nop 3
    s_cmp_eq_u64 vcc, exec
    s_cbranch_scc1 L_polld_23
    s_sleep 4
    s_sub_u32 s39, s39, 1
    s_cmp_lg_u32 s39, 0
    s_cbranch_scc1 L_poll_22
L_polld_23:
    s_mov_b64 exec, -1
L_kvf_19_b:
    s_barrier
L_kvf_19:
    s_add_u32 m0, s36, 0
    s_add_u32 s30, s34, 0
    buffer_load_dwordx4 v8, s[8:11], s30 offen offset:0 lds
    buffer_load_dwordx4 v9, s[8:11], s30 offen offset:1024 lds
    buffer_load_dwordx4 v10, s[8:11], s30 offen offset:2048 lds
    buffer_load_dwordx4 v11, s[8:11], s30 offen offset:3072 lds
    s_add_u32 m0, s37, 0
    s_add_u32 s30, s35, 0
    buffer_load_dwordx4 v12, s[12:15], s30 offen offset:0 lds
    buffer_load_dwordx4 v13, s[12:15], s30 offen offset:1024 lds
    s_add_u32 m0, s36, 16384
    s_add_u32 s30, s34, 128
    buffer_load_dwordx4 v8, s[8:11], s30 offen offset:0 lds
    buffer_load_dwordx4 v9, s[8:11], s30 offen offset:1024 lds
    buffer_load_dwordx4 v10, s[8:11], s30 offen offset:2048 lds
    buffer_load_dwordx4 v11, s[8:11], s30 offen offset:3072 lds
    s_add_u32 m0, s37, 8192
    s_add_u32 s30, s35, 131072
    buffer_load_dwordx4 v12, s[12:15], s30 offen offset:0 lds
    buffer_load_dwordx4 v13, s[12:15], s30 offen offset:1024 lds
    s_lshr_b32 s28, s3, 1
    s_lshl_b32 s28, s28, 13
    s_add_u32 s28, s28, 24576
    v_and_b32 v16, 31, v0
    v_lshrrev_b32 v17, 1, v16
    v_and_b32 v17, 7, v17
    v_lshrrev_b32 v18, 5, v0
    v_xor_b32 v17, v17, v18
    v_lshlrev_b32 v16, 7, v16
    v_add_u32 v16, s28, v16
    v_xor_b32 v18, 0, v17
    v_lshlrev_b32 v18, 4, v18
    v_add_u32 v2, v16, v18
    v_xor_b32 v18, 2, v17
    v_lshlrev_b32 v18, 4, v18
    v_add_u32 v3, v16, v18
    v_xor_b32 v18, 4, v17
    v_lshlrev_b32 v18, 4, v18
    v_add_u32 v4, v16, v18
    v_xor_b32 v18, 6, v17
    v_lshlrev_b32 v18, 4, v18
    v_add_u32 v5, v16, v18
    s_and_b32 s29, s3, 1
    v_lshrrev_b32 v16, 5, v0
    v_lshlrev_b32 v16, 3, v16
    v_bfe_u32 v17, v0, 2, 2
    v_add_u32 v16, v16, v17
    v_lshlrev_b32 v16, 7, v16
    v_lshrrev_b32 v17, 1, v17
    v_xor_b32 v17, s29, v17
    v_lshlrev_b32 v17, 6, v17
    v_add_u32 v16, v16, v17
    v_bfe_u32 v17, v0, 4, 1
    v_lshlrev_b32 v17, 5, v17
    v_add_u32 v16, v16, v17
    v_and_b32 v17, 3, v0
    v_lshlrev_b32 v17, 3, v17
    v_add_u32 v6, v16, v17
    v_mov_b32 v128, 0
    v_mov_b32 v129, 0
    v_mov_b32 v130, 0
    v_mov_b32 v131, 0
    v_mov_b32 v132, 0
    v_mov_b32 v133, 0
    v_mov_b32 v134, 0
    v_mov_b32 v135, 0
    v_mov_b32 v136, 0
    v_mov_b32 v137, 0
    v_mov_b32 v138, 0
    v_mov_b32 v139, 0
    v_mov_b32 v140, 0
    v_mov_b32 v141, 0
    v_mov_b32 v142, 0
    v_mov_b32 v143, 0
    v_mov_b32 v144, 0
    v_mov_b32 v145, 0
    v_mov_b32 v146, 0
    v_mov_b32 v147, 0
    v_mov_b32 v148, 0
    v_mov_b32 v149, 0
    v_mov_b32 v150, 0
    v_mov_b32 v151, 0
    v_mov_b32 v152, 0
    v_mov_b32 v153, 0
    v_mov_b32 v154, 0
    v_mov_b32 v155, 0
    v_mov_b32 v156, 0
    v_mov_b32 v157, 0
    v_mov_b32 v158, 0
    v_mov_b32 v159, 0
    s_waitcnt vmcnt(6)
    s_cmp_lg_u32 s68, 0
    s_cbranch_scc1 L_nordy_24
    s_waitcnt vmcnt(0)
    v_mov_b32 v24, 1
    v_mov_b32 v25, 0
    s_mov_b64 exec, 1
    buffer_store_dword v24, v25, s[20:23], 0 offen sc1
    s_mov_b64 exec, -1
L_nordy_24:
    s_barrier
    s_add_u32 m0, s36, 32768
    s_add_u32 s30, s34, 256
    buffer_load_dwordx4 v8, s[8:11], s30 offen offset:0 lds
    buffer_load_dwordx4 v9, s[8:11], s30 offen offset:1024 lds
    buffer_load_dwordx4 v10, s[8:11], s30 offen offset:2048 lds
    buffer_load_dwordx4 v11, s[8:11], s30 offen offset:3072 lds
    s_add_u32 m0, s37, 16384
    s_add_u32 s30, s35, 262144
    buffer_load_dwordx4 v12, s[12:15], s30 offen offset:0 lds
    buffer_load_dwordx4 v13, s[12:15], s30 offen offset:1024 lds
    ds_read_b64_tr_b16 v[80:81], v6 offset:0
    ds_read_b64_tr_b16 v[82:83], v6 offset:512
    ds_read_b128 v[64:67], v2 offset:0
    ds_read_b128 v[68:71], v2 offset:4096
    s_waitcnt lgkmcnt(0)
    ds_read_b64_tr_b16 v[84:85], v6 offset:2048
    ds_read_b64_tr_b16 v[86:87], v6 offset:2560
    ds_read_b128 v[72:75], v3 offset:0
    ds_read_b128 v[76:79], v3 offset:4096
    v_mfma_f32_32x32x16_bf16 v[128:143], v[80:83], v[64:67], v[128:143]
    v_mfma_f32_32x32x16_bf16 v[144:159], v[80:83], v[68:71], v[144:159]
    s_waitcnt lgkmcnt(0)
    ds_read_b64_tr_b16 v[80:81], v6 offset:4096
    ds_read_b64_tr_b16 v[82:83], v6 offset:4608
    ds_read_b128 v[64:67], v4 offset:0
    ds_read_b128 v[68:71], v4 offset:4096
    v_mfma_f32_32x32x16_bf16 v[128:143], v[84:87], v[72:75], v[128:143]
    v_mfma_f32_32x32x16_bf16 v[144:159], v[84:87], v[76:79], v[144:159]
    s_waitcnt lgkmcnt(0)
    ds_read_b64_tr_b16 v[84:85], v6 offset:6144
    ds_read_b64_tr_b16 v[86:87], v6 offset:6656
    ds_read_b128 v[72:75], v5 offset:0
    ds_read_b128 v[76:79], v5 offset:4096
    v_mfma_f32_32x32x16_bf16 v[128:143], v[80:83], v[64:67], v[128:143]
    v_mfma_f32_32x32x16_bf16 v[144:159], v[80:83], v[68:71], v[144:159]
    s_waitcnt lgkmcnt(0)
    s_waitcnt vmcnt(6)
    s_barrier
    ds_read_b64_tr_b16 v[80:81], v6 offset:8192
    ds_read_b64_tr_b16 v[82:83], v6 offset:8704
    ds_read_b128 v[64:67], v2 offset:16384
    ds_read_b128 v[68:71], v2 offset:20480
    v_mfma_f32_32x32x16_bf16 v[128:143], v[84:87], v[72:75], v[128:143]
    v_mfma_f32_32x32x16_bf16 v[144:159], v[84:87], v[76:79], v[144:159]
    s_add_u32 m0, s36, 0
    s_add_u32 s30, s34, 384
    buffer_load_dwordx4 v8, s[8:11], s30 offen offset:0 lds
    buffer_load_dwordx4 v9, s[8:11], s30 offen offset:1024 lds
    buffer_load_dwordx4 v10, s[8:11], s30 offen offset:2048 lds
    buffer_load_dwordx4 v11, s[8:11], s30 offen offset:3072 lds
    s_add_u32 m0, s37, 0
    s_add_u32 s30, s35, 393216
    buffer_load_dwordx4 v12, s[12:15], s30 offen offset:0 lds
    buffer_load_dwordx4 v13, s[12:15], s30 offen offset:1024 lds
    s_waitcnt lgkmcnt(0)
    ds_read_b64_tr_b16 v[84:85], v6 offset:10240
    ds_read_b64_tr_b16 v[86:87], v6 offset:10752
    ds_read_b128 v[72:75], v3 offset:16384
    ds_read_b128 v[76:79], v3 offset:20480
    v_mfma_f32_32x32x16_bf16 v[128:143], v[80:83], v[64:67], v[128:143]
    v_mfma_f32_32x32x16_bf16 v[144:159], v[80:83], v[68:71], v[144:159]
    s_waitcnt lgkmcnt(0)
    ds_read_b64_tr_b16 v[80:81], v6 offset:12288
    ds_read_b64_tr_b16 v[82:83], v6 offset:12800
    ds_read_b128 v[64:67], v4 offset:16384
    ds_read_b128 v[68:71], v4 offset:20480
    v_mfma_f32_32x32x16_bf16 v[128:143], v[84:87], v[72:75], v[128:143]
    v_mfma_f32_32x32x16_bf16 v[144:159], v[84:87], v[76:79], v[144:159]
    s_waitcnt lgkmcnt(0)
    ds_read_b64_tr_b16 v[84:85], v6 offset:14336
    ds_read_b64_tr_b16 v[86:87], v6 offset:14848
    ds_read_b128 v[72:75], v5 offset:16384
    ds_read_b128 v[76:79], v5 offset:20480
    v_mfma_f32_32x32x16_bf16 v[128:143], v[80:83], v[64:67], v[128:143]
    v_mfma_f32_32x32x16_bf16 v[144:159], v[80:83], v[68:71], v[144:159]
    s_waitcnt lgkmcnt(0)
    s_waitcnt vmcnt(6)
    s_barrier
    ds_read_b64_tr_b16 v[80:81], v6 offset:16384
    ds_read_b64_tr_b16 v[82:83], v6 offset:16896
    ds_read_b128 v[64:67], v2 offset:32768
    ds_read_b128 v[68:71], v2 offset:36864
    v_mfma_f32_32x32x16_bf16 v[128:143], v[84:87], v[72:75], v[128:143]
    v_mfma_f32_32x32x16_bf16 v[144:159], v[84:87], v[76:79], v[144:159]
    s_add_u32 m0, s36, 16384
    s_add_u32 s30, s34, 512
    buffer_load_dwordx4 v8, s[8:11], s30 offen offset:0 lds
    buffer_load_dwordx4 v9, s[8:11], s30 offen offset:1024 lds
    buffer_load_dwordx4 v10, s[8:11], s30 offen offset:2048 lds
    buffer_load_dwordx4 v11, s[8:11], s30 offen offset:3072 lds
    s_add_u32 m0, s37, 8192
    s_add_u32 s30, s35, 524288
    buffer_load_dwordx4 v12, s[12:15], s30 offen offset:0 lds
    buffer_load_dwordx4 v13, s[12:15], s30 offen offset:1024 lds
    s_waitcnt lgkmcnt(0)
    ds_read_b64_tr_b16 v[84:85], v6 offset:18432
    ds_read_b64_tr_b16 v[86:87], v6 offset:18944
    ds_read_b128 v[72:75], v3 offset:32768
    ds_read_b128 v[76:79], v3 offset:36864
    v_mfma_f32_32x32x16_bf16 v[128:143], v[80:83], v[64:67], v[128:143]
    v_mfma_f32_32x32x16_bf16 v[144:159], v[80:83], v[68:71], v[144:159]
    s_waitcnt lgkmcnt(0)
    ds_read_b64_tr_b16 v[80:81], v6 offset:20480
    ds_read_b64_tr_b16 v[82:83], v6 offset:20992
    ds_read_b128 v[64:67], v4 offset:32768
    ds_read_b128 v[68:71], v4 offset:36864
    v_mfma_f32_32x32x16_bf16 v[128:143], v[84:87], v[72:75], v[128:143]
    v_mfma_f32_32x32x16_bf16 v[144:159], v[84:87], v[76:79], v[144:159]
    s_waitcnt lgkmcnt(0)
    ds_read_b64_tr_b16 v[84:85], v6 offset:22528
    ds_read_b64_tr_b16 v[86:87], v6 offset:23040
    ds_read_b128 v[72:75], v5 offset:32768
    ds_read_b128 v[76:79], v5 offset:36864
    v_mfma_f32_32x32x16_bf16 v[128:143], v[80:83], v[64:67], v[128:143]
    v_mfma_f32_32x32x16_bf16 v[144:159], v[80:83], v[68:71], v[144:159]
    s_waitcnt lgkmcnt(0)
    s_waitcnt vmcnt(6)
    s_barrier
    ds_read_b64_tr_b16 v[80:81], v6 offset:0
    ds_read_b64_tr_b16 v[82:83], v6 offset:512
    ds_read_b128 v[64:67], v2 offset:0
    ds_read_b128 v[68:71], v2 offset:4096
    v_mfma_f32_32x32x16_bf16 v[128:143], v[84:87], v[72:75], v[128:143]
    v_mfma_f32_32x32x16_bf16 v[144:159], v[84:87], v[76:79], v[144:159]
    s_add_u32 m0, s36, 32768
    s_add_u32 s30, s34, 640
    buffer_load_dwordx4 v8, s[8:11], s30 offen offset:0 lds
    buffer_load_dwordx4 v9, s[8:11], s30 offen offset:1024 lds
    buffer_load_dwordx4 v10, s[8:11], s30 offen offset:2048 lds
    buffer_load_dwordx4 v11, s[8:11], s30 offen offset:3072 lds
    s_add_u32 m0, s37, 16384
    s_add_u32 s30, s35, 655360
    buffer_load_dwordx4 v12, s[12:15], s30 offen offset:0 lds
    buffer_load_dwordx4 v13, s[12:15], s30 offen offset:1024 lds
    s_waitcnt lgkmcnt(0)
    ds_read_b64_tr_b16 v[84:85], v6 offset:2048
    ds_read_b64_tr_b16 v[86:87], v6 offset:2560
    ds_read_b128 v[72:75], v3 offset:0
    ds_read_b128 v[76:79], v3 offset:4096
    v_mfma_f32_32x32x16_bf16 v[128:143], v[80:83], v[64:67], v[128:143]
    v_mfma_f32_32x32x16_bf16 v[144:159], v[80:83], v[68:71], v[144:159]
    s_waitcnt lgkmcnt(0)
    ds_read_b64_tr_b16 v[80:81], v6 offset:4096
    ds_read_b64_tr_b16 v[82:83], v6 offset:4608
    ds_read_b128 v[64:67], v4 offset:0
    ds_read_b128 v[68:71], v4 offset:4096
    v_mfma_f32_32x32x16_bf16 v[128:143], v[84:87], v[72:75], v[128:143]
    v_mfma_f32_32x32x16_bf16 v[144:159], v[84:87], v[76:79], v[144:159]
    s_waitcnt lgkmcnt(0)
    ds_read_b64_tr_b16 v[84:85], v6 offset:6144
    ds_read_b64_tr_b16 v[86:87], v6 offset:6656
    ds_read_b128 v[72:75], v5 offset:0
    ds_read_b128 v[76:79], v5 offset:4096
    v_mfma_f32_32x32x16_bf16 v[128:143], v[80:83], v[64:67], v[128:143]
    v_mfma_f32_32x32x16_bf16 v[144:159], v[80:83], v[68:71], v[144:159]
    s_waitcnt lgkmcnt(0)
    s_waitcnt vmcnt(6)
    s_barrier
    ds_read_b64_tr_b16 v[80:81], v6 offset:8192
    ds_read_b64_tr_b16 v[82:83], v6 offset:8704
    ds_read_b128 v[64:67], v2 offset:16384
    ds_read_b128 v[68:71], v2 offset:20480
    v_mfma_f32_32x32x16_bf16 v[128:143], v[84:87], v[72:75], v[128:143]
    v_mfma_f32_32x32x16_bf16 v[144:159], v[84:87], v[76:79], v[144:159]
    s_add_u32 m0, s36, 0
    s_add_u32 s30, s34, 768
    buffer_load_dwordx4 v8, s[8:11], s30 offen offset:0 lds
    buffer_load_dwordx4 v9, s[8:11], s30 offen offset:1024 lds
    buffer_load_dwordx4 v10, s[8:11], s30 offen offset:2048 lds
    buffer_load_dwordx4 v11, s[8:11], s30 offen offset:3072 lds
    s_add_u32 m0, s37, 0
    s_add_u32 s30, s35, 786432
    buffer_load_dwordx4 v12, s[12:15], s30 offen offset:0 lds
    buffer_load_dwordx4 v13, s[12:15], s30 offen offset:1024 lds
    s_waitcnt lgkmcnt(0)
    ds_read_b64_tr_b16 v[84:85], v6 offset:10240
    ds_read_b64_tr_b16 v[86:87], v6 offset:10752
    ds_read_b128 v[72:75], v3 offset:16384
    ds_read_b128 v[76:79], v3 offset:20480
    v_mfma_f32_32x32x16_bf16 v[128:143], v[80:83], v[64:67], v[128:143]
    v_mfma_f32_32x32x16_bf16 v[144:159], v[80:83], v[68:71], v[144:159]
    s_waitcnt lgkmcnt(0)
    ds_read_b64_tr_b16 v[80:81], v6 offset:12288
    ds_read_b64_tr_b16 v[82:83], v6 offset:12800
    ds_read_b128 v[64:67], v4 offset:16384
    ds_read_b128 v[68:71], v4 offset:20480
    v_mfma_f32_32x32x16_bf16 v[128:143], v[84:87], v[72:75], v[128:143]
    v_mfma_f32_32x32x16_bf16 v[144:159], v[84:87], v[76:79], v[144:159]
    s_waitcnt lgkmcnt(0)
    ds_read_b64_tr_b16 v[84:85], v6 offset:14336
    ds_read_b64_tr_b16 v[86:87], v6 offset:14848
    ds_read_b128 v[72:75], v5 offset:16384
    ds_read_b128 v[76:79], v5 offset:20480
    v_mfma_f32_32x32x16_bf16 v[128:143], v[80:83], v[64:67], v[128:143]
    v_mfma_f32_32x32x16_bf16 v[144:159], v[80:83], v[68:71], v[144:159]
    s_waitcnt lgkmcnt(0)
    s_waitcnt vmcnt(6)
    s_barrier
    ds_read_b64_tr_b16 v[80:81], v6 offset:16384
    ds_read_b64_tr_b16 v[82:83], v6 offset:16896
    ds_read_b128 v[64:67], v2 offset:32768
    ds_read_b128 v[68:71], v2 offset:36864
    v_mfma_f32_32x32x16_bf16 v[128:143], v[84:87], v[72:75], v[128:143]
    v_mfma_f32_32x32x16_bf16 v[144:159], v[84:87], v[76:79], v[144:159]
    s_add_u32 m0, s36, 16384
    s_add_u32 s30, s34, 896
    buffer_load_dwordx4 v8, s[8:11], s30 offen offset:0 lds
    buffer_load_dwordx4 v9, s[8:11], s30 offen offset:1024 lds
    buffer_load_dwordx4 v10, s[8:11], s30 offen offset:2048 lds
    buffer_load_dwordx4 v11, s[8:11], s30 offen offset:3072 lds
    s_add_u32 m0, s37, 8192
    s_add_u32 s30, s35, 917504
    buffer_load_dwordx4 v12, s[12:15], s30 offen offset:0 lds
    buffer_load_dwordx4 v13, s[12:15], s30 offen offset:1024 lds
    s_waitcnt lgkmcnt(0)
    ds_read_b64_tr_b16 v[84:85], v6 offset:18432
    ds_read_b64_tr_b16 v[86:87], v6 offset:18944
    ds_read_b128 v[72:75], v3 offset:32768
    ds_read_b128 v[76:79], v3 offset:36864
    v_mfma_f32_32x32x16_bf16 v[128:143], v[80:83], v[64:67], v[128:143]
    v_mfma_f32_32x32x16_bf16 v[144:159], v[80:83], v[68:71], v[144:159]
    s_waitcnt lgkmcnt(0)
    ds_read_b64_tr_b16 v[80:81], v6 offset:20480
    ds_read_b64_tr_b16 v[82:83], v6 offset:20992
    ds_read_b128 v[64:67], v4 offset:32768
    ds_read_b128 v[68:71], v4 offset:36864
    v_mfma_f32_32x32x16_bf16 v[128:143], v[84:87], v[72:75], v[128:143]
    v_mfma_f32_32x32x16_bf16 v[144:159], v[84:87], v[76:79], v[144:159]
    s_waitcnt lgkmcnt(0)
    ds_read_b64_tr_b16 v[84:85], v6 offset:22528
    ds_read_b64_tr_b16 v[86:87], v6 offset:23040
    ds_read_b128 v[72:75], v5 offset:32768
    ds_read_b128 v[76:79], v5 offset:36864
    v_mfma_f32_32x32x16_bf16 v[128:143], v[80:83], v[64:67], v[128:143]
    v_mfma_f32_32x32x16_bf16 v[144:159], v[80:83], v[68:71], v[144:159]
    s_waitcnt lgkmcnt(0)
    s_waitcnt vmcnt(6)
    s_barrier
    ds_read_b64_tr_b16 v[80:81], v6 offset:0
    ds_read_b64_tr_b16 v[82:83], v6 offset:512
    ds_read_b128 v[64:67], v2 offset:0
    ds_read_b128 v[68:71], v2 offset:4096
    v_mfma_f32_32x32x16_bf16 v[128:143], v[84:87], v[72:75], v[128:143]
    v_mfma_f32_32x32x16_bf16 v[144:159], v[84:87], v[76:79], v[144:159]
    s_add_u32 m0, s36, 32768
    s_add_u32 s30, s34, 1024
    buffer_load_dwordx4 v8, s[8:11], s30 offen offset:0 lds
    buffer_load_dwordx4 v9, s[8:11], s30 offen offset:1024 lds
    buffer_load_dwordx4 v10, s[8:11], s30 offen offset:2048 lds
    buffer_load_dwordx4 v11, s[8:11], s30 offen offset:3072 lds
    s_add_u32 m0, s37, 16384
    s_add_u32 s30, s35, 1048576
    buffer_load_dwordx4 v12, s[12:15], s30 offen offset:0 lds
    buffer_load_dwordx4 v13, s[12:15], s30 offen offset:1024 lds
    s_waitcnt lgkmcnt(0)
    ds_read_b64_tr_b16 v[84:85], v6 offset:2048
    ds_read_b64_tr_b16 v[86:87], v6 offset:2560
    ds_read_b128 v[72:75], v3 offset:0
    ds_read_b128 v[76:79], v3 offset:4096
    v_mfma_f32_32x32x16_bf16 v[128:143], v[80:83], v[64:67], v[128:143]
    v_mfma_f32_32x32x16_bf16 v[144:159], v[80:83], v[68:71], v[144:159]
    s_waitcnt lgkmcnt(0)
    ds_read_b64_tr_b16 v[80:81], v6 offset:4096
    ds_read_b64_tr_b16 v[82:83], v6 offset:4608
    ds_read_b128 v[64:67], v4 offset:0
    ds_read_b128 v[68:71], v4 offset:4096
    v_mfma_f32_32x32x16_bf16 v[128:143], v[84:87], v[72:75], v[128:143]
    v_mfma_f32_32x32x16_bf16 v[144:159], v[84:87], v[76:79], v[144:159]
    s_waitcnt lgkmcnt(0)
    ds_read_b64_tr_b16 v[84:85], v6 offset:6144
    ds_read_b64_tr_b16 v[86:87], v6 offset:6656
    ds_read_b128 v[72:75], v5 offset:0
    ds_read_b128 v[76:79], v5 offset:4096
    v_mfma_f32_32x32x16_bf16 v[128:143], v[80:83], v[64:67], v[128:143]
    v_mfma_f32_32x32x16_bf16 v[144:159], v[80:83], v[68:71], v[144:159]
    s_waitcnt lgkmcnt(0)
    s_waitcnt vmcnt(6)
    s_barrier
    ds_read_b64_tr_b16 v[80:81], v6 offset:8192
    ds_read_b64_tr_b16 v[82:83], v6 offset:8704
    ds_read_b128 v[64:67], v2 offset:16384
    ds_read_b128 v[68:71], v2 offset:20480
    v_mfma_f32_32x32x16_bf16 v[128:143], v[84:87], v[72:75], v[128:143]
    v_mfma_f32_32x32x16_bf16 v[144:159], v[84:87], v[76:79], v[144:159]
    s_add_u32 m0, s36, 0
    s_add_u32 s30, s34, 1152
    buffer_load_dwordx4 v8, s[8:11], s30 offen offset:0 lds
    buffer_load_dwordx4 v9, s[8:11], s30 offen offset:1024 lds
    buffer_load_dwordx4 v10, s[8:11], s30 offen offset:2048 lds
    buffer_load_dwordx4 v11, s[8:11], s30 offen offset:3072 lds
    s_add_u32 m0, s37, 0
    s_add_u32 s30, s35, 1179648
    buffer_load_dwordx4 v12, s[12:15], s30 offen offset:0 lds
    buffer_load_dwordx4 v13, s[12:15], s30 offen offset:1024 lds
    s_waitcnt lgkmcnt(0)
    ds_read_b64_tr_b16 v[84:85], v6 offset:10240
    ds_read_b64_tr_b16 v[86:87], v6 offset:10752
    ds_read_b128 v[72:75], v3 offset:16384
    ds_read_b128 v[76:79], v3 offset:20480
    v_mfma_f32_32x32x16_bf16 v[128:143], v[80:83], v[64:67], v[128:143]
    v_mfma_f32_32x32x16_bf16 v[144:159], v[80:83], v[68:71], v[144:159]
    s_waitcnt lgkmcnt(0)
    ds_read_b64_tr_b16 v[80:81], v6 offset:12288
    ds_read_b64_tr_b16 v[82:83], v6 offset:12800
    ds_read_b128 v[64:67], v4 offset:16384
    ds_read_b128 v[68:71], v4 offset:20480
    v_mfma_f32_32x32x16_bf16 v[128:143], v[84:87], v[72:75], v[128:143]
    v_mfma_f32_32x32x16_bf16 v[144:159], v[84:87], v[76:79], v[144:159]
    s_waitcnt lgkmcnt(0)
    ds_read_b64_tr_b16 v[84:85], v6 offset:14336
    ds_read_b64_tr_b16 v[86:87], v6 offset:14848
    ds_read_b128 v[72:75], v5 offset:16384
    ds_read_b128 v[76:79], v5 offset:20480
    v_mfma_f32_32x32x16_bf16 v[128:143], v[80:83], v[64:67], v[128:143]
    v_mfma_f32_32x32x16_bf16 v[144:159], v[80:83], v[68:71], v[144:159]
    s_waitcnt lgkmcnt(0)
    s_waitcnt vmcnt(6)
    s_barrier
    ds_read_b64_tr_b16 v[80:81], v6 offset:16384
    ds_read_b64_tr_b16 v[82:83], v6 offset:16896
    ds_read_b128 v[64:67], v2 offset:32768
    ds_read_b128 v[68:71], v2 offset:36864
    v_mfma_f32_32x32x16_bf16 v[128:143], v[84:87], v[72:75], v[128:143]
    v_mfma_f32_32x32x16_bf16 v[144:159], v[84:87], v[76:79], v[144:159]
    s_add_u32 m0, s36, 16384
    s_add_u32 s30, s34, 1280
    buffer_load_dwordx4 v8, s[8:11], s30 offen offset:0 lds
    buffer_load_dwordx4 v9, s[8:11], s30 offen offset:1024 lds
    buffer_load_dwordx4 v10, s[8:11], s30 offen offset:2048 lds
    buffer_load_dwordx4 v11, s[8:11], s30 offen offset:3072 lds
    s_add_u32 m0, s37, 8192
    s_add_u32 s30, s35, 1310720
    buffer_load_dwordx4 v12, s[12:15], s30 offen offset:0 lds
    buffer_load_dwordx4 v13, s[12:15], s30 offen offset:1024 lds
    s_waitcnt lgkmcnt(0)
    ds_read_b64_tr_b16 v[84:85], v6 offset:18432
    ds_read_b64_tr_b16 v[86:87], v6 offset:18944
    ds_read_b128 v[72:75], v3 offset:32768
    ds_read_b128 v[76:79], v3 offset:36864
    v_mfma_f32_32x32x16_bf16 v[128:143], v[80:83], v[64:67], v[128:143]
    v_mfma_f32_32x32x16_bf16 v[144:159], v[80:83], v[68:71], v[144:159]
    s_waitcnt lgkmcnt(0)
    ds_read_b64_tr_b16 v[80:81], v6 offset:20480
    ds_read_b64_tr_b16 v[82:83], v6 offset:20992
    ds_read_b128 v[64:67], v4 offset:32768
    ds_read_b128 v[68:71], v4 offset:36864
    v_mfma_f32_32x32x16_bf16 v[128:143], v[84:87], v[72:75], v[128:143]
    v_mfma_f32_32x32x16_bf16 v[144:159], v[84:87], v[76:79], v[144:159]
    s_waitcnt lgkmcnt(0)
    ds_read_b64_tr_b16 v[84:85], v6 offset:22528
    ds_read_b64_tr_b16 v[86:87], v6 offset:23040
    ds_read_b128 v[72:75], v5 offset:32768
    ds_read_b128 v[76:79], v5 offset:36864
    v_mfma_f32_32x32x16_bf16 v[128:143], v[80:83], v[64:67], v[128:143]
    v_mfma_f32_32x32x16_bf16 v[144:159], v[80:83], v[68:71], v[144:159]
    s_waitcnt lgkmcnt(0)
    s_waitcnt vmcnt(6)
    s_barrier
    ds_read_b64_tr_b16 v[80:81], v6 offset:0
    ds_read_b64_tr_b16 v[82:83], v6 offset:512
    ds_read_b128 v[64:67], v2 offset:0
    ds_read_b128 v[68:71], v2 offset:4096
    v_mfma_f32_32x32x16_bf16 v[128:143], v[84:87], v[72:75], v[128:143]
    v_mfma_f32_32x32x16_bf16 v[144:159], v[84:87], v[76:79], v[144:159]
    s_add_u32 m0, s36, 32768
    s_add_u32 s30, s34, 1408
    buffer_load_dwordx4 v8, s[8:11], s30 offen offset:0 lds
    buffer_load_dwordx4 v9, s[8:11], s30 offen offset:1024 lds
    buffer_load_dwordx4 v10, s[8:11], s30 offen offset:2048 lds
    buffer_load_dwordx4 v11, s[8:11], s30 offen offset:3072 lds
    s_add_u32 m0, s37, 16384
    s_add_u32 s30, s35, 1441792
    buffer_load_dwordx4 v12, s[12:15], s30 offen offset:0 lds
    buffer_load_dwordx4 v13, s[12:15], s30 offen offset:1024 lds
    s_waitcnt lgkmcnt(0)
    ds_read_b64_tr_b16 v[84:85], v6 offset:2048
    ds_read_b64_tr_b16 v[86:87], v6 offset:2560
    ds_read_b128 v[72:75], v3 offset:0
    ds_read_b128 v[76:79], v3 offset:4096
    v_mfma_f32_32x32x16_bf16 v[128:143], v[80:83], v[64:67], v[128:143]
    v_mfma_f32_32x32x16_bf16 v[144:159], v[80:83], v[68:71], v[144:159]
    s_waitcnt lgkmcnt(0)
    ds_read_b64_tr_b16 v[80:81], v6 offset:4096
    ds_read_b64_tr_b16 v[82:83], v6 offset:4608
    ds_read_b128 v[64:67], v4 offset:0
    ds_read_b128 v[68:71], v4 offset:4096
    v_mfma_f32_32x32x16_bf16 v[128:143], v[84:87], v[72:75], v[128:143]
    v_mfma_f32_32x32x16_bf16 v[144:159], v[84:87], v[76:79], v[144:159]
    s_waitcnt lgkmcnt(0)
    ds_read_b64_tr_b16 v[84:85], v6 offset:6144
    ds_read_b64_tr_b16 v[86:87], v6 offset:6656
    ds_read_b128 v[72:75], v5 offset:0
    ds_read_b128 v[76:79], v5 offset:4096
    v_mfma_f32_32x32x16_bf16 v[128:143], v[80:83], v[64:67], v[128:143]
    v_mfma_f32_32x32x16_bf16 v[144:159], v[80:83], v[68:71], v[144:159]
    s_waitcnt lgkmcnt(0)
    s_waitcnt vmcnt(6)
    s_barrier
    ds_read_b64_tr_b16 v[80:81], v6 offset:8192
    ds_read_b64_tr_b16 v[82:83], v6 offset:8704
    ds_read_b128 v[64:67], v2 offset:16384
    ds_read_b128 v[68:71], v2 offset:20480
    v_mfma_f32_32x32x16_bf16 v[128:143], v[84:87], v[72:75], v[128:143]
    v_mfma_f32_32x32x16_bf16 v[144:159], v[84:87], v[76:79], v[144:159]
    s_add_u32 m0, s36, 0
    s_add_u32 s30, s34, 1536
    buffer_load_dwordx4 v8, s[8:11], s30 offen offset:0 lds
    buffer_load_dwordx4 v9, s[8:11], s30 offen offset:1024 lds
    buffer_load_dwordx4 v10, s[8:11], s30 offen offset:2048 lds
    buffer_load_dwordx4 v11, s[8:11], s30 offen offset:3072 lds
    s_add_u32 m0, s37, 0
    s_add_u32 s30, s35, 1572864
    buffer_load_dwordx4 v12, s[12:15], s30 offen offset:0 lds
    buffer_load_dwordx4 v13, s[12:15], s30 offen offset:1024 lds
    s_waitcnt lgkmcnt(0)
    ds_read_b64_tr_b16 v[84:85], v6 offset:10240
    ds_read_b64_tr_b16 v[86:87], v6 offset:10752
    ds_read_b128 v[72:75], v3 offset:16384
    ds_read_b128 v[76:79], v3 offset:20480
    v_mfma_f32_32x32x16_bf16 v[128:143], v[80:83], v[64:67], v[128:143]
    v_mfma_f32_32x32x16_bf16 v[144:159], v[80:83], v[68:71], v[144:159]
    s_waitcnt lgkmcnt(0)
    ds_read_b64_tr_b16 v[80:81], v6 offset:12288
    ds_read_b64_tr_b16 v[82:83], v6 offset:12800
    ds_read_b128 v[64:67], v4 offset:16384
    ds_read_b128 v[68:71], v4 offset:20480
    v_mfma_f32_32x32x16_bf16 v[128:143], v[84:87], v[72:75], v[128:143]
    v_mfma_f32_32x32x16_bf16 v[144:159], v[84:87], v[76:79], v[144:159]
    s_waitcnt lgkmcnt(0)
    ds_read_b64_tr_b16 v[84:85], v6 offset:14336
    ds_read_b64_tr_b16 v[86:87], v6 offset:14848
    ds_read_b128 v[72:75], v5 offset:16384
    ds_read_b128 v[76:79], v5 offset:20480
    v_mfma_f32_32x32x16_bf16 v[128:143], v[80:83], v[64:67], v[128:143]
    v_mfma_f32_32x32x16_bf16 v[144:159], v[80:83], v[68:71], v[144:159]
    s_waitcnt lgkmcnt(0)
    s_waitcnt vmcnt(6)
    s_barrier
    ds_read_b64_tr_b16 v[80:81], v6 offset:16384
    ds_read_b64_tr_b16 v[82:83], v6 offset:16896
    ds_read_b128 v[64:67], v2 offset:32768
    ds_read_b128 v[68:71], v2 offset:36864
    v_mfma_f32_32x32x16_bf16 v[128:143], v[84:87], v[72:75], v[128:143]
    v_mfma_f32_32x32x16_bf16 v[144:159], v[84:87], v[76:79], v[144:159]
    s_add_u32 m0, s36, 16384
    s_add_u32 s30, s34, 1664
    buffer_load_dwordx4 v8, s[8:11], s30 offen offset:0 lds
    buffer_load_dwordx4 v9, s[8:11], s30 offen offset:1024 lds
    buffer_load_dwordx4 v10, s[8:11], s30 offen offset:2048 lds
    buffer_load_dwordx4 v11, s[8:11], s30 offen offset:3072 lds
    s_add_u32 m0, s37, 8192
    s_add_u32 s30, s35, 1703936
    buffer_load_dwordx4 v12, s[12:15], s30 offen offset:0 lds
    buffer_load_dwordx4 v13, s[12:15], s30 offen offset:1024 lds
    s_waitcnt lgkmcnt(0)
    ds_read_b64_tr_b16 v[84:85], v6 offset:18432
    ds_read_b64_tr_b16 v[86:87], v6 offset:18944
    ds_read_b128 v[72:75], v3 offset:32768
    ds_read_b128 v[76:79], v3 offset:36864
    v_mfma_f32_32x32x16_bf16 v[128:143], v[80:83], v[64:67], v[128:143]
    v_mfma_f32_32x32x16_bf16 v[144:159], v[80:83], v[68:71], v[144:159]
    s_waitcnt lgkmcnt(0)
    ds_read_b64_tr_b16 v[80:81], v6 offset:20480
    ds_read_b64_tr_b16 v[82:83], v6 offset:20992
    ds_read_b128 v[64:67], v4 offset:32768
    ds_read_b128 v[68:71], v4 offset:36864
    v_mfma_f32_32x32x16_bf16 v[128:143], v[84:87], v[72:75], v[128:143]
    v_mfma_f32_32x32x16_bf16 v[144:159], v[84:87], v[76:79], v[144:159]
    s_waitcnt lgkmcnt(0)
    ds_read_b64_tr_b16 v[84:85], v6 offset:22528
    ds_read_b64_tr_b16 v[86:87], v6 offset:23040
    ds_read_b128 v[72:75], v5 offset:32768
    ds_read_b128 v[76:79], v5 offset:36864
    v_mfma_f32_32x32x16_bf16 v[128:143], v[80:83], v[64:67], v[128:143]
    v_mfma_f32_32x32x16_bf16 v[144:159], v[80:83], v[68:71], v[144:159]
    s_waitcnt lgkmcnt(0)
    s_waitcnt vmcnt(6)
    s_barrier
    ds_read_b64_tr_b16 v[80:81], v6 offset:0
    ds_read_b64_tr_b16 v[82:83], v6 offset:512
    ds_read_b128 v[64:67], v2 offset:0
    ds_read_b128 v[68:71], v2 offset:4096
    v_mfma_f32_32x32x16_bf16 v[128:143], v[84:87], v[72:75], v[128:143]
    v_mfma_f32_32x32x16_bf16 v[144:159], v[84:87], v[76:79], v[144:159]
    s_add_u32 m0, s36, 32768
    s_add_u32 s30, s34, 1792
    buffer_load_dwordx4 v8, s[8:11], s30 offen offset:0 lds
    buffer_load_dwordx4 v9, s[8:11], s30 offen offset:1024 lds
    buffer_load_dwordx4 v10, s[8:11], s30 offen offset:2048 lds
    buffer_load_dwordx4 v11, s[8:11], s30 offen offset:3072 lds
    s_add_u32 m0, s37, 16384
    s_add_u32 s30, s35, 1835008
    buffer_load_dwordx4 v12, s[12:15], s30 offen offset:0 lds
    buffer_load_dwordx4 v13, s[12:15], s30 offen offset:1024 lds
    s_waitcnt lgkmcnt(0)
    ds_read_b64_tr_b16 v[84:85], v6 offset:2048
    ds_read_b64_tr_b16 v[86:87], v6 offset:2560
    ds_read_b128 v[72:75], v3 offset:0
    ds_read_b128 v[76:79], v3 offset:4096
    v_mfma_f32_32x32x16_bf16 v[128:143], v[80:83], v[64:67], v[128:143]
    v_mfma_f32_32x32x16_bf16 v[144:159], v[80:83], v[68:71], v[144:159]
    s_waitcnt lgkmcnt(0)
    ds_read_b64_tr_b16 v[80:81], v6 offset:4096
    ds_read_b64_tr_b16 v[82:83], v6 offset:4608
    ds_read_b128 v[64:67], v4 offset:0
    ds_read_b128 v[68:71], v4 offset:4096
    v_mfma_f32_32x32x16_bf16 v[128:143], v[84:87], v[72:75], v[128:143]
    v_mfma_f32_32x32x16_bf16 v[144:159], v[84:87], v[76:79], v[144:159]
    s_waitcnt lgkmcnt(0)
    ds_read_b64_tr_b16 v[84:85], v6 offset:6144
    ds_read_b64_tr_b16 v[86:87], v6 offset:6656
    ds_read_b128 v[72:75], v5 offset:0
    ds_read_b128 v[76:79], v5 offset:4096
    v_mfma_f32_32x32x16_bf16 v[128:143], v[80:83], v[64:67], v[128:143]
    v_mfma_f32_32x32x16_bf16 v[144:159], v[80:83], v[68:71], v[144:159]
    s_waitcnt lgkmcnt(0)
    s_waitcnt vmcnt(6)
    s_barrier
    ds_read_b64_tr_b16 v[80:81], v6 offset:8192
    ds_read_b64_tr_b16 v[82:83], v6 offset:8704
    ds_read_b128 v[64:67], v2 offset:16384
    ds_read_b128 v[68:71], v2 offset:20480
    v_mfma_f32_32x32x16_bf16 v[128:143], v[84:87], v[72:75], v[128:143]
    v_mfma_f32_32x32x16_bf16 v[144:159], v[84:87], v[76:79], v[144:159]
    s_add_u32 m0, s36, 0
    s_add_u32 s30, s34, 1920
    buffer_load_dwordx4 v8, s[8:11], s30 offen offset:0 lds
    buffer_load_dwordx4 v9, s[8:11], s30 offen offset:1024 lds
    buffer_load_dwordx4 v10, s[8:11], s30 offen offset:2048 lds
    buffer_load_dwordx4 v11, s[8:11], s30 offen offset:3072 lds
    s_add_u32 m0, s37, 0
    s_add_u32 s30, s35, 1966080
    buffer_load_dwordx4 v12, s[12:15], s30 offen offset:0 lds
    buffer_load_dwordx4 v13, s[12:15], s30 offen offset:1024 lds
    s_waitcnt lgkmcnt(0)
    ds_read_b64_tr_b16 v[84:85], v6 offset:10240
    ds_read_b64_tr_b16 v[86:87], v6 offset:10752
    ds_read_b128 v[72:75], v3 offset:16384
    ds_read_b128 v[76:79], v3 offset:20480
    v_mfma_f32_32x32x16_bf16 v[128:143], v[80:83], v[64:67], v[128:143]
    v_mfma_f32_32x32x16_bf16 v[144:159], v[80:83], v[68:71], v[144:159]
    s_waitcnt lgkmcnt(0)
    ds_read_b64_tr_b16 v[80:81], v6 offset:12288
    ds_read_b64_tr_b16 v[82:83], v6 offset:12800
    ds_read_b128 v[64:67], v4 offset:16384
    ds_read_b128 v[68:71], v4 offset:20480
    v_mfma_f32_32x32x16_bf16 v[128:143], v[84:87], v[72:75], v[128:143]
    v_mfma_f32_32x32x16_bf16 v[144:159], v[84:87], v[76:79], v[144:159]
    s_waitcnt lgkmcnt(0)
    ds_read_b64_tr_b16 v[84:85], v6 offset:14336
    ds_read_b64_tr_b16 v[86:87], v6 offset:14848
    ds_read_b128 v[72:75], v5 offset:16384
    ds_read_b128 v[76:79], v5 offset:20480
    v_mfma_f32_32x32x16_bf16 v[128:143], v[80:83], v[64:67], v[128:143]
    v_mfma_f32_32x32x16_bf16 v[144:159], v[80:83], v[68:71], v[144:159]
    s_waitcnt lgkmcnt(0)
    s_waitcnt vmcnt(6)
    s_barrier
    ds_read_b64_tr_b16 v[80:81], v6 offset:16384
    ds_read_b64_tr_b16 v[82:83], v6 offset:16896
    ds_read_b128 v[64:67], v2 offset:32768
    ds_read_b128 v[68:71], v2 offset:36864
    v_mfma_f32_32x32x16_bf16 v[128:143], v[84:87], v[72:75], v[128:143]
    v_mfma_f32_32x32x16_bf16 v[144:159], v[84:87], v[76:79], v[144:159]
    v_mov_b32 v247, 0
    buffer_load_dword v246, v247, s[20:23], 0 offen sc1
    s_waitcnt lgkmcnt(0)
    ds_read_b64_tr_b16 v[84:85], v6 offset:18432
    ds_read_b64_tr_b16 v[86:87], v6 offset:18944
    ds_read_b128 v[72:75], v3 offset:32768
    ds_read_b128 v[76:79], v3 offset:36864
    v_mfma_f32_32x32x16_bf16 v[128:143], v[80:83], v[64:67], v[128:143]
    v_mfma_f32_32x32x16_bf16 v[144:159], v[80:83], v[68:71], v[144:159]
    s_waitcnt lgkmcnt(0)
    ds_read_b64_tr_b16 v[80:81], v6 offset:20480
    ds_read_b64_tr_b16 v[82:83], v6 offset:20992
    ds_read_b128 v[64:67], v4 offset:32768
    ds_read_b128 v[68:71], v4 offset:36864
    v_mfma_f32_32x32x16_bf16 v[128:143], v[84:87], v[72:75], v[128:143]
    v_mfma_f32_32x32x16_bf16 v[144:159], v[84:87], v[76:79], v[144:159]
    s_waitcnt lgkmcnt(0)
    ds_read_b64_tr_b16 v[84:85], v6 offset:22528
    ds_read_b64_tr_b16 v[86:87], v6 offset:23040
    ds_read_b128 v[72:75], v5 offset:32768
    ds_read_b128 v[76:79], v5 offset:36864
    v_mfma_f32_32x32x16_bf16 v[128:143], v[80:83], v[64:67], v[128:143]
    v_mfma_f32_32x32x16_bf16 v[144:159], v[80:83], v[68:71], v[144:159]
    s_waitcnt lgkmcnt(0)
    s_waitcnt vmcnt(1)
    s_barrier
    ds_read_b64_tr_b16 v[80:81], v6 offset:0
    ds_read_b64_tr_b16 v[82:83], v6 offset:512
    ds_read_b128 v[64:67], v2 offset:0
    ds_read_b128 v[68:71], v2 offset:4096
    v_mfma_f32_32x32x16_bf16 v[128:143], v[84:87], v[72:75], v[128:143]
    v_mfma_f32_32x32x16_bf16 v[144:159], v[84:87], v[76:79], v[144:159]
    s_waitcnt lgkmcnt(0)
    ds_read_b64_tr_b16 v[84:85], v6 offset:2048
    ds_read_b64_tr_b16 v[86:87], v6 offset:2560
    ds_read_b128 v[72:75], v3 offset:0
    ds_read_b128 v[76:79], v3 offset:4096
    v_mfma_f32_32x32x16_bf16 v[128:143], v[80:83], v[64:67], v[128:143]
    v_mfma_f32_32x32x16_bf16 v[144:159], v[80:83], v[68:71], v[144:159]
    s_waitcnt lgkmcnt(0)
    ds_read_b64_tr_b16 v[80:81], v6 offset:4096
    ds_read_b64_tr_b16 v[82:83], v6 offset:4608
    ds_read_b128 v[64:67], v4 offset:0
    ds_read_b128 v[68:71], v4 offset:4096
    v_mfma_f32_32x32x16_bf16 v[128:143], v[84:87], v[72:75], v[128:143]
    v_mfma_f32_32x32x16_bf16 v[144:159], v[84:87], v[76:79], v[144:159]
    s_waitcnt lgkmcnt(0)
    ds_read_b64_tr_b16 v[84:85], v6 offset:6144
    ds_read_b64_tr_b16 v[86:87], v6 offset:6656
    ds_read_b128 v[72:75], v5 offset:0
    ds_read_b128 v[76:79], v5 offset:4096
    v_mfma_f32_32x32x16_bf16 v[128:143], v[80:83], v[64:67], v[128:143]
    v_mfma_f32_32x32x16_bf16 v[144:159], v[80:83], v[68:71], v[144:159]
    s_waitcnt lgkmcnt(0)
    v_mfma_f32_32x32x16_bf16 v[128:143], v[84:87], v[72:75], v[128:143]
    v_mfma_f32_32x32x16_bf16 v[144:159], v[84:87], v[76:79], v[144:159]
    s_mov_b32 s40, 0x3e8293ee
    s_nop 9
    v_mul_f32 v128, s40, v128
    v_mul_f32 v129, s40, v129
    v_mul_f32 v130, s40, v130
    v_mul_f32 v131, s40, v131
    v_mul_f32 v132, s40, v132
    v_mul_f32 v133, s40, v133
    v_mul_f32 v134, s40, v134
    v_mul_f32 v135, s40, v135
    v_mul_f32 v136, s40, v136
    v_mul_f32 v137, s40, v137
    v_mul_f32 v138, s40, v138
    v_mul_f32 v139, s40, v139
    v_mul_f32 v140, s40, v140
    v_mul_f32 v141, s40, v141
    v_mul_f32 v142, s40, v142
    v_mul_f32 v143, s40, v143
    v_cvt_pk_bf16_f32 v16, v128, v129
    v_cvt_pk_bf16_f32 v17, v130, v131
    v_cvt_pk_bf16_f32 v18, v132, v133
    v_cvt_pk_bf16_f32 v19, v134, v135
    v_cvt_pk_bf16_f32 v20, v136, v137
    v_cvt_pk_bf16_f32 v21, v138, v139
    v_cvt_pk_bf16_f32 v22, v140, v141
    v_cvt_pk_bf16_f32 v23, v142, v143
    v_mul_f32 v144, s40, v144
    v_mul_f32 v145, s40, v145
    v_mul_f32 v146, s40, v146
    v_mul_f32 v147, s40, v147
    v_mul_f32 v148, s40, v148
    v_mul_f32 v149, s40, v149
    v_mul_f32 v150, s40, v150
    v_mul_f32 v151, s40, v151
    v_mul_f32 v152, s40, v152
    v_mul_f32 v153, s40, v153
    v_mul_f32 v154, s40, v154
    v_mul_f32 v155, s40, v155
    v_mul_f32 v156, s40, v156
    v_mul_f32 v157, s40, v157
    v_mul_f32 v158, s40, v158
    v_mul_f32 v159, s40, v159
    v_cvt_pk_bf16_f32 v24, v144, v145
    v_cvt_pk_bf16_f32 v25, v146, v147
    v_cvt_pk_bf16_f32 v26, v148, v149
    v_cvt_pk_bf16_f32 v27, v150, v151
    v_cvt_pk_bf16_f32 v28, v152, v153
    v_cvt_pk_bf16_f32 v29, v154, v155
    v_cvt_pk_bf16_f32 v30, v156, v157
    v_cvt_pk_bf16_f32 v31, v158, v159
    v_mov_b32 v225, 0x3f803f80
    v_and_b32 v224, 6, v0
    v_cmp_eq_u32 vcc, 0, v224
    s_nop 1
    v_cndmask_b32 v184, 0, v225, vcc
    v_mov_b32 v185, v184
    v_cmp_eq_u32 vcc, 4, v224
    s_nop 1
    v_cndmask_b32 v186, 0, v225, vcc
    v_mov_b32 v187, v186
    v_and_b32 v224, 1, v0
    v_cmp_eq_u32 vcc, 0, v224
    v_mov_b32 v225, 0x44444444
    v_mov_b32 v226, 0xeeeeeeee
    v_cndmask_b32 v188, v226, v225, vcc
    v_mov_b32 v192, 0
    v_mov_b32 v193, 0
    v_mov_b32 v194, 0
    v_mov_b32 v195, 0
    v_mov_b32 v196, 0
    v_mov_b32 v197, 0
    v_mov_b32 v198, 0
    v_mov_b32 v199, 0
    v_mov_b32 v200, 0
    v_mov_b32 v201, 0
    v_mov_b32 v202, 0
    v_mov_b32 v203, 0
    v_mov_b32 v204, 0
    v_mov_b32 v205, 0
    v_mov_b32 v206, 0
    v_mov_b32 v207, 0
    v_mov_b32 v208, 0
    v_mov_b32 v209, 0
    v_mov_b32 v210, 0
    v_mov_b32 v211, 0
    v_mov_b32 v212, 0
    v_mov_b32 v213, 0
    v_mov_b32 v214, 0
    v_mov_b32 v215, 0
    v_mov_b32 v216, 0
    v_mov_b32 v217, 0
    v_mov_b32 v218, 0
    v_mov_b32 v219, 0
    v_mov_b32 v220, 0
    v_mov_b32 v221, 0
    v_mov_b32 v222, 0
    v_mov_b32 v223, 0
    s_mov_b32 s52, 0
    s_cmp_lg_u32 s3, 0
    s_cbranch_scc1 L_w0_25
    s_cmp_ge_u32 s25, 28
    s_cbranch_scc1 L_w0_25
    s_waitcnt vmcnt(0)
    v_readfirstlane_b32 s31, v246
    s_nop 2
    s_cmp_lg_u32 s31, 0
    s_cbranch_scc1 L_rdyok_26
    v_mov_b32 v247, 0
    s_bfm_b64 exec, 1, 0
    s_mov_b32 s39, 200000
L_poll_27:
    buffer_load_dword v246, v247, s[20:23], 0 offen sc1
    s_waitcnt vmcnt(0)
    v_cmp_ne_u32 vcc, 0, v246
    s_nop 3
    s_cmp_eq_u64 vcc, exec
    s_cbranch_scc1 L_polld_28
    s_sleep 4
    s_sub_u32 s39, s39, 1
    s_cmp_lg_u32 s39, 0
    s_cbranch_scc1 L_poll_27
L_polld_28:
    s_mov_b64 exec, -1
L_rdyok_26:
    s_bfm_b64 exec, 32, 0
    s_mov_b32 s39, 200000
L_poll_29:
    buffer_load_dword v224, v15, s[4:7], 0 offen sc1
    s_waitcnt vmcnt(0)
    v_cmp_ne_u32 vcc, 0, v224
    s_nop 3
    s_cmp_eq_u64 vcc, exec
    s_cbranch_scc1 L_polld_30
    s_sleep 4
    s_sub_u32 s39, s39, 1
    s_cmp_lg_u32 s39, 0
    s_cbranch_scc1 L_poll_29
L_polld_30:
    s_mov_b64 exec, -1
L_w0_25:
    s_setprio 1
L_attn_start:
    s_waitcnt vmcnt(0) lgkmcnt(0)
    s_barrier
    s_lshl_b32 s36, s3, 12
    s_add_u32 s34, s36, 65536
    s_mov_b32 m0, s36
    s_nop 0
    buffer_load_dwordx4 v14, s[4:7], s34 offen offset:0 sc1 lds
    buffer_load_dwordx4 v14, s[4:7], s34 offen offset:1024 sc1 lds
    buffer_load_dwordx4 v14, s[4:7], s34 offen offset:2048 sc1 lds
    buffer_load_dwordx4 v14, s[4:7], s34 offen offset:3072 sc1 lds
    s_add_u32 s34, s34, 16384
    s_add_u32 s36, s36, 16384
    s_and_b32 s36, s36, 0xffff
    s_mov_b32 m0, s36
    s_nop 0
    buffer_load_dwordx4 v14, s[4:7], s34 offen offset:0 sc1 lds
    buffer_load_dwordx4 v14, s[4:7], s34 offen offset:1024 sc1 lds
    buffer_load_dwordx4 v14, s[4:7], s34 offen offset:2048 sc1 lds
    buffer_load_dwordx4 v14, s[4:7], s34 offen offset:3072 sc1 lds
    s_add_u32 s34, s34, 16384
    s_add_u32 s36, s36, 16384
    s_and_b32 s36, s36, 0xffff
    s_mov_b32 m0, s36
    s_nop 0
    buffer_load_dwordx4 v14, s[4:7], s34 offen offset:0 sc1 lds
    buffer_load_dwordx4 v14, s[4:7], s34 offen offset:1024 sc1 lds
    buffer_load_dwordx4 v14, s[4:7], s34 offen offset:2048 sc1 lds
    buffer_load_dwordx4 v14, s[4:7], s34 offen offset:3072 sc1 lds
    s_add_u32 s34, s34, 16384
    s_add_u32 s36, s36, 16384
    s_and_b32 s36, s36, 0xffff
    v_mov_b32 v7, v14
    s_mov_b32 s53, 0
    s_waitcnt vmcnt(8)
    s_barrier
    v_mov_b32 v32, 0
    v_mov_b32 v33, 0
    v_mov_b32 v34, 0
    v_mov_b32 v35, 0
    v_mov_b32 v36, 0
    v_mov_b32 v37, 0
    v_mov_b32 v38, 0
    v_mov_b32 v39, 0
    v_mov_b32 v40, 0
    v_mov_b32 v41, 0
    v_mov_b32 v42, 0
    v_mov_b32 v43, 0
    v_mov_b32 v44, 0
    v_mov_b32 v45, 0
    v_mov_b32 v46, 0
    v_mov_b32 v47, 0
    v_mov_b32 v176, 0
    v_mov_b32 v177, 0
    v_mov_b32 v178, 0
    v_mov_b32 v179, 0
    v_mov_b32 v48, 0
    v_mov_b32 v49, 0
    v_mov_b32 v50, 0
    v_mov_b32 v51, 0
    v_mov_b32 v52, 0
    v_mov_b32 v53, 0
    v_mov_b32 v54, 0
    v_mov_b32 v55, 0
    v_mov_b32 v56, 0
    v_mov_b32 v57, 0
    v_mov_b32 v58, 0
    v_mov_b32 v59, 0
    v_mov_b32 v60, 0
    v_mov_b32 v61, 0
    v_mov_b32 v62, 0
    v_mov_b32 v63, 0
    v_mov_b32 v180, 0
    v_mov_b32 v181, 0
    v_mov_b32 v182, 0
    v_mov_b32 v183, 0
    v_mov_b32 v104, 0
    v_mov_b32 v168, 0
    v_mov_b32 v105, 0
    v_mov_b32 v169, 0
    v_mov_b32 v106, 0
    v_mov_b32 v170, 0
    v_mov_b32 v107, 0
    v_mov_b32 v171, 0
    v_mov_b32 v108, 0
    v_mov_b32 v172, 0
    v_mov_b32 v109, 0
    v_mov_b32 v173, 0
    v_mov_b32 v110, 0
    v_mov_b32 v174, 0
    v_mov_b32 v111, 0
    v_mov_b32 v175, 0
    ds_read_b128 v[112:115], v7 offset:0
    ds_read_b128 v[116:119], v7 offset:1024
    s_waitcnt lgkmcnt(0)
    v_mfma_f32_32x32x16_bf16 v[64:79], v[112:115], v[16:19], 0
    v_mfma_f32_32x32x16_bf16 v[64:79], v[116:119], v[20:23], v[64:79]
    s_nop 7
    s_mov_b32 s38, 16
.p2align 6
L_attnm_31:
    ds_read_b128 v[120:123], v7 offset:4096
    ds_read_b128 v[124:127], v7 offset:5120
    ds_read_b128 v[160:163], v7 offset:2048
    ds_read_b128 v[164:167], v7 offset:3072
    v_mfma_f32_32x32x16_bf16 v[80:95], v[112:115], v[24:27], 0
    v_exp_f32 v64, v64
    v_exp_f32 v65, v65
    v_exp_f32 v66, v66
    v_exp_f32 v67, v67
    v_cvt_pk_bf16_f32 v96, v64, v65
    v_mfma_f32_32x32x16_bf16 v[80:95], v[116:119], v[28:31], v[80:95]
    v_exp_f32 v68, v68
    v_exp_f32 v69, v69
    v_cvt_pk_bf16_f32 v97, v66, v67
    v_exp_f32 v70, v70
    v_exp_f32 v71, v71
    v_mfma_f32_32x32x16_bf16 v[48:63], v[168:171], v[104:107], v[48:63]
    v_cvt_pk_bf16_f32 v98, v68, v69
    v_exp_f32 v72, v72
    v_exp_f32 v73, v73
    v_cvt_pk_bf16_f32 v99, v70, v71
    v_mfma_f32_32x32x16_bf16 v[48:63], v[172:175], v[108:111], v[48:63]
    v_exp_f32 v74, v74
    v_exp_f32 v75, v75
    v_cvt_pk_bf16_f32 v100, v72, v73
    v_exp_f32 v76, v76
    v_exp_f32 v77, v77
    v_smfmac_f32_16x16x64_bf16 v[180:183], v[184:187], v[104:111], v188
    v_cvt_pk_bf16_f32 v101, v74, v75
    v_exp_f32 v78, v78
    v_exp_f32 v79, v79
    v_cvt_pk_bf16_f32 v102, v76, v77
    v_cvt_pk_bf16_f32 v103, v78, v79
    s_waitcnt lgkmcnt(0)
    v_mfma_f32_32x32x16_bf16 v[64:79], v[120:123], v[16:19], 0
    v_exp_f32 v80, v80
    v_exp_f32 v81, v81
    v_exp_f32 v82, v82
    v_exp_f32 v83, v83
    v_cvt_pk_bf16_f32 v104, v80, v81
    v_mfma_f32_32x32x16_bf16 v[64:79], v[124:127], v[20:23], v[64:79]
    v_exp_f32 v84, v84
    v_exp_f32 v85, v85
    v_cvt_pk_bf16_f32 v105, v82, v83
    v_exp_f32 v86, v86
    v_exp_f32 v87, v87
    v_mfma_f32_32x32x16_bf16 v[32:47], v[160:163], v[96:99], v[32:47]
    v_cvt_pk_bf16_f32 v106, v84, v85
    v_exp_f32 v88, v88
    v_exp_f32 v89, v89
    v_cvt_pk_bf16_f32 v107, v86, v87
    v_mfma_f32_32x32x16_bf16 v[32:47], v[164:167], v[100:103], v[32:47]
    v_exp_f32 v90, v90
    v_exp_f32 v91, v91
    v_cvt_pk_bf16_f32 v108, v88, v89
    v_exp_f32 v92, v92
    v_exp_f32 v93, v93
    v_smfmac_f32_16x16x64_bf16 v[176:179], v[184:187], v[96:103], v188
    v_cvt_pk_bf16_f32 v109, v90, v91
    v_exp_f32 v94, v94
    v_exp_f32 v95, v95
    v_cvt_pk_bf16_f32 v110, v92, v93
    v_cvt_pk_bf16_f32 v111, v94, v95
    ds_read_b128 v[112:115], v7 offset:8192
    ds_read_b128 v[116:119], v7 offset:9216
    ds_read_b128 v[168:171], v7 offset:6144
    ds_read_b128 v[172:175], v7 offset:7168
    v_mfma_f32_32x32x16_bf16 v[80:95], v[120:123], v[24:27], 0
    v_exp_f32 v64, v64
    v_exp_f32 v65, v65
    v_exp_f32 v66, v66
    v_exp_f32 v67, v67
    v_cvt_pk_bf16_f32 v96, v64, v65
    v_mfma_f32_32x32x16_bf16 v[80:95], v[124:127], v[28:31], v[80:95]
    v_exp_f32 v68, v68
    v_exp_f32 v69, v69
    v_cvt_pk_bf16_f32 v97, v66, v67
    v_exp_f32 v70, v70
    v_exp_f32 v71, v71
    v_mfma_f32_32x32x16_bf16 v[48:63], v[160:163], v[104:107], v[48:63]
    v_cvt_pk_bf16_f32 v98, v68, v69
    v_exp_f32 v72, v72
    v_exp_f32 v73, v73
    v_cvt_pk_bf16_f32 v99, v70, v71
    v_mfma_f32_32x32x16_bf16 v[48:63], v[164:167], v[108:111], v[48:63]
    v_exp_f32 v74, v74
    v_exp_f32 v75, v75
    v_cvt_pk_bf16_f32 v100, v72, v73
    v_exp_f32 v76, v76
    v_exp_f32 v77, v77
    v_smfmac_f32_16x16x64_bf16 v[180:183], v[184:187], v[104:111], v188
    v_cvt_pk_bf16_f32 v101, v74, v75
    v_exp_f32 v78, v78
    v_exp_f32 v79, v79
    v_cvt_pk_bf16_f32 v102, v76, v77
    v_cvt_pk_bf16_f32 v103, v78, v79
    s_waitcnt lgkmcnt(0)
    v_mfma_f32_32x32x16_bf16 v[64:79], v[112:115], v[16:19], 0
    v_exp_f32 v80, v80
    v_exp_f32 v81, v81
    v_exp_f32 v82, v82
    v_exp_f32 v83, v83
    v_cvt_pk_bf16_f32 v104, v80, v81
    v_mfma_f32_32x32x16_bf16 v[64:79], v[116:119], v[20:23], v[64:79]
    v_exp_f32 v84, v84
    v_exp_f32 v85, v85
    v_cvt_pk_bf16_f32 v105, v82, v83
    v_exp_f32 v86, v86
    v_exp_f32 v87, v87
    v_mfma_f32_32x32x16_bf16 v[32:47], v[168:171], v[96:99], v[32:47]
    v_cvt_pk_bf16_f32 v106, v84, v85
    v_exp_f32 v88, v88
    v_exp_f32 v89, v89
    v_cvt_pk_bf16_f32 v107, v86, v87
    v_mfma_f32_32x32x16_bf16 v[32:47], v[172:175], v[100:103], v[32:47]
    v_exp_f32 v90, v90
    v_exp_f32 v91, v91
    v_cvt_pk_bf16_f32 v108, v88, v89
    v_exp_f32 v92, v92
    v_exp_f32 v93, v93
    v_smfmac_f32_16x16x64_bf16 v[176:179], v[184:187], v[96:103], v188
    v_cvt_pk_bf16_f32 v109, v90, v91
    v_exp_f32 v94, v94
    v_exp_f32 v95, v95
    v_cvt_pk_bf16_f32 v110, v92, v93
    v_cvt_pk_bf16_f32 v111, v94, v95
    ds_read_b128 v[120:123], v7 offset:12288
    ds_read_b128 v[124:127], v7 offset:13312
    ds_read_b128 v[160:163], v7 offset:10240
    ds_read_b128 v[164:167], v7 offset:11264
    v_mfma_f32_32x32x16_bf16 v[80:95], v[112:115], v[24:27], 0
    v_exp_f32 v64, v64
    v_exp_f32 v65, v65
    v_exp_f32 v66, v66
    v_exp_f32 v67, v67
    v_cvt_pk_bf16_f32 v96, v64, v65
    v_mfma_f32_32x32x16_bf16 v[80:95], v[116:119], v[28:31], v[80:95]
    v_exp_f32 v68, v68
    v_exp_f32 v69, v69
    v_cvt_pk_bf16_f32 v97, v66, v67
    v_exp_f32 v70, v70
    v_exp_f32 v71, v71
    v_mfma_f32_32x32x16_bf16 v[48:63], v[168:171], v[104:107], v[48:63]
    v_cvt_pk_bf16_f32 v98, v68, v69
    v_exp_f32 v72, v72
    v_exp_f32 v73, v73
    v_cvt_pk_bf16_f32 v99, v70, v71
    v_mfma_f32_32x32x16_bf16 v[48:63], v[172:175], v[108:111], v[48:63]
    v_exp_f32 v74, v74
    v_exp_f32 v75, v75
    v_cvt_pk_bf16_f32 v100, v72, v73
    v_exp_f32 v76, v76
    v_exp_f32 v77, v77
    v_smfmac_f32_16x16x64_bf16 v[180:183], v[184:187], v[104:111], v188
    v_cvt_pk_bf16_f32 v101, v74, v75
    v_exp_f32 v78, v78
    v_exp_f32 v79, v79
    v_cvt_pk_bf16_f32 v102, v76, v77
    v_cvt_pk_bf16_f32 v103, v78, v79
    s_waitcnt lgkmcnt(0)
    v_mfma_f32_32x32x16_bf16 v[64:79], v[120:123], v[16:19], 0
    v_exp_f32 v80, v80
    v_exp_f32 v81, v81
    v_exp_f32 v82, v82
    v_exp_f32 v83, v83
    v_cvt_pk_bf16_f32 v104, v80, v81
    v_mfma_f32_32x32x16_bf16 v[64:79], v[124:127], v[20:23], v[64:79]
    v_exp_f32 v84, v84
    v_exp_f32 v85, v85
    v_cvt_pk_bf16_f32 v105, v82, v83
    v_exp_f32 v86, v86
    v_exp_f32 v87, v87
    v_mfma_f32_32x32x16_bf16 v[32:47], v[160:163], v[96:99], v[32:47]
    v_cvt_pk_bf16_f32 v106, v84, v85
    v_exp_f32 v88, v88
    v_exp_f32 v89, v89
    v_cvt_pk_bf16_f32 v107, v86, v87
    v_mfma_f32_32x32x16_bf16 v[32:47], v[164:167], v[100:103], v[32:47]
    v_exp_f32 v90, v90
    v_exp_f32 v91, v91
    v_cvt_pk_bf16_f32 v108, v88, v89
    v_exp_f32 v92, v92
    v_exp_f32 v93, v93
    v_smfmac_f32_16x16x64_bf16 v[176:179], v[184:187], v[96:103], v188
    v_cvt_pk_bf16_f32 v109, v90, v91
    v_exp_f32 v94, v94
    v_exp_f32 v95, v95
    v_cvt_pk_bf16_f32 v110, v92, v93
    v_cvt_pk_bf16_f32 v111, v94, v95
    s_waitcnt vmcnt(4)
    s_barrier
    s_add_u32 s53, s53, 16384
    s_and_b32 s53, s53, 0xffff
    ds_read_b128 v[168:171], v7 offset:14336
    ds_read_b128 v[172:175], v7 offset:15360
    v_add_u32 v7, s53, v14
    ds_read_b128 v[112:115], v7 offset:0
    ds_read_b128 v[116:119], v7 offset:1024
    s_mov_b32 m0, s36
    s_nop 0
    buffer_load_dwordx4 v14, s[4:7], s34 offen offset:0 sc1 lds
    buffer_load_dwordx4 v14, s[4:7], s34 offen offset:1024 sc1 lds
    buffer_load_dwordx4 v14, s[4:7], s34 offen offset:2048 sc1 lds
    buffer_load_dwordx4 v14, s[4:7], s34 offen offset:3072 sc1 lds
    s_add_u32 s34, s34, 16384
    s_add_u32 s36, s36, 16384
    s_and_b32 s36, s36, 0xffff
    v_mfma_f32_32x32x16_bf16 v[80:95], v[120:123], v[24:27], 0
    v_exp_f32 v64, v64
    v_exp_f32 v65, v65
    v_exp_f32 v66, v66
    v_exp_f32 v67, v67
    v_cvt_pk_bf16_f32 v96, v64, v65
    v_mfma_f32_32x32x16_bf16 v[80:95], v[124:127], v[28:31], v[80:95]
    v_exp_f32 v68, v68
    v_exp_f32 v69, v69
    v_cvt_pk_bf16_f32 v97, v66, v67
    v_exp_f32 v70, v70
    v_exp_f32 v71, v71
    v_mfma_f32_32x32x16_bf16 v[48:63], v[160:163], v[104:107], v[48:63]
    v_cvt_pk_bf16_f32 v98, v68, v69
    v_exp_f32 v72, v72
    v_exp_f32 v73, v73
    v_cvt_pk_bf16_f32 v99, v70, v71
    v_mfma_f32_32x32x16_bf16 v[48:63], v[164:167], v[108:111], v[48:63]
    v_exp_f32 v74, v74
    v_exp_f32 v75, v75
    v_cvt_pk_bf16_f32 v100, v72, v73
    v_exp_f32 v76, v76
    v_exp_f32 v77, v77
    v_smfmac_f32_16x16x64_bf16 v[180:183], v[184:187], v[104:111], v188
    v_cvt_pk_bf16_f32 v101, v74, v75
    v_exp_f32 v78, v78
    v_exp_f32 v79, v79
    v_cvt_pk_bf16_f32 v102, v76, v77
    v_cvt_pk_bf16_f32 v103, v78, v79
    s_waitcnt lgkmcnt(0)
    v_mfma_f32_32x32x16_bf16 v[64:79], v[112:115], v[16:19], 0
    v_exp_f32 v80, v80
    v_exp_f32 v81, v81
    v_exp_f32 v82, v82
    v_exp_f32 v83, v83
    v_cvt_pk_bf16_f32 v104, v80, v81
    v_mfma_f32_32x32x16_bf16 v[64:79], v[116:119], v[20:23], v[64:79]
    v_exp_f32 v84, v84
    v_exp_f32 v85, v85
    v_cvt_pk_bf16_f32 v105, v82, v83
    v_exp_f32 v86, v86
    v_exp_f32 v87, v87
    v_mfma_f32_32x32x16_bf16 v[32:47], v[168:171], v[96:99], v[32:47]
    v_cvt_pk_bf16_f32 v106, v84, v85
    v_exp_f32 v88, v88
    v_exp_f32 v89, v89
    v_cvt_pk_bf16_f32 v107, v86, v87
    v_mfma_f32_32x32x16_bf16 v[32:47], v[172:175], v[100:103], v[32:47]
    v_exp_f32 v90, v90
    v_exp_f32 v91, v91
    v_cvt_pk_bf16_f32 v108, v88, v89
    v_exp_f32 v92, v92
    v_exp_f32 v93, v93
    v_smfmac_f32_16x16x64_bf16 v[176:179], v[184:187], v[96:103], v188
    v_cvt_pk_bf16_f32 v109, v90, v91
    v_exp_f32 v94, v94
    v_exp_f32 v95, v95
    v_cvt_pk_bf16_f32 v110, v92, v93
    v_cvt_pk_bf16_f32 v111, v94, v95
    s_sub_u32 s38, s38, 1
    s_cmp_lg_u32 s38, 0
    s_cbranch_scc1 L_attnm_31
    v_mfma_f32_32x32x16_bf16 v[48:63], v[168:171], v[104:107], v[48:63]
    v_mfma_f32_32x32x16_bf16 v[48:63], v[172:175], v[108:111], v[48:63]
    v_smfmac_f32_16x16x64_bf16 v[180:183], v[184:187], v[104:111], v188
    v_add_f32 v176, v176, v177
    s_nop 6
    v_add_f32 v180, v180, v181
    s_waitcnt vmcnt(0) lgkmcnt(0)
    s_nop 15
    s_cmp_lg_u32 s52, 0
    s_cbranch_scc1 L_attn_fin
    s_mov_b32 s40, 0x1f800000
    s_mov_b32 s41, 0x5f800000
    v_cmp_nle_f32 s[28:29], s40, v176
    v_cmp_nle_f32 s[30:31], s40, v180
    s_nop 2
    s_or_b64 s[28:29], s[28:29], s[30:31]
    v_cmp_nge_f32 s[30:31], s41, v176
    s_nop 2
    s_or_b64 s[28:29], s[28:29], s[30:31]
    v_cmp_nge_f32 s[30:31], s41, v180
    s_nop 2
    s_or_b64 s[28:29], s[28:29], s[30:31]
    v_mul_f32 v226, 0, v32
    v_mul_f32 v227, 0, v40
    v_mul_f32 v228, 0, v48
    v_mul_f32 v229, 0, v56
    v_fma_f32 v226, v33, 0, v226
    v_fma_f32 v227, v41, 0, v227
    v_fma_f32 v228, v49, 0, v228
    v_fma_f32 v229, v57, 0, v229
    v_fma_f32 v226, v34, 0, v226
    v_fma_f32 v227, v42, 0, v227
    v_fma_f32 v228, v50, 0, v228
    v_fma_f32 v229, v58, 0, v229
    v_fma_f32 v226, v35, 0, v226
    v_fma_f32 v227, v43, 0, v227
    v_fma_f32 v228, v51, 0, v228
    v_fma_f32 v229, v59, 0, v229
    v_fma_f32 v226, v36, 0, v226
    v_fma_f32 v227, v44, 0, v227
    v_fma_f32 v228, v52, 0, v228
    v_fma_f32 v229, v60, 0, v229
    v_fma_f32 v226, v37, 0, v226
    v_fma_f32 v227, v45, 0, v227
    v_fma_f32 v228, v53, 0, v228
    v_fma_f32 v229, v61, 0, v229
    v_fma_f32 v226, v38, 0, v226
    v_fma_f32 v227, v46, 0, v227
    v_fma_f32 v228, v54, 0, v228
    v_fma_f32 v229, v62, 0, v229
    v_fma_f32 v226, v39, 0, v226
    v_fma_f32 v227, v47, 0, v227
    v_fma_f32 v228, v55, 0, v228
    v_fma_f32 v229, v63, 0, v229
    v_add_f32 v226, v226, v227
    v_add_f32 v228, v228, v229
    v_add_f32 v226, v226, v228
    v_cmp_u_f32 s[30:31], v226, v226
    s_nop 2
    s_or_b64 s[28:29], s[28:29], s[30:31]
    s_cmp_lg_u64 s[28:29], 0
    s_cselect_b32 s30, 1, 0
    v_mov_b32 v224, s30
    s_lshl_b32 s31, s3, 2
    s_add_u32 s31, s31, 65536
    v_mov_b32 v225, s31
    ds_write_b32 v225, v224
    s_waitcnt lgkmcnt(0)
    s_barrier
    v_mov_b32 v225, 0x10000
    ds_read_b128 v[228:231], v225
    s_waitcnt lgkmcnt(0)
    v_or_b32 v228, v228, v229
    v_or_b32 v230, v230, v231
    v_or_b32 v228, v228, v230
    s_nop 0
    v_readfirstlane_b32 s30, v228
    s_nop 2
    s_cmp_eq_u32 s30, 0
    s_cbranch_scc1 L_attn_fin
    s_mov_b32 s52, 1
    s_waitcnt vmcnt(0) lgkmcnt(0)
    s_barrier
    s_lshl_b32 s36, s3, 12
    s_add_u32 s34, s36, 65536
    s_mov_b32 m0, s36
    s_nop 0
    buffer_load_dwordx4 v14, s[4:7], s34 offen offset:0 sc1 lds
    buffer_load_dwordx4 v14, s[4:7], s34 offen offset:1024 sc1 lds
    buffer_load_dwordx4 v14, s[4:7], s34 offen offset:2048 sc1 lds
    buffer_load_dwordx4 v14, s[4:7], s34 offen offset:3072 sc1 lds
    s_add_u32 s34, s34, 16384
    s_add_u32 s36, s36, 16384
    s_and_b32 s36, s36, 0xffff
    s_mov_b32 m0, s36
    s_nop 0
    buffer_load_dwordx4 v14, s[4:7], s34 offen offset:0 sc1 lds
    buffer_load_dwordx4 v14, s[4:7], s34 offen offset:1024 sc1 lds
    buffer_load_dwordx4 v14, s[4:7], s34 offen offset:2048 sc1 lds
    buffer_load_dwordx4 v14, s[4:7], s34 offen offset:3072 sc1 lds
    s_add_u32 s34, s34, 16384
    s_add_u32 s36, s36, 16384
    s_and_b32 s36, s36, 0xffff
    s_mov_b32 m0, s36
    s_nop 0
    buffer_load_dwordx4 v14, s[4:7], s34 offen offset:0 sc1 lds
    buffer_load_dwordx4 v14, s[4:7], s34 offen offset:1024 sc1 lds
    buffer_load_dwordx4 v14, s[4:7], s34 offen offset:2048 sc1 lds
    buffer_load_dwordx4 v14, s[4:7], s34 offen offset:3072 sc1 lds
    s_add_u32 s34, s34, 16384
    s_add_u32 s36, s36, 16384
    s_and_b32 s36, s36, 0xffff
    v_mov_b32 v7, v14
    s_mov_b32 s53, 0
    s_waitcnt vmcnt(8)
    s_barrier
    v_mov_b32 v232, 0xff800000
    v_mov_b32 v233, 0xff800000
    s_mov_b32 s38, 16
.p2align 6
L_amax_32:
    ds_read_b128 v[112:115], v7 offset:0
    ds_read_b128 v[116:119], v7 offset:1024
    s_waitcnt lgkmcnt(0)
    v_mfma_f32_32x32x16_bf16 v[64:79], v[112:115], v[16:19], 0
    v_mfma_f32_32x32x16_bf16 v[64:79], v[116:119], v[20:23], v[64:79]
    v_mfma_f32_32x32x16_bf16 v[80:95], v[112:115], v[24:27], 0
    v_mfma_f32_32x32x16_bf16 v[80:95], v[116:119], v[28:31], v[80:95]
    s_nop 9
    v_max3_f32 v232, v64, v65, v232
    v_max3_f32 v232, v66, v67, v232
    v_max3_f32 v232, v68, v69, v232
    v_max3_f32 v232, v70, v71, v232
    v_max3_f32 v232, v72, v73, v232
    v_max3_f32 v232, v74, v75, v232
    v_max3_f32 v232, v76, v77, v232
    v_max3_f32 v232, v78, v79, v232
    v_max3_f32 v233, v80, v81, v233
    v_max3_f32 v233, v82, v83, v233
    v_max3_f32 v233, v84, v85, v233
    v_max3_f32 v233, v86, v87, v233
    v_max3_f32 v233, v88, v89, v233
    v_max3_f32 v233, v90, v91, v233
    v_max3_f32 v233, v92, v93, v233
    v_max3_f32 v233, v94, v95, v233
    ds_read_b128 v[112:115], v7 offset:4096
    ds_read_b128 v[116:119], v7 offset:5120
    s_waitcnt lgkmcnt(0)
    v_mfma_f32_32x32x16_bf16 v[64:79], v[112:115], v[16:19], 0
    v_mfma_f32_32x32x16_bf16 v[64:79], v[116:119], v[20:23], v[64:79]
    v_mfma_f32_32x32x16_bf16 v[80:95], v[112:115], v[24:27], 0
    v_mfma_f32_32x32x16_bf16 v[80:95], v[116:119], v[28:31], v[80:95]
    s_nop 9
    v_max3_f32 v232, v64, v65, v232
    v_max3_f32 v232, v66, v67, v232
    v_max3_f32 v232, v68, v69, v232
    v_max3_f32 v232, v70, v71, v232
    v_max3_f32 v232, v72, v73, v232
    v_max3_f32 v232, v74, v75, v232
    v_max3_f32 v232, v76, v77, v232
    v_max3_f32 v232, v78, v79, v232
    v_max3_f32 v233, v80, v81, v233
    v_max3_f32 v233, v82, v83, v233
    v_max3_f32 v233, v84, v85, v233
    v_max3_f32 v233, v86, v87, v233
    v_max3_f32 v233, v88, v89, v233
    v_max3_f32 v233, v90, v91, v233
    v_max3_f32 v233, v92, v93, v233
    v_max3_f32 v233, v94, v95, v233
    ds_read_b128 v[112:115], v7 offset:8192
    ds_read_b128 v[116:119], v7 offset:9216
    s_waitcnt lgkmcnt(0)
    v_mfma_f32_32x32x16_bf16 v[64:79], v[112:115], v[16:19], 0
    v_mfma_f32_32x32x16_bf16 v[64:79], v[116:119], v[20:23], v[64:79]
    v_mfma_f32_32x32x16_bf16 v[80:95], v[112:115], v[24:27], 0
    v_mfma_f32_32x32x16_bf16 v[80:95], v[116:119], v[28:31], v[80:95]
    s_nop 9
    v_max3_f32 v232, v64, v65, v232
    v_max3_f32 v232, v66, v67, v232
    v_max3_f32 v232, v68, v69, v232
    v_max3_f32 v232, v70, v71, v232
    v_max3_f32 v232, v72, v73, v232
    v_max3_f32 v232, v74, v75, v232
    v_max3_f32 v232, v76, v77, v232
    v_max3_f32 v232, v78, v79, v232
    v_max3_f32 v233, v80, v81, v233
    v_max3_f32 v233, v82, v83, v233
    v_max3_f32 v233, v84, v85, v233
    v_max3_f32 v233, v86, v87, v233
    v_max3_f32 v233, v88, v89, v233
    v_max3_f32 v233, v90, v91, v233
    v_max3_f32 v233, v92, v93, v233
    v_max3_f32 v233, v94, v95, v233
    ds_read_b128 v[112:115], v7 offset:12288
    ds_read_b128 v[116:119], v7 offset:13312
    s_waitcnt lgkmcnt(0)
    v_mfma_f32_32x32x16_bf16 v[64:79], v[112:115], v[16:19], 0
    v_mfma_f32_32x32x16_bf16 v[64:79], v[116:119], v[20:23], v[64:79]
    v_mfma_f32_32x32x16_bf16 v[80:95], v[112:115], v[24:27], 0
    v_mfma_f32_32x32x16_bf16 v[80:95], v[116:119], v[28:31], v[80:95]
    s_nop 9
    v_max3_f32 v232, v64, v65, v232
    v_max3_f32 v232, v66, v67, v232
    v_max3_f32 v232, v68, v69, v232
    v_max3_f32 v232, v70, v71, v232
    v_max3_f32 v232, v72, v73, v232
    v_max3_f32 v232, v74, v75, v232
    v_max3_f32 v232, v76, v77, v232
    v_max3_f32 v232, v78, v79, v232
    v_max3_f32 v233, v80, v81, v233
    v_max3_f32 v233, v82, v83, v233
    v_max3_f32 v233, v84, v85, v233
    v_max3_f32 v233, v86, v87, v233
    v_max3_f32 v233, v88, v89, v233
    v_max3_f32 v233, v90, v91, v233
    v_max3_f32 v233, v92, v93, v233
    v_max3_f32 v233, v94, v95, v233
    s_waitcnt vmcnt(4)
    s_barrier
    s_add_u32 s53, s53, 16384
    s_and_b32 s53, s53, 0xffff
    v_add_u32 v7, s53, v14
    s_mov_b32 m0, s36
    s_nop 0
    buffer_load_dwordx4 v14, s[4:7], s34 offen offset:0 sc1 lds
    buffer_load_dwordx4 v14, s[4:7], s34 offen offset:1024 sc1 lds
    buffer_load_dwordx4 v14, s[4:7], s34 offen offset:2048 sc1 lds
    buffer_load_dwordx4 v14, s[4:7], s34 offen offset:3072 sc1 lds
    s_add_u32 s34, s34, 16384
    s_add_u32 s36, s36, 16384
    s_and_b32 s36, s36, 0xffff
    s_sub_u32 s38, s38, 1
    s_cmp_lg_u32 s38, 0
    s_cbranch_scc1 L_amax_32
    s_waitcnt vmcnt(0) lgkmcnt(0)
    v_mov_b32 v224, v232
    v_mov_b32 v225, v232
    s_nop 1
    v_permlane32_swap_b32 v224, v225
    v_max_f32 v224, v224, v225
    v_max_f32 v224, v224, v232
    v_sub_f32 v192, 0, v224
    v_sub_f32 v193, 0, v224
    v_sub_f32 v194, 0, v224
    v_sub_f32 v195, 0, v224
    v_sub_f32 v196, 0, v224
    v_sub_f32 v197, 0, v224
    v_sub_f32 v198, 0, v224
    v_sub_f32 v199, 0, v224
    v_sub_f32 v200, 0, v224
    v_sub_f32 v201, 0, v224
    v_sub_f32 v202, 0, v224
    v_sub_f32 v203, 0, v224
    v_sub_f32 v204, 0, v224
    v_sub_f32 v205, 0, v224
    v_sub_f32 v206, 0, v224
    v_sub_f32 v207, 0, v224
    v_mov_b32 v224, v233
    v_mov_b32 v225, v233
    s_nop 1
    v_permlane32_swap_b32 v224, v225
    v_max_f32 v224, v224, v225
    v_max_f32 v224, v224, v233
    v_sub_f32 v208, 0, v224
    v_sub_f32 v209, 0, v224
    v_sub_f32 v210, 0, v224
    v_sub_f32 v211, 0, v224
    v_sub_f32 v212, 0, v224
    v_sub_f32 v213, 0, v224
    v_sub_f32 v214, 0, v224
    v_sub_f32 v215, 0, v224
    v_sub_f32 v216, 0, v224
    v_sub_f32 v217, 0, v224
    v_sub_f32 v218, 0, v224
    v_sub_f32 v219, 0, v224
    v_sub_f32 v220, 0, v224
    v_sub_f32 v221, 0, v224
    v_sub_f32 v222, 0, v224
    v_sub_f32 v223, 0, v224
    s_nop 7
    s_waitcnt vmcnt(0) lgkmcnt(0)
    s_barrier
    s_lshl_b32 s36, s3, 12
    s_add_u32 s34, s36, 65536
    s_mov_b32 m0, s36
    s_nop 0
    buffer_load_dwordx4 v14, s[4:7], s34 offen offset:0 sc1 lds
    buffer_load_dwordx4 v14, s[4:7], s34 offen offset:1024 sc1 lds
    buffer_load_dwordx4 v14, s[4:7], s34 offen offset:2048 sc1 lds
    buffer_load_dwordx4 v14, s[4:7], s34 offen offset:3072 sc1 lds
    s_add_u32 s34, s34, 16384
    s_add_u32 s36, s36, 16384
    s_and_b32 s36, s36, 0xffff
    s_mov_b32 m0, s36
    s_nop 0
    buffer_load_dwordx4 v14, s[4:7], s34 offen offset:0 sc1 lds
    buffer_load_dwordx4 v14, s[4:7], s34 offen offset:1024 sc1 lds
    buffer_load_dwordx4 v14, s[4:7], s34 offen offset:2048 sc1 lds
    buffer_load_dwordx4 v14, s[4:7], s34 offen offset:3072 sc1 lds
    s_add_u32 s34, s34, 16384
    s_add_u32 s36, s36, 16384
    s_and_b32 s36, s36, 0xffff
    s_mov_b32 m0, s36
    s_nop 0
    buffer_load_dwordx4 v14, s[4:7], s34 offen offset:0 sc1 lds
    buffer_load_dwordx4 v14, s[4:7], s34 offen offset:1024 sc1 lds
    buffer_load_dwordx4 v14, s[4:7], s34 offen offset:2048 sc1 lds
    buffer_load_dwordx4 v14, s[4:7], s34 offen offset:3072 sc1 lds
    s_add_u32 s34, s34, 16384
    s_add_u32 s36, s36, 16384
    s_and_b32 s36, s36, 0xffff
    v_mov_b32 v7, v14
    s_mov_b32 s53, 0
    s_waitcnt vmcnt(8)
    s_barrier
    v_mov_b32 v32, 0
    v_mov_b32 v33, 0
    v_mov_b32 v34, 0
    v_mov_b32 v35, 0
    v_mov_b32 v36, 0
    v_mov_b32 v37, 0
    v_mov_b32 v38, 0
    v_mov_b32 v39, 0
    v_mov_b32 v40, 0
    v_mov_b32 v41, 0
    v_mov_b32 v42, 0
    v_mov_b32 v43, 0
    v_mov_b32 v44, 0
    v_mov_b32 v45, 0
    v_mov_b32 v46, 0
    v_mov_b32 v47, 0
    v_mov_b32 v176, 0
    v_mov_b32 v177, 0
    v_mov_b32 v178, 0
    v_mov_b32 v179, 0
    v_mov_b32 v48, 0
    v_mov_b32 v49, 0
    v_mov_b32 v50, 0
    v_mov_b32 v51, 0
    v_mov_b32 v52, 0
    v_mov_b32 v53, 0
    v_mov_b32 v54, 0
    v_mov_b32 v55, 0
    v_mov_b32 v56, 0
    v_mov_b32 v57, 0
    v_mov_b32 v58, 0
    v_mov_b32 v59, 0
    v_mov_b32 v60, 0
    v_mov_b32 v61, 0
    v_mov_b32 v62, 0
    v_mov_b32 v63, 0
    v_mov_b32 v180, 0
    v_mov_b32 v181, 0
    v_mov_b32 v182, 0
    v_mov_b32 v183, 0
    v_mov_b32 v104, 0
    v_mov_b32 v168, 0
    v_mov_b32 v105, 0
    v_mov_b32 v169, 0
    v_mov_b32 v106, 0
    v_mov_b32 v170, 0
    v_mov_b32 v107, 0
    v_mov_b32 v171, 0
    v_mov_b32 v108, 0
    v_mov_b32 v172, 0
    v_mov_b32 v109, 0
    v_mov_b32 v173, 0
    v_mov_b32 v110, 0
    v_mov_b32 v174, 0
    v_mov_b32 v111, 0
    v_mov_b32 v175, 0
    ds_read_b128 v[112:115], v7 offset:0
    ds_read_b128 v[116:119], v7 offset:1024
    s_waitcnt lgkmcnt(0)
    v_mfma_f32_32x32x16_bf16 v[64:79], v[112:115], v[16:19], v[192:207]
    v_mfma_f32_32x32x16_bf16 v[64:79], v[116:119], v[20:23], v[64:79]
    s_nop 7
    s_mov_b32 s38, 16
.p2align 6
L_attnf_33:
    ds_read_b128 v[120:123], v7 offset:4096
    ds_read_b128 v[124:127], v7 offset:5120
    ds_read_b128 v[160:163], v7 offset:2048
    ds_read_b128 v[164:167], v7 offset:3072
    v_mfma_f32_32x32x16_bf16 v[80:95], v[112:115], v[24:27], v[208:223]
    v_exp_f32 v64, v64
    v_exp_f32 v65, v65
    v_exp_f32 v66, v66
    v_exp_f32 v67, v67
    v_cvt_pk_bf16_f32 v96, v64, v65
    v_mfma_f32_32x32x16_bf16 v[80:95], v[116:119], v[28:31], v[80:95]
    v_exp_f32 v68, v68
    v_exp_f32 v69, v69
    v_cvt_pk_bf16_f32 v97, v66, v67
    v_exp_f32 v70, v70
    v_exp_f32 v71, v71
    v_mfma_f32_32x32x16_bf16 v[48:63], v[168:171], v[104:107], v[48:63]
    v_cvt_pk_bf16_f32 v98, v68, v69
    v_exp_f32 v72, v72
    v_exp_f32 v73, v73
    v_cvt_pk_bf16_f32 v99, v70, v71
    v_mfma_f32_32x32x16_bf16 v[48:63], v[172:175], v[108:111], v[48:63]
    v_exp_f32 v74, v74
    v_exp_f32 v75, v75
    v_cvt_pk_bf16_f32 v100, v72, v73
    v_exp_f32 v76, v76
    v_exp_f32 v77, v77
    v_smfmac_f32_16x16x64_bf16 v[180:183], v[184:187], v[104:111], v188
    v_cvt_pk_bf16_f32 v101, v74, v75
    v_exp_f32 v78, v78
    v_exp_f32 v79, v79
    v_cvt_pk_bf16_f32 v102, v76, v77
    v_cvt_pk_bf16_f32 v103, v78, v79
    s_waitcnt lgkmcnt(0)
    v_mfma_f32_32x32x16_bf16 v[64:79], v[120:123], v[16:19], v[192:207]
    v_exp_f32 v80, v80
    v_exp_f32 v81, v81
    v_exp_f32 v82, v82
    v_exp_f32 v83, v83
    v_cvt_pk_bf16_f32 v104, v80, v81
    v_mfma_f32_32x32x16_bf16 v[64:79], v[124:127], v[20:23], v[64:79]
    v_exp_f32 v84, v84
    v_exp_f32 v85, v85
    v_cvt_pk_bf16_f32 v105, v82, v83
    v_exp_f32 v86, v86
    v_exp_f32 v87, v87
    v_mfma_f32_32x32x16_bf16 v[32:47], v[160:163], v[96:99], v[32:47]
    v_cvt_pk_bf16_f32 v106, v84, v85
    v_exp_f32 v88, v88
    v_exp_f32 v89, v89
    v_cvt_pk_bf16_f32 v107, v86, v87
    v_mfma_f32_32x32x16_bf16 v[32:47], v[164:167], v[100:103], v[32:47]
    v_exp_f32 v90, v90
    v_exp_f32 v91, v91
    v_cvt_pk_bf16_f32 v108, v88, v89
    v_exp_f32 v92, v92
    v_exp_f32 v93, v93
    v_smfmac_f32_16x16x64_bf16 v[176:179], v[184:187], v[96:103], v188
    v_cvt_pk_bf16_f32 v109, v90, v91
    v_exp_f32 v94, v94
    v_exp_f32 v95, v95
    v_cvt_pk_bf16_f32 v110, v92, v93
    v_cvt_pk_bf16_f32 v111, v94, v95
    ds_read_b128 v[112:115], v7 offset:8192
    ds_read_b128 v[116:119], v7 offset:9216
    ds_read_b128 v[168:171], v7 offset:6144
    ds_read_b128 v[172:175], v7 offset:7168
    v_mfma_f32_32x32x16_bf16 v[80:95], v[120:123], v[24:27], v[208:223]
    v_exp_f32 v64, v64
    v_exp_f32 v65, v65
    v_exp_f32 v66, v66
    v_exp_f32 v67, v67
    v_cvt_pk_bf16_f32 v96, v64, v65
    v_mfma_f32_32x32x16_bf16 v[80:95], v[124:127], v[28:31], v[80:95]
    v_exp_f32 v68, v68
    v_exp_f32 v69, v69
    v_cvt_pk_bf16_f32 v97, v66, v67
    v_exp_f32 v70, v70
    v_exp_f32 v71, v71
    v_mfma_f32_32x32x16_bf16 v[48:63], v[160:163], v[104:107], v[48:63]
    v_cvt_pk_bf16_f32 v98, v68, v69
    v_exp_f32 v72, v72
    v_exp_f32 v73, v73
    v_cvt_pk_bf16_f32 v99, v70, v71
    v_mfma_f32_32x32x16_bf16 v[48:63], v[164:167], v[108:111], v[48:63]
    v_exp_f32 v74, v74
    v_exp_f32 v75, v75
    v_cvt_pk_bf16_f32 v100, v72, v73
    v_exp_f32 v76, v76
    v_exp_f32 v77, v77
    v_smfmac_f32_16x16x64_bf16 v[180:183], v[184:187], v[104:111], v188
    v_cvt_pk_bf16_f32 v101, v74, v75
    v_exp_f32 v78, v78
    v_exp_f32 v79, v79
    v_cvt_pk_bf16_f32 v102, v76, v77
    v_cvt_pk_bf16_f32 v103, v78, v79
    s_waitcnt lgkmcnt(0)
    v_mfma_f32_32x32x16_bf16 v[64:79], v[112:115], v[16:19], v[192:207]
    v_exp_f32 v80, v80
    v_exp_f32 v81, v81
    v_exp_f32 v82, v82
    v_exp_f32 v83, v83
    v_cvt_pk_bf16_f32 v104, v80, v81
    v_mfma_f32_32x32x16_bf16 v[64:79], v[116:119], v[20:23], v[64:79]
    v_exp_f32 v84, v84
    v_exp_f32 v85, v85
    v_cvt_pk_bf16_f32 v105, v82, v83
    v_exp_f32 v86, v86
    v_exp_f32 v87, v87
    v_mfma_f32_32x32x16_bf16 v[32:47], v[168:171], v[96:99], v[32:47]
    v_cvt_pk_bf16_f32 v106, v84, v85
    v_exp_f32 v88, v88
    v_exp_f32 v89, v89
    v_cvt_pk_bf16_f32 v107, v86, v87
    v_mfma_f32_32x32x16_bf16 v[32:47], v[172:175], v[100:103], v[32:47]
    v_exp_f32 v90, v90
    v_exp_f32 v91, v91
    v_cvt_pk_bf16_f32 v108, v88, v89
    v_exp_f32 v92, v92
    v_exp_f32 v93, v93
    v_smfmac_f32_16x16x64_bf16 v[176:179], v[184:187], v[96:103], v188
    v_cvt_pk_bf16_f32 v109, v90, v91
    v_exp_f32 v94, v94
    v_exp_f32 v95, v95
    v_cvt_pk_bf16_f32 v110, v92, v93
    v_cvt_pk_bf16_f32 v111, v94, v95
    ds_read_b128 v[120:123], v7 offset:12288
    ds_read_b128 v[124:127], v7 offset:13312
    ds_read_b128 v[160:163], v7 offset:10240
    ds_read_b128 v[164:167], v7 offset:11264
    v_mfma_f32_32x32x16_bf16 v[80:95], v[112:115], v[24:27], v[208:223]
    v_exp_f32 v64, v64
    v_exp_f32 v65, v65
    v_exp_f32 v66, v66
    v_exp_f32 v67, v67
    v_cvt_pk_bf16_f32 v96, v64, v65
    v_mfma_f32_32x32x16_bf16 v[80:95], v[116:119], v[28:31], v[80:95]
    v_exp_f32 v68, v68
    v_exp_f32 v69, v69
    v_cvt_pk_bf16_f32 v97, v66, v67
    v_exp_f32 v70, v70
    v_exp_f32 v71, v71
    v_mfma_f32_32x32x16_bf16 v[48:63], v[168:171], v[104:107], v[48:63]
    v_cvt_pk_bf16_f32 v98, v68, v69
    v_exp_f32 v72, v72
    v_exp_f32 v73, v73
    v_cvt_pk_bf16_f32 v99, v70, v71
    v_mfma_f32_32x32x16_bf16 v[48:63], v[172:175], v[108:111], v[48:63]
    v_exp_f32 v74, v74
    v_exp_f32 v75, v75
    v_cvt_pk_bf16_f32 v100, v72, v73
    v_exp_f32 v76, v76
    v_exp_f32 v77, v77
    v_smfmac_f32_16x16x64_bf16 v[180:183], v[184:187], v[104:111], v188
    v_cvt_pk_bf16_f32 v101, v74, v75
    v_exp_f32 v78, v78
    v_exp_f32 v79, v79
    v_cvt_pk_bf16_f32 v102, v76, v77
    v_cvt_pk_bf16_f32 v103, v78, v79
    s_waitcnt lgkmcnt(0)
    v_mfma_f32_32x32x16_bf16 v[64:79], v[120:123], v[16:19], v[192:207]
    v_exp_f32 v80, v80
    v_exp_f32 v81, v81
    v_exp_f32 v82, v82
    v_exp_f32 v83, v83
    v_cvt_pk_bf16_f32 v104, v80, v81
    v_mfma_f32_32x32x16_bf16 v[64:79], v[124:127], v[20:23], v[64:79]
    v_exp_f32 v84, v84
    v_exp_f32 v85, v85
    v_cvt_pk_bf16_f32 v105, v82, v83
    v_exp_f32 v86, v86
    v_exp_f32 v87, v87
    v_mfma_f32_32x32x16_bf16 v[32:47], v[160:163], v[96:99], v[32:47]
    v_cvt_pk_bf16_f32 v106, v84, v85
    v_exp_f32 v88, v88
    v_exp_f32 v89, v89
    v_cvt_pk_bf16_f32 v107, v86, v87
    v_mfma_f32_32x32x16_bf16 v[32:47], v[164:167], v[100:103], v[32:47]
    v_exp_f32 v90, v90
    v_exp_f32 v91, v91
    v_cvt_pk_bf16_f32 v108, v88, v89
    v_exp_f32 v92, v92
    v_exp_f32 v93, v93
    v_smfmac_f32_16x16x64_bf16 v[176:179], v[184:187], v[96:103], v188
    v_cvt_pk_bf16_f32 v109, v90, v91
    v_exp_f32 v94, v94
    v_exp_f32 v95, v95
    v_cvt_pk_bf16_f32 v110, v92, v93
    v_cvt_pk_bf16_f32 v111, v94, v95
    s_waitcnt vmcnt(4)
    s_barrier
    s_add_u32 s53, s53, 16384
    s_and_b32 s53, s53, 0xffff
    ds_read_b128 v[168:171], v7 offset:14336
    ds_read_b128 v[172:175], v7 offset:15360
    v_add_u32 v7, s53, v14
    ds_read_b128 v[112:115], v7 offset:0
    ds_read_b128 v[116:119], v7 offset:1024
    s_mov_b32 m0, s36
    s_nop 0
    buffer_load_dwordx4 v14, s[4:7], s34 offen offset:0 sc1 lds
    buffer_load_dwordx4 v14, s[4:7], s34 offen offset:1024 sc1 lds
    buffer_load_dwordx4 v14, s[4:7], s34 offen offset:2048 sc1 lds
    buffer_load_dwordx4 v14, s[4:7], s34 offen offset:3072 sc1 lds
    s_add_u32 s34, s34, 16384
    s_add_u32 s36, s36, 16384
    s_and_b32 s36, s36, 0xffff
    v_mfma_f32_32x32x16_bf16 v[80:95], v[120:123], v[24:27], v[208:223]
    v_exp_f32 v64, v64
    v_exp_f32 v65, v65
    v_exp_f32 v66, v66
    v_exp_f32 v67, v67
    v_cvt_pk_bf16_f32 v96, v64, v65
    v_mfma_f32_32x32x16_bf16 v[80:95], v[124:127], v[28:31], v[80:95]
    v_exp_f32 v68, v68
    v_exp_f32 v69, v69
    v_cvt_pk_bf16_f32 v97, v66, v67
    v_exp_f32 v70, v70
    v_exp_f32 v71, v71
    v_mfma_f32_32x32x16_bf16 v[48:63], v[160:163], v[104:107], v[48:63]
    v_cvt_pk_bf16_f32 v98, v68, v69
    v_exp_f32 v72, v72
    v_exp_f32 v73, v73
    v_cvt_pk_bf16_f32 v99, v70, v71
    v_mfma_f32_32x32x16_bf16 v[48:63], v[164:167], v[108:111], v[48:63]
    v_exp_f32 v74, v74
    v_exp_f32 v75, v75
    v_cvt_pk_bf16_f32 v100, v72, v73
    v_exp_f32 v76, v76
    v_exp_f32 v77, v77
    v_smfmac_f32_16x16x64_bf16 v[180:183], v[184:187], v[104:111], v188
    v_cvt_pk_bf16_f32 v101, v74, v75
    v_exp_f32 v78, v78
    v_exp_f32 v79, v79
    v_cvt_pk_bf16_f32 v102, v76, v77
    v_cvt_pk_bf16_f32 v103, v78, v79
    s_waitcnt lgkmcnt(0)
    v_mfma_f32_32x32x16_bf16 v[64:79], v[112:115], v[16:19], v[192:207]
    v_exp_f32 v80, v80
    v_exp_f32 v81, v81
    v_exp_f32 v82, v82
    v_exp_f32 v83, v83
    v_cvt_pk_bf16_f32 v104, v80, v81
    v_mfma_f32_32x32x16_bf16 v[64:79], v[116:119], v[20:23], v[64:79]
    v_exp_f32 v84, v84
    v_exp_f32 v85, v85
    v_cvt_pk_bf16_f32 v105, v82, v83
    v_exp_f32 v86, v86
    v_exp_f32 v87, v87
    v_mfma_f32_32x32x16_bf16 v[32:47], v[168:171], v[96:99], v[32:47]
    v_cvt_pk_bf16_f32 v106, v84, v85
    v_exp_f32 v88, v88
    v_exp_f32 v89, v89
    v_cvt_pk_bf16_f32 v107, v86, v87
    v_mfma_f32_32x32x16_bf16 v[32:47], v[172:175], v[100:103], v[32:47]
    v_exp_f32 v90, v90
    v_exp_f32 v91, v91
    v_cvt_pk_bf16_f32 v108, v88, v89
    v_exp_f32 v92, v92
    v_exp_f32 v93, v93
    v_smfmac_f32_16x16x64_bf16 v[176:179], v[184:187], v[96:103], v188
    v_cvt_pk_bf16_f32 v109, v90, v91
    v_exp_f32 v94, v94
    v_exp_f32 v95, v95
    v_cvt_pk_bf16_f32 v110, v92, v93
    v_cvt_pk_bf16_f32 v111, v94, v95
    s_sub_u32 s38, s38, 1
    s_cmp_lg_u32 s38, 0
    s_cbranch_scc1 L_attnf_33
    v_mfma_f32_32x32x16_bf16 v[48:63], v[168:171], v[104:107], v[48:63]
    v_mfma_f32_32x32x16_bf16 v[48:63], v[172:175], v[108:111], v[48:63]
    v_smfmac_f32_16x16x64_bf16 v[180:183], v[184:187], v[104:111], v188
    v_add_f32 v176, v176, v177
    s_nop 6
    v_add_f32 v180, v180, v181
    s_waitcnt vmcnt(0) lgkmcnt(0)
    s_nop 15
L_attn_fin:
    s_lshr_b32 s28, s3, 1
    s_lshl_b32 s28, s28, 8
    s_lshl_b32 s29, s26, 9
    s_add_u32 s28, s28, s29
    s_add_u32 s28, s28, 8192
    v_and_b32 v224, 31, v0
    v_lshlrev_b32 v224, 2, v224
    buffer_load_dword v226, v224, s[4:7], s28 offen offset:0 sc1
    buffer_load_dword v227, v224, s[4:7], s28 offen offset:128 sc1
    s_lshl_b32 s28, s26, 5
    s_lshl_b32 s29, s27, 1
    s_add_u32 s28, s28, s29
    s_and_b32 s29, s3, 1
    s_add_u32 s28, s28, s29
    s_lshl_b32 s28, s28, 13
    s_lshr_b32 s29, s3, 1
    s_lshl_b32 s29, s29, 12
    s_add_u32 s28, s28, s29
    s_add_u32 s57, s28, 1048576
    v_bfe_u32 v230, v0, 4, 1
    v_lshlrev_b32 v230, 10, v230
    v_and_b32 v231, 15, v0
    v_lshlrev_b32 v231, 4, v231
    v_add_u32 v230, v230, v231
    v_lshrrev_b32 v231, 5, v0
    v_lshlrev_b32 v231, 8, v231
    v_add_u32 v230, v230, v231
    v_rcp_f32 v228, v176
    v_rcp_f32 v229, v180
    s_waitcnt vmcnt(0)
    v_mul_f32 v228, v228, v226
    v_mul_f32 v229, v229, v227
    v_mul_f32 v32, v228, v32
    v_mul_f32 v33, v228, v33
    v_mul_f32 v34, v228, v34
    v_mul_f32 v35, v228, v35
    v_mul_f32 v36, v228, v36
    v_mul_f32 v37, v228, v37
    v_mul_f32 v38, v228, v38
    v_mul_f32 v39, v228, v39
    v_mul_f32 v40, v228, v40
    v_mul_f32 v41, v228, v41
    v_mul_f32 v42, v228, v42
    v_mul_f32 v43, v228, v43
    v_mul_f32 v44, v228, v44
    v_mul_f32 v45, v228, v45
    v_mul_f32 v46, v228, v46
    v_mul_f32 v47, v228, v47
    v_cvt_pk_bf16_f32 v64, v32, v33
    v_cvt_pk_bf16_f32 v65, v34, v35
    v_cvt_pk_bf16_f32 v66, v40, v41
    v_cvt_pk_bf16_f32 v67, v42, v43
    buffer_store_dwordx4 v[64:67], v230, s[4:7], s57 offen offset:0 sc1
    v_cvt_pk_bf16_f32 v68, v36, v37
    v_cvt_pk_bf16_f32 v69, v38, v39
    v_cvt_pk_bf16_f32 v70, v44, v45
    v_cvt_pk_bf16_f32 v71, v46, v47
    buffer_store_dwordx4 v[68:71], v230, s[4:7], s57 offen offset:512 sc1
    v_mul_f32 v48, v229, v48
    v_mul_f32 v49, v229, v49
    v_mul_f32 v50, v229, v50
    v_mul_f32 v51, v229, v51
    v_mul_f32 v52, v229, v52
    v_mul_f32 v53, v229, v53
    v_mul_f32 v54, v229, v54
    v_mul_f32 v55, v229, v55
    v_mul_f32 v56, v229, v56
    v_mul_f32 v57, v229, v57
    v_mul_f32 v58, v229, v58
    v_mul_f32 v59, v229, v59
    v_mul_f32 v60, v229, v60
    v_mul_f32 v61, v229, v61
    v_mul_f32 v62, v229, v62
    v_mul_f32 v63, v229, v63
    v_cvt_pk_bf16_f32 v80, v48, v49
    v_cvt_pk_bf16_f32 v81, v50, v51
    v_cvt_pk_bf16_f32 v82, v56, v57
    v_cvt_pk_bf16_f32 v83, v58, v59
    buffer_store_dwordx4 v[80:83], v230, s[4:7], s57 offen offset:2048 sc1
    v_cvt_pk_bf16_f32 v84, v52, v53
    v_cvt_pk_bf16_f32 v85, v54, v55
    v_cvt_pk_bf16_f32 v86, v60, v61
    v_cvt_pk_bf16_f32 v87, v62, v63
    buffer_store_dwordx4 v[84:87], v230, s[4:7], s57 offen offset:2560 sc1
    s_lshl_b32 s28, s26, 7
    s_lshl_b32 s29, s27, 2
    s_add_u32 s28, s28, s29
    s_add_u32 s59, s28, 2176
    v_mov_b32 v232, 1
    s_waitcnt vmcnt(0) lgkmcnt(0)
    s_cmp_lg_u32 s3, 0
    s_cbranch_scc1 L_sig0_35
    v_readfirstlane_b32 s31, v232
    s_nop 2
    s_cmp_lg_u32 s31, 0
    s_cbranch_scc1 L_rdyok_36
    v_mov_b32 v225, 0
    s_bfm_b64 exec, 1, 0
    s_mov_b32 s39, 200000
L_poll_37:
    buffer_load_dword v232, v225, s[20:23], 0 offen sc1
    s_waitcnt vmcnt(0)
    v_cmp_ne_u32 vcc, 0, v232
    s_nop 3
    s_cmp_eq_u64 vcc, exec
    s_cbranch_scc1 L_polld_38
    s_sleep 4
    s_sub_u32 s39, s39, 1
    s_cmp_lg_u32 s39, 0
    s_cbranch_scc1 L_poll_37
L_polld_38:
    s_mov_b64 exec, -1
L_rdyok_36:
L_sig0_35:
    s_barrier
    s_cmp_lg_u32 s3, 0
    s_cbranch_scc1 L_sig_34
    v_mov_b32 v224, 1
    v_mov_b32 v225, 0
    s_mov_b64 exec, 1
    buffer_store_dword v224, v225, s[4:7], s59 offen sc1
    s_mov_b64 exec, -1
L_sig_34:
    s_waitcnt vmcnt(0)
    s_endpgm
L_exit:
    s_endpgm
.section .rodata,"a"
.p2align 6
.amdhsa_kernel gated_mix__grouped_kv_mqa__dense_activation_mish__prompt_kernel
  .amdhsa_next_free_vgpr 256
  .amdhsa_next_free_sgpr 102
  .amdhsa_accum_offset 256
  .amdhsa_group_segment_fixed_size 0
  .amdhsa_kernarg_size 104
  .amdhsa_user_sgpr_count 2
  .amdhsa_user_sgpr_kernarg_segment_ptr 1
  .amdhsa_system_sgpr_workgroup_id_x 1
  .amdhsa_float_denorm_mode_32 3
.end_amdhsa_kernel
```
